```python
import torch

def _softmax(x, axis=-1):
    return torch.softmax(x, dim=axis)

def _gelu(x):
    return torch.nn.functional.gelu(x, approximate='tanh')

def _silu(x):
    return torch.nn.functional.silu(x)

def _sigmoid(x):
    return torch.sigmoid(x)

def _layernorm(x, axis=-1, eps=1e-05):
    m = x.mean(dim=axis, keepdim=True)
    v = x.var(dim=axis, keepdim=True, unbiased=False)
    return (x - m) / torch.sqrt(v + eps)

def _scatter_add(tgt, idx, src, axis=0):
    return tgt.clone().index_add_(axis, idx, src)

def _segment_sum(src, seg, n):
    out = torch.zeros((n,) + src.shape[1:], dtype=src.dtype)
    return out.index_add_(0, seg, src)

def _pad(x, pw):
    flat = tuple((v for pair in reversed(pw) for v in pair))
    return torch.nn.functional.pad(x, flat)
kernel_name = 'adaLN_cond__grouped_kv_mqa__glu_gated_glu__prompt'

def setup_inputs():

    _w = lambda a: (lambda t: t.to(torch.bfloat16) if t.is_floating_point() else t)(torch.as_tensor(a))

    def _A_setup():
        B, S, D, H = (1, 2048, 1024, 32)
        Dh = D // H
        return {'x': _w((lambda *s: torch.randn(*s, dtype=torch.bfloat16) * 0.05)(B, S, D)), 'wq': _w((lambda *s: torch.randn(*s, dtype=torch.bfloat16) * 0.05)(D, H * Dh)), 'wk': _w((lambda *s: torch.randn(*s, dtype=torch.bfloat16) * 0.05)(D, Dh)), 'wv': _w((lambda *s: torch.randn(*s, dtype=torch.bfloat16) * 0.05)(D, Dh)), 'wo': _w((lambda *s: torch.randn(*s, dtype=torch.bfloat16) * 0.05)(H * Dh, D))}
    _A_in = _A_setup()

    def _B_setup():
        B, S, D, F = (1, 2048, 1024, 3584)
        return {'x': _w((lambda *s: torch.randn(*s, dtype=torch.bfloat16) * 0.05)(B, S, D)), 'w_gate': _w((lambda *s: torch.randn(*s, dtype=torch.bfloat16) * 0.05)(D, F)), 'w_up': _w((lambda *s: torch.randn(*s, dtype=torch.bfloat16) * 0.05)(D, F)), 'w_down': _w((lambda *s: torch.randn(*s, dtype=torch.bfloat16) * 0.05)(F, D))}
    _B_in = _B_setup()
    return {'A_x': _A_in['x'], 'A_wq': _A_in['wq'], 'A_wk': _A_in['wk'], 'A_wv': _A_in['wv'], 'A_wo': _A_in['wo'], 'B_x': _B_in['x'], 'B_w_gate': _B_in['w_gate'], 'B_w_up': _B_in['w_up'], 'B_w_down': _B_in['w_down'], 'c': _w((lambda *s: torch.randn(*s, dtype=torch.bfloat16) * 0.2)(1, 1024) * 8.0), 'w_mod': _w((lambda *s: torch.randn(*s, dtype=torch.bfloat16) * 0.2)(1024, 6 * 1024) * 1024 ** (-0.5) * 8.0)}

def reference(A_x, A_wq, A_wk, A_wv, A_wo, B_x, B_w_gate, B_w_up, B_w_down, c, w_mod):

    def _A_ref(x, wq, wk, wv, wo):
        B, S, D = x.shape
        H = 32
        Dh = D // H
        q = (lambda x, *d: x.permute(*d))((x @ wq).reshape(B, S, H, Dh), 0, 2, 1, 3)
        k = x @ wk
        v = x @ wv
        scores = torch.einsum('bhqd,bkd->bhqk', q, k) * Dh ** (-0.5)
        p = _softmax(scores, axis=-1)
        o = torch.einsum('bhqk,bkd->bhqd', p, v)
        return (lambda x, *d: x.permute(*d))(o, 0, 2, 1, 3).reshape(B, S, H * Dh) @ wo

    def _B_ref(x, w_gate, w_up, w_down):
        g = torch.einsum('bsd,df->bsf', x, w_gate)
        u = torch.einsum('bsd,df->bsf', x, w_up)
        h = _sigmoid(g) * u
        return torch.einsum('bsf,fd->bsd', h, w_down)
    x = A_x
    mod = (_silu(c) @ w_mod).reshape(c.shape[0], 6, 1, -1)
    sa, ca, ga, sb, cb, gb = (mod[:, 0].clone(), mod[:, 1].clone(), mod[:, 2].clone(), mod[:, 3].clone(), mod[:, 4].clone(), mod[:, 5].clone())
    h = _layernorm(x, axis=-1) * (1 + ca) + sa
    x = x + ga * _A_ref(h, A_wq, A_wk, A_wv, A_wo)
    h = _layernorm(x, axis=-1) * (1 + cb) + sb
    x = x + gb * _B_ref(h, B_w_gate, B_w_up, B_w_down)
    return x
```

```asm
; @launch kernel=k0_mod_kernel grid=(388,1,1) block=(256,1,1) lds=32768
; @launch kernel=ka_attn_kernel grid=(256,1,1) block=(512,1,1) lds=163840
; @launch kernel=k4_glu_kernel grid=(256,1,1) block=(256,1,1) lds=163840
.amdgcn_target "amdgcn-amd-amdhsa--gfx950"
.text
.p2align 8
.globl k0_mod_kernel
.type k0_mod_kernel,@function
k0_mod_kernel:
    s_cmp_ge_u32 s2, 388
    s_cbranch_scc1 L_k0_mod_kernel_end
    s_load_dwordx2 s[4:5], s[0:1], 72
    s_load_dwordx2 s[6:7], s[0:1], 80
    s_load_dwordx2 s[8:9], s[0:1], 104
    s_load_dwordx2 s[48:49], s[0:1], 0
    s_load_dwordx2 s[52:53], s[0:1], 16
    s_load_dwordx2 s[56:57], s[0:1], 24
    s_load_dwordx2 s[60:61], s[0:1], 8
    v_lshrrev_b32 v2, 6, v0
    v_and_b32 v1, 63, v0
    v_readfirstlane_b32 s3, v2
    s_cmp_lg_u32 s3, 0
    s_cbranch_scc1 L_k0_mod_kernel_cp_1
    s_getpc_b64 s[64:65]
L_k0_mod_kernel_pc_2:
    s_add_u32 s64, s64, k0_mod_kernel-L_k0_mod_kernel_pc_2
    s_addc_u32 s65, s65, -1
    s_mov_b32 s66, L_k0_mod_kernel_end-k0_mod_kernel
    s_mov_b32 s67, 0x20000
    s_lshr_b32 s68, s2, 3
    s_and_b32 s68, s68, 0
    s_lshl_b32 s68, s68, 12
    v_lshlrev_b32 v92, 6, v1
    v_add_u32 v92, s68, v92
    buffer_load_dword v93, v92, s[64:67], 0 offen
L_k0_mod_kernel_cp_1:
    s_cmp_lg_u32 s3, 1
    s_cbranch_scc1 L_k0_mod_kernel_cp_3
    s_getpc_b64 s[72:73]
L_k0_mod_kernel_pc_4:
    s_add_u32 s72, s72, ka_attn_kernel-L_k0_mod_kernel_pc_4
    s_addc_u32 s73, s73, 0
    s_mov_b32 s74, L_k4_glu_kernel_end-ka_attn_kernel
    s_mov_b32 s75, 0x20000
    s_lshr_b32 s76, s2, 3
    s_and_b32 s76, s76, 15
    s_lshl_b32 s76, s76, 12
    v_lshlrev_b32 v94, 6, v1
    v_add_u32 v94, s76, v94
    buffer_load_dword v95, v94, s[72:75], 0 offen
L_k0_mod_kernel_cp_3:
    s_cmp_ge_u32 s2, 384
    s_cbranch_scc1 L_k0_mod_kernel_w_6
    s_sub_u32 s29, s2, 128
    s_cmp_ge_u32 s29, 128
    s_cbranch_scc1 L_k0_mod_kernel_ln_5
    s_bfe_u32 s30, s29, 0x40003
    s_and_b32 s31, s29, 1
    s_lshl_b32 s31, s31, 4
    s_add_u32 s30, s30, s31
    s_bfe_u32 s31, s29, 0x20001
    s_add_u32 s30, s30, 0
    s_lshl_b32 s12, s31, 2
    s_add_u32 s12, s12, s3
    s_lshl_b32 s12, s12, 6
    v_and_b32 v3, 0x38, v1
    v_add_u32 v3, s12, v3
    v_lshlrev_b32 v4, 1, v3
    v_mul_u32_u24 v5, 12288, v3
    v_and_b32 v6, 7, v1
    v_lshlrev_b32 v6, 4, v6
    s_lshl_b32 s13, s30, 7
    v_add3_u32 v5, v5, v6, s13
    s_mov_b32 s41, 12288
    s_mov_b32 s42, 24576
    s_mov_b32 s43, 36864
    s_mov_b32 s44, 49152
    s_mov_b32 s45, 61440
    s_mov_b32 s46, 73728
    s_mov_b32 s47, 86016
    s_waitcnt lgkmcnt(0)
    s_mov_b32 s16, s4
    s_mov_b32 s17, s5
    s_mov_b32 s18, 0x800
    s_mov_b32 s19, 0x20000
    s_mov_b32 s20, s6
    s_mov_b32 s21, s7
    s_mov_b32 s22, 0xc00000
    s_mov_b32 s23, 0x20000
    s_mov_b32 s24, s8
    s_mov_b32 s25, s9
    s_mov_b32 s26, 0x18000
    s_mov_b32 s27, 0x20000
    buffer_load_dwordx4 v[8:11], v4, s[16:19], 0 offen
    buffer_load_dwordx4 v[32:35], v5, s[20:23], 0 offen
    buffer_load_dwordx4 v[36:39], v5, s[20:23], s41 offen
    buffer_load_dwordx4 v[40:43], v5, s[20:23], s42 offen
    buffer_load_dwordx4 v[44:47], v5, s[20:23], s43 offen
    buffer_load_dwordx4 v[48:51], v5, s[20:23], s44 offen
    buffer_load_dwordx4 v[52:55], v5, s[20:23], s45 offen
    buffer_load_dwordx4 v[56:59], v5, s[20:23], s46 offen
    buffer_load_dwordx4 v[60:63], v5, s[20:23], s47 offen
    s_waitcnt vmcnt(8)
    v_lshlrev_b32 v12, 16, v8
    v_and_b32 v13, 0xffff0000, v8
    v_lshlrev_b32 v14, 16, v9
    v_and_b32 v15, 0xffff0000, v9
    v_lshlrev_b32 v16, 16, v10
    v_and_b32 v17, 0xffff0000, v10
    v_lshlrev_b32 v18, 16, v11
    v_and_b32 v19, 0xffff0000, v11
    v_mul_f32 v20, 0xbfb8aa3b, v12
    v_mul_f32 v21, 0xbfb8aa3b, v13
    v_mul_f32 v22, 0xbfb8aa3b, v14
    v_mul_f32 v23, 0xbfb8aa3b, v15
    v_mul_f32 v24, 0xbfb8aa3b, v16
    v_mul_f32 v25, 0xbfb8aa3b, v17
    v_mul_f32 v26, 0xbfb8aa3b, v18
    v_mul_f32 v27, 0xbfb8aa3b, v19
    v_exp_f32 v20, v20
    v_exp_f32 v21, v21
    v_exp_f32 v22, v22
    v_exp_f32 v23, v23
    v_exp_f32 v24, v24
    v_exp_f32 v25, v25
    v_exp_f32 v26, v26
    v_exp_f32 v27, v27
    v_add_f32 v20, 1.0, v20
    v_add_f32 v21, 1.0, v21
    v_add_f32 v22, 1.0, v22
    v_add_f32 v23, 1.0, v23
    v_add_f32 v24, 1.0, v24
    v_add_f32 v25, 1.0, v25
    v_add_f32 v26, 1.0, v26
    v_add_f32 v27, 1.0, v27
    v_rcp_f32 v20, v20
    v_rcp_f32 v21, v21
    v_rcp_f32 v22, v22
    v_rcp_f32 v23, v23
    v_rcp_f32 v24, v24
    v_rcp_f32 v25, v25
    v_rcp_f32 v26, v26
    v_rcp_f32 v27, v27
    v_mul_f32 v12, v12, v20
    v_mul_f32 v13, v13, v21
    v_mul_f32 v14, v14, v22
    v_mul_f32 v15, v15, v23
    v_mul_f32 v16, v16, v24
    v_mul_f32 v17, v17, v25
    v_mul_f32 v18, v18, v26
    v_mul_f32 v19, v19, v27
    v_cvt_pk_bf16_f32 v8, v12, v13
    v_cvt_pk_bf16_f32 v9, v14, v15
    v_cvt_pk_bf16_f32 v10, v16, v17
    v_cvt_pk_bf16_f32 v11, v18, v19
    s_cmp_lg_u32 s30, 0
    s_cbranch_scc1 L_k0_mod_kernel_sc_8
    s_add_u32 s32, s8, 0x30000
    s_addc_u32 s33, s9, 0
    s_mov_b32 s34, 0x800
    s_mov_b32 s35, 0x20000
    buffer_store_dwordx4 v[8:11], v4, s[32:35], 0 offen sc1
L_k0_mod_kernel_sc_8:
    v_and_b32 v64, 0xffff, v8
    v_lshlrev_b32 v72, 16, v8
    v_lshrrev_b32 v65, 16, v8
    v_and_b32 v73, 0xffff0000, v8
    v_and_b32 v66, 0xffff, v9
    v_lshlrev_b32 v74, 16, v9
    v_lshrrev_b32 v67, 16, v9
    v_and_b32 v75, 0xffff0000, v9
    v_and_b32 v68, 0xffff, v10
    v_lshlrev_b32 v76, 16, v10
    v_lshrrev_b32 v69, 16, v10
    v_and_b32 v77, 0xffff0000, v10
    v_and_b32 v70, 0xffff, v11
    v_lshlrev_b32 v78, 16, v11
    v_lshrrev_b32 v71, 16, v11
    v_and_b32 v79, 0xffff0000, v11
    s_waitcnt vmcnt(7)
    v_dot2_f32_bf16 v80, v32, v64, 0
    v_dot2_f32_bf16 v81, v32, v72, 0
    v_dot2_f32_bf16 v82, v33, v64, 0
    v_dot2_f32_bf16 v83, v33, v72, 0
    v_dot2_f32_bf16 v84, v34, v64, 0
    v_dot2_f32_bf16 v85, v34, v72, 0
    v_dot2_f32_bf16 v86, v35, v64, 0
    v_dot2_f32_bf16 v87, v35, v72, 0
    s_waitcnt vmcnt(6)
    v_dot2_f32_bf16 v80, v36, v65, v80
    v_dot2_f32_bf16 v81, v36, v73, v81
    v_dot2_f32_bf16 v82, v37, v65, v82
    v_dot2_f32_bf16 v83, v37, v73, v83
    v_dot2_f32_bf16 v84, v38, v65, v84
    v_dot2_f32_bf16 v85, v38, v73, v85
    v_dot2_f32_bf16 v86, v39, v65, v86
    v_dot2_f32_bf16 v87, v39, v73, v87
    s_waitcnt vmcnt(5)
    v_dot2_f32_bf16 v80, v40, v66, v80
    v_dot2_f32_bf16 v81, v40, v74, v81
    v_dot2_f32_bf16 v82, v41, v66, v82
    v_dot2_f32_bf16 v83, v41, v74, v83
    v_dot2_f32_bf16 v84, v42, v66, v84
    v_dot2_f32_bf16 v85, v42, v74, v85
    v_dot2_f32_bf16 v86, v43, v66, v86
    v_dot2_f32_bf16 v87, v43, v74, v87
    s_waitcnt vmcnt(4)
    v_dot2_f32_bf16 v80, v44, v67, v80
    v_dot2_f32_bf16 v81, v44, v75, v81
    v_dot2_f32_bf16 v82, v45, v67, v82
    v_dot2_f32_bf16 v83, v45, v75, v83
    v_dot2_f32_bf16 v84, v46, v67, v84
    v_dot2_f32_bf16 v85, v46, v75, v85
    v_dot2_f32_bf16 v86, v47, v67, v86
    v_dot2_f32_bf16 v87, v47, v75, v87
    s_waitcnt vmcnt(3)
    v_dot2_f32_bf16 v80, v48, v68, v80
    v_dot2_f32_bf16 v81, v48, v76, v81
    v_dot2_f32_bf16 v82, v49, v68, v82
    v_dot2_f32_bf16 v83, v49, v76, v83
    v_dot2_f32_bf16 v84, v50, v68, v84
    v_dot2_f32_bf16 v85, v50, v76, v85
    v_dot2_f32_bf16 v86, v51, v68, v86
    v_dot2_f32_bf16 v87, v51, v76, v87
    s_waitcnt vmcnt(2)
    v_dot2_f32_bf16 v80, v52, v69, v80
    v_dot2_f32_bf16 v81, v52, v77, v81
    v_dot2_f32_bf16 v82, v53, v69, v82
    v_dot2_f32_bf16 v83, v53, v77, v83
    v_dot2_f32_bf16 v84, v54, v69, v84
    v_dot2_f32_bf16 v85, v54, v77, v85
    v_dot2_f32_bf16 v86, v55, v69, v86
    v_dot2_f32_bf16 v87, v55, v77, v87
    s_waitcnt vmcnt(1)
    v_dot2_f32_bf16 v80, v56, v70, v80
    v_dot2_f32_bf16 v81, v56, v78, v81
    v_dot2_f32_bf16 v82, v57, v70, v82
    v_dot2_f32_bf16 v83, v57, v78, v83
    v_dot2_f32_bf16 v84, v58, v70, v84
    v_dot2_f32_bf16 v85, v58, v78, v85
    v_dot2_f32_bf16 v86, v59, v70, v86
    v_dot2_f32_bf16 v87, v59, v78, v87
    s_waitcnt vmcnt(0)
    v_dot2_f32_bf16 v80, v60, v71, v80
    v_dot2_f32_bf16 v81, v60, v79, v81
    v_dot2_f32_bf16 v82, v61, v71, v82
    v_dot2_f32_bf16 v83, v61, v79, v83
    v_dot2_f32_bf16 v84, v62, v71, v84
    v_dot2_f32_bf16 v85, v62, v79, v85
    v_dot2_f32_bf16 v86, v63, v71, v86
    v_dot2_f32_bf16 v87, v63, v79, v87
    s_nop 2
    v_permlane32_swap_b32 v80, v84
    v_permlane32_swap_b32 v81, v85
    v_permlane32_swap_b32 v82, v86
    v_permlane32_swap_b32 v83, v87
    v_add_f32 v80, v80, v84
    v_add_f32 v81, v81, v85
    v_add_f32 v82, v82, v86
    v_add_f32 v83, v83, v87
    s_nop 0
    v_permlane16_swap_b32 v80, v82
    v_permlane16_swap_b32 v81, v83
    v_add_f32 v80, v80, v82
    v_add_f32 v81, v81, v83
    v_and_b32 v6, 7, v1
    v_lshlrev_b32 v6, 5, v6
    v_lshrrev_b32 v7, 5, v1
    v_lshl_add_u32 v6, v7, 4, v6
    v_bfe_u32 v7, v1, 4, 1
    v_lshl_add_u32 v6, v7, 3, v6
    s_lshl_b32 s14, s3, 8
    v_add_u32 v6, s14, v6
    v_add_f32_dpp v80, v80, v80 row_ror:8 row_mask:0xf bank_mask:0xf
    v_add_f32_dpp v81, v81, v81 row_ror:8 row_mask:0xf bank_mask:0xf
    ds_write_b64 v6, v[80:81]
    s_waitcnt lgkmcnt(0)
    s_barrier
    s_cmp_lg_u32 s3, 0
    s_cbranch_scc1 L_k0_mod_kernel_fin_7
    v_lshlrev_b32 v6, 2, v1
    ds_read2st64_b32 v[8:9], v6 offset0:0 offset1:1
    ds_read2st64_b32 v[10:11], v6 offset0:2 offset1:3
    s_mul_i32 s14, s31, 24576
    s_lshl_b32 s15, s30, 8
    s_add_u32 s14, s14, s15
    s_waitcnt lgkmcnt(0)
    v_add_f32 v8, v8, v9
    v_add_f32 v10, v10, v11
    v_add_f32 v8, v8, v10
    buffer_store_dword v8, v6, s[24:27], s14 offen
    s_branch L_k0_mod_kernel_fin_7
L_k0_mod_kernel_ln_5:
    s_min_u32 s30, s2, s29
    s_lshl_b32 s36, s30, 2
    s_add_u32 s36, s36, s3
    s_lshl_b32 s37, s36, 10
    v_lshlrev_b32 v7, 4, v1
    v_and_b32 v3, 7, v1
    v_bfe_u32 v4, v1, 3, 1
    v_bfe_u32 v5, v1, 4, 1
    v_lshrrev_b32 v6, 5, v1
    v_lshlrev_b32 v8, 11, v3
    v_lshl_add_u32 v8, v4, 5, v8
    v_lshl_add_u32 v8, v5, 4, v8
    v_lshl_add_u32 v8, v6, 6, v8
    s_lshl_b32 s12, s30, 14
    s_lshl_b32 s13, s3, 9
    s_add_u32 s12, s12, s13
    v_add_u32 v8, s12, v8
    s_waitcnt lgkmcnt(0)
    s_mov_b32 s50, 0x400000
    s_mov_b32 s51, 0x20000
    s_mov_b32 s62, 0x200000
    s_mov_b32 s63, 0x20000
    buffer_load_dwordx4 v[32:35], v8, s[48:51], 0 offen offset:0
    buffer_load_dwordx4 v[36:39], v8, s[48:51], 0 offen offset:128
    buffer_load_dwordx4 v[40:43], v8, s[48:51], 0 offen offset:256
    buffer_load_dwordx4 v[44:47], v8, s[48:51], 0 offen offset:384
    s_add_u32 s38, s37, 0x100000
    buffer_load_dwordx4 v[88:91], v7, s[60:63], s37 offen
    buffer_load_dwordx4 v[88:91], v7, s[60:63], s38 offen
    s_lshr_b32 s41, s30, 3
    s_lshl_b32 s41, s41, 2
    s_add_u32 s41, s41, s3
    s_lshl_b32 s41, s41, 14
    s_and_b32 s42, s30, 1
    s_lshl_b32 s42, s42, 10
    s_add_u32 s41, s41, s42
    s_add_u32 s41, s41, 384
    v_lshrrev_b32 v13, 3, v1
    v_lshlrev_b32 v13, 11, v13
    v_lshl_add_u32 v13, v3, 4, v13
    buffer_load_dwordx4 v[88:91], v13, s[60:63], s41 offen
    s_mov_b32 s24, s8
    s_mov_b32 s25, s9
    s_mov_b32 s26, 0x900000
    s_mov_b32 s27, 0x20000
    v_mov_b32 v84, -1
    v_mov_b32 v85, -1
    v_mov_b32 v86, -1
    v_mov_b32 v87, -1
    v_lshlrev_b32 v9, 2, v1
    s_lshl_b32 s39, s36, 8
    s_add_u32 s39, s39, 524288
    buffer_store_dword v84, v9, s[24:27], s39 offen sc1
    s_cmp_ge_u32 s36, 160
    s_cbranch_scc1 L_k0_mod_kernel_nf_9
    s_sub_u32 s39, s36, 96
    s_lshr_b32 s40, s39, 4
    s_mul_i32 s40, s40, 24576
    s_and_b32 s39, s39, 15
    s_lshl_b32 s39, s39, 10
    s_add_u32 s39, s39, s40
    s_add_u32 s39, s39, 8192
    s_add_u32 s40, s37, 204800
    s_cmp_lt_u32 s36, 96
    s_cselect_b32 s39, s40, s39
    buffer_store_dwordx4 v[84:87], v7, s[24:27], s39 offen sc1
L_k0_mod_kernel_nf_9:
    v_lshl_add_u32 v10, v6, 1, v4
    v_lshlrev_b32 v10, 10, v10
    v_lshl_add_u32 v10, v5, 9, v10
    v_lshl_add_u32 v10, v3, 4, v10
    s_lshr_b32 s12, s30, 2
    s_lshl_b32 s12, s12, 16
    s_and_b32 s13, s30, 3
    s_lshl_b32 s13, s13, 7
    s_add_u32 s12, s12, s13
    s_lshl_b32 s13, s3, 14
    s_add_u32 s12, s12, s13
    s_add_u32 s12, s12, 5242880
    v_add_u32 v10, s12, v10
    v_lshlrev_b32 v12, 2, v3
    v_lshl_add_u32 v11, v6, 5, v12
    s_lshl_b32 s13, s3, 6
    v_add_u32 v11, s13, v11
    v_mov_b32 v17, 0x3f803f80
    s_waitcnt vmcnt(7)
    v_permlane16_swap_b32 v32, v34
    v_permlane16_swap_b32 v33, v35
    v_dot2_f32_bf16 v18, v32, v17, 0
    v_dot2_f32_bf16 v20, v32, v32, 0
    v_dot2_f32_bf16 v19, v33, v17, 0
    v_dot2_f32_bf16 v21, v33, v33, 0
    v_dot2_f32_bf16 v18, v34, v17, v18
    v_dot2_f32_bf16 v20, v34, v34, v20
    v_dot2_f32_bf16 v19, v35, v17, v19
    v_dot2_f32_bf16 v21, v35, v35, v21
    s_waitcnt vmcnt(6)
    v_permlane16_swap_b32 v36, v38
    v_permlane16_swap_b32 v37, v39
    v_dot2_f32_bf16 v18, v36, v17, v18
    v_dot2_f32_bf16 v20, v36, v36, v20
    v_dot2_f32_bf16 v19, v37, v17, v19
    v_dot2_f32_bf16 v21, v37, v37, v21
    v_dot2_f32_bf16 v18, v38, v17, v18
    v_dot2_f32_bf16 v20, v38, v38, v20
    v_dot2_f32_bf16 v19, v39, v17, v19
    v_dot2_f32_bf16 v21, v39, v39, v21
    s_waitcnt vmcnt(5)
    v_permlane16_swap_b32 v40, v42
    v_permlane16_swap_b32 v41, v43
    v_dot2_f32_bf16 v18, v40, v17, v18
    v_dot2_f32_bf16 v20, v40, v40, v20
    v_dot2_f32_bf16 v19, v41, v17, v19
    v_dot2_f32_bf16 v21, v41, v41, v21
    v_dot2_f32_bf16 v18, v42, v17, v18
    v_dot2_f32_bf16 v20, v42, v42, v20
    v_dot2_f32_bf16 v19, v43, v17, v19
    v_dot2_f32_bf16 v21, v43, v43, v21
    s_waitcnt vmcnt(4)
    v_permlane16_swap_b32 v44, v46
    v_permlane16_swap_b32 v45, v47
    v_dot2_f32_bf16 v18, v44, v17, v18
    v_dot2_f32_bf16 v20, v44, v44, v20
    v_dot2_f32_bf16 v19, v45, v17, v19
    v_dot2_f32_bf16 v21, v45, v45, v21
    v_dot2_f32_bf16 v18, v46, v17, v18
    v_dot2_f32_bf16 v20, v46, v46, v20
    v_dot2_f32_bf16 v19, v47, v17, v19
    v_dot2_f32_bf16 v21, v47, v47, v21
    s_nop 2
    v_add_f32 v18, v18, v19
    v_add_f32 v20, v20, v21
    s_nop 1
    v_permlane32_swap_b32 v18, v20
    v_add_f32 v18, v18, v20
    v_mov_b32 v19, v18
    s_nop 1
    v_permlane16_swap_b32 v18, v19
    v_add_f32 v18, v18, v19
    s_nop 1
    v_add_f32_dpp v18, v18, v18 row_ror:8 row_mask:0xf bank_mask:0xf
    ds_write_b32 v11, v18
    s_waitcnt lgkmcnt(0)
    s_barrier
    ds_read2_b32 v[20:21], v12 offset0:0 offset1:8
    ds_read2_b32 v[22:23], v12 offset0:16 offset1:24
    ds_read2_b32 v[24:25], v12 offset0:32 offset1:40
    ds_read2_b32 v[26:27], v12 offset0:48 offset1:56
    v_lshlrev_b32 v48, 16, v32
    v_and_b32 v49, 0xffff0000, v32
    v_lshlrev_b32 v50, 16, v33
    v_and_b32 v51, 0xffff0000, v33
    v_lshlrev_b32 v52, 16, v34
    v_and_b32 v53, 0xffff0000, v34
    v_lshlrev_b32 v54, 16, v35
    v_and_b32 v55, 0xffff0000, v35
    v_lshlrev_b32 v56, 16, v36
    v_and_b32 v57, 0xffff0000, v36
    v_lshlrev_b32 v58, 16, v37
    v_and_b32 v59, 0xffff0000, v37
    v_lshlrev_b32 v60, 16, v38
    v_and_b32 v61, 0xffff0000, v38
    v_lshlrev_b32 v62, 16, v39
    v_and_b32 v63, 0xffff0000, v39
    v_lshlrev_b32 v64, 16, v40
    v_and_b32 v65, 0xffff0000, v40
    v_lshlrev_b32 v66, 16, v41
    v_and_b32 v67, 0xffff0000, v41
    v_lshlrev_b32 v68, 16, v42
    v_and_b32 v69, 0xffff0000, v42
    v_lshlrev_b32 v70, 16, v43
    v_and_b32 v71, 0xffff0000, v43
    v_lshlrev_b32 v72, 16, v44
    v_and_b32 v73, 0xffff0000, v44
    v_lshlrev_b32 v74, 16, v45
    v_and_b32 v75, 0xffff0000, v45
    v_lshlrev_b32 v76, 16, v46
    v_and_b32 v77, 0xffff0000, v46
    v_lshlrev_b32 v78, 16, v47
    v_and_b32 v79, 0xffff0000, v47
    s_waitcnt lgkmcnt(0)
    v_pk_add_f32 v[20:21], v[20:21], v[24:25]
    v_pk_add_f32 v[22:23], v[22:23], v[26:27]
    v_pk_add_f32 v[20:21], v[20:21], v[22:23]
    v_mul_f32 v24, 0x3a800000, v20
    v_mul_f32 v25, 0x3a800000, v21
    v_fma_f32 v25, -v24, v24, v25
    v_max_f32 v25, 0, v25
    v_add_f32 v25, 0x3727c5ac, v25
    v_rsq_f32 v26, v25
    s_nop 0
    v_mul_f32 v24, -v24, v26
    v_pk_fma_f32 v[48:49], v[48:49], v[26:27], v[24:25] op_sel_hi:[1,0,0]
    v_pk_fma_f32 v[50:51], v[50:51], v[26:27], v[24:25] op_sel_hi:[1,0,0]
    v_pk_fma_f32 v[52:53], v[52:53], v[26:27], v[24:25] op_sel_hi:[1,0,0]
    v_pk_fma_f32 v[54:55], v[54:55], v[26:27], v[24:25] op_sel_hi:[1,0,0]
    v_cvt_pk_bf16_f32 v32, v48, v49
    v_cvt_pk_bf16_f32 v33, v50, v51
    v_cvt_pk_bf16_f32 v34, v52, v53
    v_cvt_pk_bf16_f32 v35, v54, v55
    buffer_store_dwordx4 v[32:35], v10, s[24:27], 0 offen sc1
    v_pk_fma_f32 v[56:57], v[56:57], v[26:27], v[24:25] op_sel_hi:[1,0,0]
    v_pk_fma_f32 v[58:59], v[58:59], v[26:27], v[24:25] op_sel_hi:[1,0,0]
    v_pk_fma_f32 v[60:61], v[60:61], v[26:27], v[24:25] op_sel_hi:[1,0,0]
    v_pk_fma_f32 v[62:63], v[62:63], v[26:27], v[24:25] op_sel_hi:[1,0,0]
    v_cvt_pk_bf16_f32 v36, v56, v57
    v_cvt_pk_bf16_f32 v37, v58, v59
    v_cvt_pk_bf16_f32 v38, v60, v61
    v_cvt_pk_bf16_f32 v39, v62, v63
    s_mov_b32 s13, 4096
    buffer_store_dwordx4 v[36:39], v10, s[24:27], s13 offen sc1
    v_pk_fma_f32 v[64:65], v[64:65], v[26:27], v[24:25] op_sel_hi:[1,0,0]
    v_pk_fma_f32 v[66:67], v[66:67], v[26:27], v[24:25] op_sel_hi:[1,0,0]
    v_pk_fma_f32 v[68:69], v[68:69], v[26:27], v[24:25] op_sel_hi:[1,0,0]
    v_pk_fma_f32 v[70:71], v[70:71], v[26:27], v[24:25] op_sel_hi:[1,0,0]
    v_cvt_pk_bf16_f32 v40, v64, v65
    v_cvt_pk_bf16_f32 v41, v66, v67
    v_cvt_pk_bf16_f32 v42, v68, v69
    v_cvt_pk_bf16_f32 v43, v70, v71
    s_mov_b32 s13, 8192
    buffer_store_dwordx4 v[40:43], v10, s[24:27], s13 offen sc1
    v_pk_fma_f32 v[72:73], v[72:73], v[26:27], v[24:25] op_sel_hi:[1,0,0]
    v_pk_fma_f32 v[74:75], v[74:75], v[26:27], v[24:25] op_sel_hi:[1,0,0]
    v_pk_fma_f32 v[76:77], v[76:77], v[26:27], v[24:25] op_sel_hi:[1,0,0]
    v_pk_fma_f32 v[78:79], v[78:79], v[26:27], v[24:25] op_sel_hi:[1,0,0]
    v_cvt_pk_bf16_f32 v44, v72, v73
    v_cvt_pk_bf16_f32 v45, v74, v75
    v_cvt_pk_bf16_f32 v46, v76, v77
    v_cvt_pk_bf16_f32 v47, v78, v79
    s_mov_b32 s13, 12288
    buffer_store_dwordx4 v[44:47], v10, s[24:27], s13 offen sc1
    s_waitcnt vmcnt(0)
    s_branch L_k0_mod_kernel_fin_7
L_k0_mod_kernel_w_6:
    s_sub_u32 s30, s2, 384
    s_lshl_b32 s36, s30, 2
    s_add_u32 s36, s36, s3
    s_and_b32 s37, s36, 7
    s_lshl_b32 s37, s37, 13
    v_lshlrev_b32 v7, 4, v1
    v_bfe_u32 v12, v1, 4, 1
    v_lshlrev_b32 v12, 5, v12
    v_xor_b32 v12, v12, v7
    v_add_u32 v12, s37, v12
    s_lshl_b32 s38, s3, 13
    s_mov_b32 m0, s38
    v_and_b32 v3, 15, v1
    v_bfe_u32 v16, v1, 4, 1
    v_lshrrev_b32 v15, 5, v1
    v_lshrrev_b32 v28, 2, v3
    v_lshl_add_u32 v28, v16, 2, v28
    v_lshl_add_u32 v28, v15, 4, v28
    v_lshlrev_b32 v28, 6, v28
    v_lshl_add_u32 v28, v16, 5, v28
    v_and_b32 v29, 3, v3
    v_lshl_add_u32 v28, v29, 3, v28
    v_add_u32 v28, s38, v28
    v_xor_b32 v29, 32, v28
    s_waitcnt lgkmcnt(0)
    s_cmp_lt_u32 s36, 8
    s_cselect_b32 s16, s52, s56
    s_cselect_b32 s17, s53, s57
    s_mov_b32 s18, 0x10000
    s_mov_b32 s19, 0x20000
    s_add_u32 s24, s8, 0x50000
    s_addc_u32 s25, s9, 0
    s_mov_b32 s26, 0x20000
    s_mov_b32 s27, 0x20000
    buffer_load_dwordx4 v12, s[16:19], 0 offen offset:0 lds
    buffer_load_dwordx4 v12, s[16:19], 0 offen offset:1024 lds
    buffer_load_dwordx4 v12, s[16:19], 0 offen offset:2048 lds
    buffer_load_dwordx4 v12, s[16:19], 0 offen offset:3072 lds
    s_add_u32 m0, m0, 4096
    s_mov_b32 s13, 4096
    buffer_load_dwordx4 v12, s[16:19], s13 offen offset:0 lds
    buffer_load_dwordx4 v12, s[16:19], s13 offen offset:1024 lds
    buffer_load_dwordx4 v12, s[16:19], s13 offen offset:2048 lds
    buffer_load_dwordx4 v12, s[16:19], s13 offen offset:3072 lds
    s_lshl_b32 s12, s36, 13
    v_add_u32 v7, s12, v7
    s_waitcnt vmcnt(0)
    ds_read_b64_tr_b16 v[32:33], v28 offset:0
    ds_read_b64_tr_b16 v[34:35], v28 offset:512
    ds_read_b64_tr_b16 v[36:37], v29 offset:0
    ds_read_b64_tr_b16 v[38:39], v29 offset:512
    ds_read_b64_tr_b16 v[40:41], v28 offset:2048
    ds_read_b64_tr_b16 v[42:43], v28 offset:2560
    ds_read_b64_tr_b16 v[44:45], v29 offset:2048
    ds_read_b64_tr_b16 v[46:47], v29 offset:2560
    ds_read_b64_tr_b16 v[48:49], v28 offset:4096
    ds_read_b64_tr_b16 v[50:51], v28 offset:4608
    ds_read_b64_tr_b16 v[52:53], v29 offset:4096
    ds_read_b64_tr_b16 v[54:55], v29 offset:4608
    ds_read_b64_tr_b16 v[56:57], v28 offset:6144
    ds_read_b64_tr_b16 v[58:59], v28 offset:6656
    ds_read_b64_tr_b16 v[60:61], v29 offset:6144
    ds_read_b64_tr_b16 v[62:63], v29 offset:6656
    s_waitcnt lgkmcnt(14)
    buffer_store_dwordx4 v[32:35], v7, s[24:27], 0 offen offset:0 sc1
    s_waitcnt lgkmcnt(12)
    buffer_store_dwordx4 v[36:39], v7, s[24:27], 0 offen offset:1024 sc1
    s_waitcnt lgkmcnt(10)
    buffer_store_dwordx4 v[40:43], v7, s[24:27], 0 offen offset:2048 sc1
    s_waitcnt lgkmcnt(8)
    buffer_store_dwordx4 v[44:47], v7, s[24:27], 0 offen offset:3072 sc1
    s_waitcnt lgkmcnt(6)
    buffer_store_dwordx4 v[48:51], v7, s[24:27], s13 offen offset:0 sc1
    s_waitcnt lgkmcnt(4)
    buffer_store_dwordx4 v[52:55], v7, s[24:27], s13 offen offset:1024 sc1
    s_waitcnt lgkmcnt(2)
    buffer_store_dwordx4 v[56:59], v7, s[24:27], s13 offen offset:2048 sc1
    s_waitcnt lgkmcnt(0)
    buffer_store_dwordx4 v[60:63], v7, s[24:27], s13 offen offset:3072 sc1
    s_waitcnt vmcnt(0)
L_k0_mod_kernel_fin_7:
L_k0_mod_kernel_end:
    s_endpgm
.p2align 8
.globl ka_attn_kernel
.type ka_attn_kernel,@function
ka_attn_kernel:
    s_cmp_ge_u32 s2, 256
    s_cbranch_scc1 L_ka_attn_kernel_end
    s_load_dwordx2 s[20:21], s[0:1], 104
    s_load_dwordx2 s[24:25], s[0:1], 0
    s_load_dwordx2 s[32:33], s[0:1], 8
    s_load_dwordx2 s[60:61], s[0:1], 32
    s_load_dwordx2 s[10:11], s[0:1], 48
    s_load_dwordx2 s[96:97], s[0:1], 56
    s_load_dwordx2 s[52:53], s[0:1], 64
    s_load_dwordx2 s[56:57], s[0:1], 80
    v_lshrrev_b32 v2, 6, v0
    v_and_b32 v1, 63, v0
    v_readfirstlane_b32 s3, v2
    s_lshr_b32 s9, s3, 2
    s_lshl_b32 s36, s2, 3
    s_add_u32 s36, s36, s3
    s_mov_b32 s8, s3
    s_and_b32 s3, s3, 3
    s_and_b32 s14, s2, 7
    s_lshr_b32 s15, s2, 3
    s_lshr_b32 s12, s14, 1
    s_lshl_b32 s12, s12, 2
    s_lshr_b32 s16, s15, 3
    s_add_u32 s12, s12, s16
    s_and_b32 s13, s14, 1
    s_lshl_b32 s13, s13, 3
    s_and_b32 s16, s15, 7
    s_add_u32 s13, s13, s16
    s_lshl_b32 s37, s12, 3
    s_lshr_b32 s16, s13, 1
    s_add_u32 s37, s37, s16
    s_and_b32 s38, s13, 1
    v_lshlrev_b32 v4, 4, v1
    v_and_b32 v3, 15, v1
    v_lshrrev_b32 v2, 4, v1
    v_and_b32 v13, 31, v1
    v_lshlrev_b32 v13, 4, v13
    v_lshrrev_b32 v15, 5, v1
    v_lshl_add_u32 v13, v15, 12, v13
    s_lshl_b32 s16, s8, 9
    v_add_u32 v13, s16, v13
    s_lshr_b32 s18, s37, 1
    s_lshl_b32 s46, s18, 16
    s_lshl_b32 s17, s8, 13
    s_add_u32 s46, s46, s17
    s_and_b32 s19, s37, 1
    s_lshl_b32 s16, s19, 8
    s_add_u32 s46, s46, s16
    s_add_u32 s46, s46, 5242880
    s_lshl_b32 s15, s38, 16
    s_add_u32 s15, s15, s17
    s_add_u32 s15, s15, 327680
    v_and_b32 v12, 1, v2
    v_lshlrev_b32 v14, 10, v15
    v_lshl_add_u32 v14, v12, 9, v14
    v_lshl_add_u32 v14, v3, 4, v14
    s_lshl_b32 s43, s12, 2
    s_add_u32 s43, s43, s3
    s_lshl_b32 s41, s9, 20
    s_lshl_b32 s42, s3, 12
    s_lshl_b32 s16, s9, 16
    s_add_u32 s42, s42, s16
    v_lshrrev_b32 v5, 3, v1
    v_and_b32 v6, 7, v1
    v_lshlrev_b32 v11, 13, v5
    v_lshl_add_u32 v11, v6, 4, v11
    s_lshl_b32 s16, s3, 16
    s_lshl_b32 s17, s13, 7
    s_add_u32 s39, s16, s17
    v_add_u32 v11, s39, v11
    s_mov_b32 s22, 0x3000000
    s_mov_b32 s23, 0x20000
    s_mov_b32 s26, 0x400000
    s_mov_b32 s27, 0x20000
    s_mov_b32 s34, 0x200000
    s_mov_b32 s35, 0x20000
    s_mov_b32 s50, 0x700000
    s_mov_b32 s51, 0x20000
    s_mov_b32 s54, 0x700000
    s_mov_b32 s55, 0x20000
    s_mov_b32 s58, 0xc00000
    s_mov_b32 s59, 0x20000
    s_mov_b32 s62, 0x200000
    s_mov_b32 s63, 0x20000
    s_waitcnt lgkmcnt(0)
    s_lshl_b32 s40, s43, 16
    s_lshl_b32 s16, s9, 15
    s_add_u32 s40, s40, s16
    s_add_u32 s40, s40, 5242880
    buffer_load_dwordx4 v[144:147], v13, s[20:23], 0 offen
    s_mov_b32 s17, 24576
    buffer_load_dwordx4 v[148:151], v13, s[20:23], s17 offen
    s_mov_b32 s17, 49152
    buffer_load_dwordx4 v[152:155], v13, s[20:23], s17 offen
    s_mov_b32 s17, 73728
    buffer_load_dwordx4 v[156:159], v13, s[20:23], s17 offen
    buffer_load_dwordx4 v[128:131], v14, s[20:23], s46 offen offset:0
    buffer_load_dwordx4 v[132:135], v14, s[20:23], s46 offen offset:2048
    s_add_u32 s46, s46, 4096
    buffer_load_dwordx4 v[136:139], v14, s[20:23], s46 offen offset:0
    buffer_load_dwordx4 v[140:143], v14, s[20:23], s46 offen offset:2048
    s_barrier
    buffer_load_dwordx4 v[176:179], v4, s[20:23], s15 offen offset:0
    buffer_load_dwordx4 v[180:183], v4, s[20:23], s15 offen offset:1024
    buffer_load_dwordx4 v[184:187], v4, s[20:23], s15 offen offset:2048
    buffer_load_dwordx4 v[188:191], v4, s[20:23], s15 offen offset:3072
    s_cmp_eq_u32 s9, 0
    s_cselect_b32 s48, s10, s96
    s_cselect_b32 s49, s11, s97
    v_lshlrev_b32 v2, 9, v5
    v_lshl_add_u32 v2, v6, 4, v2
    v_add_u32 v2, s42, v2
    v_bfe_u32 v7, v1, 4, 1
    v_lshlrev_b32 v7, 2, v7
    v_xor_b32 v6, v6, v7
    v_lshlrev_b32 v6, 4, v6
    v_lshl_add_u32 v8, v5, 11, v6
    v_lshlrev_b32 v171, 4, v5
    v_add_u32 v5, s39, v8
    v_add_u32 v6, 15360, v5
    v_add_u32 v7, 30720, v5
    v_add_u32 v8, 46080, v5
    s_add_u32 s15, s15, 4096
    buffer_load_dwordx4 v[192:195], v4, s[20:23], s15 offen offset:0
    v_bfe_u32 v9, v1, 2, 2
    v_lshl_add_u32 v9, v15, 2, v9
    v_lshlrev_b32 v9, 7, v9
    v_lshl_add_u32 v9, v12, 5, v9
    v_bfe_u32 v10, v1, 1, 1
    v_lshl_add_u32 v9, v10, 4, v9
    v_bfe_u32 v10, v1, 3, 1
    v_lshl_add_u32 v9, v10, 6, v9
    v_and_b32 v10, 1, v1
    v_lshl_add_u32 v9, v10, 3, v9
    s_mul_i32 s16, s9, 0x10040
    v_xor_b32 v9, s16, v9
    v_xor_b32 v10, 64, v9
    buffer_load_dwordx4 v[196:199], v4, s[20:23], s15 offen offset:1024
    v_add_u32 v13, 131072, v13
    v_cmp_lt_u32 vcc, 31, v1
    v_lshlrev_b32 v170, 6, v15
    v_lshl_add_u32 v170, v12, 4, v170
    s_lshl_b32 s16, s8, 9
    s_add_u32 s16, s16, 131072
    v_add_u32 v170, s16, v170
    s_lshl_b32 s16, s9, 11
    s_lshl_b32 s17, s3, 7
    s_add_u32 s16, s16, s17
    s_add_u32 s16, s16, 131072
    v_add_u32 v171, s16, v171
    s_lshl_b32 s17, s8, 11
    s_add_u32 s17, s17, 139264
    v_add_u32 v172, s17, v4
    v_lshlrev_b32 v14, 4, v3
    v_lshl_add_u32 v14, v12, 9, v14
    v_lshl_add_u32 v14, v15, 3, v14
    v_xor_b32 v3, 64, v2
    v_cndmask_b32 v173, 0, 1.0, vcc
    buffer_load_dwordx4 v[200:203], v4, s[20:23], s15 offen offset:2048
    s_waitcnt vmcnt(11)
    v_pk_add_f32 v[144:145], v[144:145], v[148:149]
    v_pk_add_f32 v[152:153], v[152:153], v[156:157]
    v_pk_add_f32 v[146:147], v[146:147], v[150:151]
    v_pk_add_f32 v[154:155], v[154:155], v[158:159]
    v_pk_add_f32 v[144:145], v[144:145], v[152:153]
    v_pk_add_f32 v[146:147], v[146:147], v[154:155]
    v_cvt_pk_bf16_f32 v148, v144, v145
    v_cvt_pk_bf16_f32 v149, v146, v147
    v_lshlrev_b32 v144, 16, v148
    v_and_b32 v145, 0xffff0000, v148
    v_lshlrev_b32 v146, 16, v149
    v_and_b32 v147, 0xffff0000, v149
    buffer_load_dwordx4 v[204:207], v4, s[20:23], s15 offen offset:3072
    v_add_f32 v144, v173, v144
    v_add_f32 v145, v173, v145
    v_add_f32 v146, v173, v146
    v_add_f32 v147, v173, v147
    v_cvt_pk_bf16_f32 v148, v144, v145
    v_cvt_pk_bf16_f32 v149, v146, v147
    v_lshlrev_b32 v144, 16, v148
    v_and_b32 v145, 0xffff0000, v148
    v_lshlrev_b32 v146, 16, v149
    v_and_b32 v147, 0xffff0000, v149
    ds_write_b128 v13, v[144:147]
    ds_read_b128 v[240:243], v170 offset:0
    ds_read_b128 v[248:251], v170 offset:4096
    ds_read_b128 v[244:247], v170 offset:32
    ds_read_b128 v[252:255], v170 offset:4128
    ds_read_b128 v[144:147], v170 offset:128
    ds_read_b128 v[152:155], v170 offset:4224
    ds_read_b128 v[148:151], v170 offset:160
    ds_read_b128 v[156:159], v170 offset:4256
    s_add_u32 s14, s41, 0
    buffer_load_dwordx4 v[16:19], v11, s[32:35], s14 offen offset:0
    buffer_load_dwordx4 v[20:23], v11, s[32:35], s14 offen offset:2048
    s_waitcnt vmcnt(13) lgkmcnt(4)
    v_lshlrev_b32 v160, 16, v128
    v_and_b32 v161, 0xffff0000, v128
    v_lshlrev_b32 v162, 16, v129
    v_and_b32 v163, 0xffff0000, v129
    v_lshlrev_b32 v164, 16, v130
    v_and_b32 v165, 0xffff0000, v130
    v_lshlrev_b32 v166, 16, v131
    v_and_b32 v167, 0xffff0000, v131
    v_pk_fma_f32 v[160:161], v[160:161], v[248:249], v[240:241]
    v_pk_fma_f32 v[162:163], v[162:163], v[250:251], v[242:243]
    v_pk_fma_f32 v[164:165], v[164:165], v[252:253], v[244:245]
    v_pk_fma_f32 v[166:167], v[166:167], v[254:255], v[246:247]
    ds_read_b128 v[240:243], v170 offset:256
    ds_read_b128 v[248:251], v170 offset:4352
    ds_read_b128 v[244:247], v170 offset:288
    ds_read_b128 v[252:255], v170 offset:4384
    s_add_u32 s14, s41, 4096
    buffer_load_dwordx4 v[24:27], v11, s[32:35], s14 offen offset:0
    buffer_load_dwordx4 v[28:31], v11, s[32:35], s14 offen offset:2048
    v_cvt_pk_bf16_f32 v128, v160, v161
    v_cvt_pk_bf16_f32 v129, v162, v163
    v_cvt_pk_bf16_f32 v130, v164, v165
    v_cvt_pk_bf16_f32 v131, v166, v167
    s_waitcnt vmcnt(14) lgkmcnt(4)
    v_lshlrev_b32 v160, 16, v132
    v_and_b32 v161, 0xffff0000, v132
    v_lshlrev_b32 v162, 16, v133
    v_and_b32 v163, 0xffff0000, v133
    v_lshlrev_b32 v164, 16, v134
    v_and_b32 v165, 0xffff0000, v134
    v_lshlrev_b32 v166, 16, v135
    v_and_b32 v167, 0xffff0000, v135
    v_pk_fma_f32 v[160:161], v[160:161], v[152:153], v[144:145]
    v_pk_fma_f32 v[162:163], v[162:163], v[154:155], v[146:147]
    v_pk_fma_f32 v[164:165], v[164:165], v[156:157], v[148:149]
    v_pk_fma_f32 v[166:167], v[166:167], v[158:159], v[150:151]
    ds_read_b128 v[144:147], v170 offset:384
    ds_read_b128 v[152:155], v170 offset:4480
    ds_read_b128 v[148:151], v170 offset:416
    ds_read_b128 v[156:159], v170 offset:4512
    s_add_u32 s14, s41, 262144
    buffer_load_dwordx4 v[32:35], v11, s[32:35], s14 offen offset:0
    buffer_load_dwordx4 v[36:39], v11, s[32:35], s14 offen offset:2048
    v_cvt_pk_bf16_f32 v132, v160, v161
    v_cvt_pk_bf16_f32 v133, v162, v163
    v_cvt_pk_bf16_f32 v134, v164, v165
    v_cvt_pk_bf16_f32 v135, v166, v167
    s_waitcnt vmcnt(15) lgkmcnt(4)
    v_lshlrev_b32 v160, 16, v136
    v_and_b32 v161, 0xffff0000, v136
    v_lshlrev_b32 v162, 16, v137
    v_and_b32 v163, 0xffff0000, v137
    v_lshlrev_b32 v164, 16, v138
    v_and_b32 v165, 0xffff0000, v138
    v_lshlrev_b32 v166, 16, v139
    v_and_b32 v167, 0xffff0000, v139
    v_pk_fma_f32 v[160:161], v[160:161], v[248:249], v[240:241]
    v_pk_fma_f32 v[162:163], v[162:163], v[250:251], v[242:243]
    v_pk_fma_f32 v[164:165], v[164:165], v[252:253], v[244:245]
    v_pk_fma_f32 v[166:167], v[166:167], v[254:255], v[246:247]
    s_add_u32 s14, s41, 266240
    buffer_load_dwordx4 v[40:43], v11, s[32:35], s14 offen offset:0
    buffer_load_dwordx4 v[44:47], v11, s[32:35], s14 offen offset:2048
    v_cvt_pk_bf16_f32 v136, v160, v161
    v_cvt_pk_bf16_f32 v137, v162, v163
    v_cvt_pk_bf16_f32 v138, v164, v165
    v_cvt_pk_bf16_f32 v139, v166, v167
    s_waitcnt vmcnt(16) lgkmcnt(0)
    v_lshlrev_b32 v160, 16, v140
    v_and_b32 v161, 0xffff0000, v140
    v_lshlrev_b32 v162, 16, v141
    v_and_b32 v163, 0xffff0000, v141
    v_lshlrev_b32 v164, 16, v142
    v_and_b32 v165, 0xffff0000, v142
    v_lshlrev_b32 v166, 16, v143
    v_and_b32 v167, 0xffff0000, v143
    v_pk_fma_f32 v[160:161], v[160:161], v[152:153], v[144:145]
    v_pk_fma_f32 v[162:163], v[162:163], v[154:155], v[146:147]
    v_pk_fma_f32 v[164:165], v[164:165], v[156:157], v[148:149]
    v_pk_fma_f32 v[166:167], v[166:167], v[158:159], v[150:151]
    buffer_load_dwordx4 v[80:83], v4, s[20:23], s40 offen offset:0
    buffer_load_dwordx4 v[84:87], v4, s[20:23], s40 offen offset:1024
    v_cvt_pk_bf16_f32 v140, v160, v161
    v_cvt_pk_bf16_f32 v141, v162, v163
    v_cvt_pk_bf16_f32 v142, v164, v165
    v_cvt_pk_bf16_f32 v143, v166, v167
    s_lshl_b32 s46, s18, 12
    s_add_u32 s46, s46, 9437184
    s_cmp_eq_u32 s38, 0
    s_cbranch_scc0 L_ka_attn_kernel_v_1
    s_waitcnt vmcnt(16)
    v_mfma_f32_16x16x32_bf16 v[160:163], v[176:179], v[128:131], 0
    v_mfma_f32_16x16x32_bf16 v[164:167], v[180:183], v[128:131], 0
    s_waitcnt vmcnt(14)
    v_mfma_f32_16x16x32_bf16 v[160:163], v[184:187], v[132:135], v[160:163]
    v_mfma_f32_16x16x32_bf16 v[164:167], v[188:191], v[132:135], v[164:167]
    s_waitcnt vmcnt(12)
    v_mfma_f32_16x16x32_bf16 v[160:163], v[192:195], v[136:139], v[160:163]
    v_mfma_f32_16x16x32_bf16 v[164:167], v[196:199], v[136:139], v[164:167]
    s_waitcnt vmcnt(10)
    v_mfma_f32_16x16x32_bf16 v[160:163], v[200:203], v[140:143], v[160:163]
    v_mfma_f32_16x16x32_bf16 v[164:167], v[204:207], v[140:143], v[164:167]
    s_lshl_b32 s16, s19, 8
    s_add_u32 s46, s46, s16
    s_add_u32 s47, s46, 1024
    s_mov_b32 s45, 0x3e8293ee
    s_branch L_ka_attn_kernel_join_2
L_ka_attn_kernel_v_1:
    s_waitcnt vmcnt(16)
    v_mfma_f32_16x16x32_bf16 v[160:163], v[128:131], v[176:179], 0
    v_mfma_f32_16x16x32_bf16 v[164:167], v[128:131], v[180:183], 0
    s_waitcnt vmcnt(14)
    v_mfma_f32_16x16x32_bf16 v[160:163], v[132:135], v[184:187], v[160:163]
    v_mfma_f32_16x16x32_bf16 v[164:167], v[132:135], v[188:191], v[164:167]
    s_waitcnt vmcnt(12)
    v_mfma_f32_16x16x32_bf16 v[160:163], v[136:139], v[192:195], v[160:163]
    v_mfma_f32_16x16x32_bf16 v[164:167], v[136:139], v[196:199], v[164:167]
    s_waitcnt vmcnt(10)
    v_mfma_f32_16x16x32_bf16 v[160:163], v[140:143], v[200:203], v[160:163]
    v_mfma_f32_16x16x32_bf16 v[164:167], v[140:143], v[204:207], v[164:167]
    s_lshl_b32 s16, s19, 10
    s_add_u32 s46, s46, s16
    s_add_u32 s46, s46, 2048
    s_add_u32 s47, s46, 256
    s_mov_b32 s45, 1.0
L_ka_attn_kernel_join_2:
    s_nop 3
    ds_write_b128 v172, v[160:163]
    ds_write_b128 v172, v[164:167] offset:1024
    buffer_load_dwordx4 v[88:91], v4, s[20:23], s40 offen offset:2048
    buffer_load_dwordx4 v[92:95], v4, s[20:23], s40 offen offset:3072
    s_waitcnt lgkmcnt(0)
    s_barrier
    ds_read_b128 v[208:211], v171 offset:4096
    ds_read_b128 v[212:215], v171 offset:0
    ds_read_b128 v[216:219], v171 offset:4608
    ds_read_b128 v[220:223], v171 offset:512
    ds_read_b128 v[224:227], v171 offset:5120
    ds_read_b128 v[228:231], v171 offset:1024
    ds_read_b128 v[232:235], v171 offset:5632
    ds_read_b128 v[236:239], v171 offset:1536
    s_add_u32 s40, s40, 4096
    buffer_load_dwordx4 v[96:99], v4, s[20:23], s40 offen offset:0
    buffer_load_dwordx4 v[100:103], v4, s[20:23], s40 offen offset:1024
    s_cmp_lg_u32 s8, 0
    s_cbranch_scc1 L_ka_attn_kernel_b_3
    ds_read_b128 v[128:131], v172 offset:0
    ds_read_b128 v[132:135], v172 offset:2048
    ds_read_b128 v[136:139], v172 offset:4096
    ds_read_b128 v[140:143], v172 offset:6144
    ds_read_b128 v[144:147], v172 offset:8192
    ds_read_b128 v[148:151], v172 offset:10240
    ds_read_b128 v[152:155], v172 offset:12288
    ds_read_b128 v[156:159], v172 offset:14336
    s_waitcnt lgkmcnt(0)
    ds_read_b128 v[176:179], v172 offset:1024
    ds_read_b128 v[180:183], v172 offset:3072
    ds_read_b128 v[184:187], v172 offset:5120
    ds_read_b128 v[188:191], v172 offset:7168
    ds_read_b128 v[192:195], v172 offset:9216
    ds_read_b128 v[196:199], v172 offset:11264
    ds_read_b128 v[200:203], v172 offset:13312
    ds_read_b128 v[204:207], v172 offset:15360
    v_pk_add_f32 v[128:129], v[128:129], v[144:145]
    v_pk_add_f32 v[130:131], v[130:131], v[146:147]
    v_pk_add_f32 v[132:133], v[132:133], v[148:149]
    v_pk_add_f32 v[134:135], v[134:135], v[150:151]
    v_pk_add_f32 v[136:137], v[136:137], v[152:153]
    v_pk_add_f32 v[138:139], v[138:139], v[154:155]
    v_pk_add_f32 v[140:141], v[140:141], v[156:157]
    v_pk_add_f32 v[142:143], v[142:143], v[158:159]
    v_pk_add_f32 v[128:129], v[128:129], v[136:137]
    v_pk_add_f32 v[130:131], v[130:131], v[138:139]
    v_pk_add_f32 v[132:133], v[132:133], v[140:141]
    v_pk_add_f32 v[134:135], v[134:135], v[142:143]
    v_pk_add_f32 v[128:129], v[128:129], v[132:133]
    v_pk_add_f32 v[130:131], v[130:131], v[134:135]
    v_mul_f32 v128, s45, v128
    v_mul_f32 v129, s45, v129
    v_mul_f32 v130, s45, v130
    v_mul_f32 v131, s45, v131
    v_cvt_pk_bf16_f32 v128, v128, v129
    v_cvt_pk_bf16_f32 v129, v130, v131
    buffer_store_dwordx2 v[128:129], v14, s[20:23], s46 offen sc1
    s_waitcnt lgkmcnt(0)
    v_pk_add_f32 v[176:177], v[176:177], v[192:193]
    v_pk_add_f32 v[178:179], v[178:179], v[194:195]
    v_pk_add_f32 v[180:181], v[180:181], v[196:197]
    v_pk_add_f32 v[182:183], v[182:183], v[198:199]
    v_pk_add_f32 v[184:185], v[184:185], v[200:201]
    v_pk_add_f32 v[186:187], v[186:187], v[202:203]
    v_pk_add_f32 v[188:189], v[188:189], v[204:205]
    v_pk_add_f32 v[190:191], v[190:191], v[206:207]
    v_pk_add_f32 v[176:177], v[176:177], v[184:185]
    v_pk_add_f32 v[178:179], v[178:179], v[186:187]
    v_pk_add_f32 v[180:181], v[180:181], v[188:189]
    v_pk_add_f32 v[182:183], v[182:183], v[190:191]
    v_pk_add_f32 v[176:177], v[176:177], v[180:181]
    v_pk_add_f32 v[178:179], v[178:179], v[182:183]
    v_mul_f32 v176, s45, v176
    v_mul_f32 v177, s45, v177
    v_mul_f32 v178, s45, v178
    v_mul_f32 v179, s45, v179
    v_cvt_pk_bf16_f32 v176, v176, v177
    v_cvt_pk_bf16_f32 v177, v178, v179
    buffer_store_dwordx2 v[176:177], v14, s[20:23], s47 offen sc1
L_ka_attn_kernel_b_3:
    s_waitcnt vmcnt(13) lgkmcnt(6)
    v_lshlrev_b32 v248, 16, v16
    v_and_b32 v249, 0xffff0000, v16
    v_lshlrev_b32 v250, 16, v17
    v_and_b32 v251, 0xffff0000, v17
    v_lshlrev_b32 v252, 16, v18
    v_and_b32 v253, 0xffff0000, v18
    v_lshlrev_b32 v254, 16, v19
    v_and_b32 v255, 0xffff0000, v19
    v_pk_mul_f32 v[240:241], v[248:249], v[212:213] op_sel_hi:[1,0]
    v_pk_mul_f32 v[248:249], v[248:249], v[208:209] op_sel_hi:[1,0]
    s_add_u32 s14, s41, 524288
    buffer_load_dwordx4 v[48:51], v11, s[32:35], s14 offen offset:0
    v_pk_mul_f32 v[242:243], v[250:251], v[212:213] op_sel_hi:[1,0]
    v_pk_mul_f32 v[250:251], v[250:251], v[208:209] op_sel_hi:[1,0]
    v_pk_mul_f32 v[244:245], v[252:253], v[212:213] op_sel_hi:[1,0]
    v_pk_mul_f32 v[252:253], v[252:253], v[208:209] op_sel_hi:[1,0]
    v_pk_mul_f32 v[246:247], v[254:255], v[212:213] op_sel_hi:[1,0]
    v_pk_mul_f32 v[254:255], v[254:255], v[208:209] op_sel_hi:[1,0]
    v_cvt_pk_bf16_f32 v16, v248, v249
    v_cvt_pk_bf16_f32 v17, v250, v251
    v_cvt_pk_bf16_f32 v18, v252, v253
    v_cvt_pk_bf16_f32 v19, v254, v255
    buffer_load_dwordx4 v[52:55], v11, s[32:35], s14 offen offset:2048
    ds_write_b128 v2, v[16:19] offset:0
    s_waitcnt vmcnt(14)
    v_lshlrev_b32 v248, 16, v20
    v_and_b32 v249, 0xffff0000, v20
    v_lshlrev_b32 v250, 16, v21
    v_and_b32 v251, 0xffff0000, v21
    v_lshlrev_b32 v252, 16, v22
    v_and_b32 v253, 0xffff0000, v22
    v_lshlrev_b32 v254, 16, v23
    v_and_b32 v255, 0xffff0000, v23
    s_add_u32 s14, s41, 528384
    buffer_load_dwordx4 v[56:59], v11, s[32:35], s14 offen offset:0
    v_pk_fma_f32 v[240:241], v[248:249], v[212:213], v[240:241] op_sel:[0,1,0] op_sel_hi:[1,1,1]
    v_pk_mul_f32 v[248:249], v[248:249], v[208:209] op_sel:[0,1] op_sel_hi:[1,1]
    v_pk_fma_f32 v[242:243], v[250:251], v[212:213], v[242:243] op_sel:[0,1,0] op_sel_hi:[1,1,1]
    v_pk_mul_f32 v[250:251], v[250:251], v[208:209] op_sel:[0,1] op_sel_hi:[1,1]
    v_pk_fma_f32 v[244:245], v[252:253], v[212:213], v[244:245] op_sel:[0,1,0] op_sel_hi:[1,1,1]
    v_pk_mul_f32 v[252:253], v[252:253], v[208:209] op_sel:[0,1] op_sel_hi:[1,1]
    v_pk_fma_f32 v[246:247], v[254:255], v[212:213], v[246:247] op_sel:[0,1,0] op_sel_hi:[1,1,1]
    v_pk_mul_f32 v[254:255], v[254:255], v[208:209] op_sel:[0,1] op_sel_hi:[1,1]
    v_cvt_pk_bf16_f32 v20, v248, v249
    v_cvt_pk_bf16_f32 v21, v250, v251
    buffer_load_dwordx4 v[60:63], v11, s[32:35], s14 offen offset:2048
    v_cvt_pk_bf16_f32 v22, v252, v253
    v_cvt_pk_bf16_f32 v23, v254, v255
    ds_write_b128 v2, v[20:23] offset:128
    s_waitcnt vmcnt(15)
    v_lshlrev_b32 v248, 16, v24
    v_and_b32 v249, 0xffff0000, v24
    v_lshlrev_b32 v250, 16, v25
    v_and_b32 v251, 0xffff0000, v25
    v_lshlrev_b32 v252, 16, v26
    v_and_b32 v253, 0xffff0000, v26
    buffer_load_dwordx4 v[104:107], v4, s[20:23], s40 offen offset:2048
    v_lshlrev_b32 v254, 16, v27
    v_and_b32 v255, 0xffff0000, v27
    v_pk_fma_f32 v[240:241], v[248:249], v[214:215], v[240:241] op_sel_hi:[1,0,1]
    v_pk_mul_f32 v[248:249], v[248:249], v[210:211] op_sel_hi:[1,0]
    v_pk_fma_f32 v[242:243], v[250:251], v[214:215], v[242:243] op_sel_hi:[1,0,1]
    v_pk_mul_f32 v[250:251], v[250:251], v[210:211] op_sel_hi:[1,0]
    v_pk_fma_f32 v[244:245], v[252:253], v[214:215], v[244:245] op_sel_hi:[1,0,1]
    v_pk_mul_f32 v[252:253], v[252:253], v[210:211] op_sel_hi:[1,0]
    v_pk_fma_f32 v[246:247], v[254:255], v[214:215], v[246:247] op_sel_hi:[1,0,1]
    v_pk_mul_f32 v[254:255], v[254:255], v[210:211] op_sel_hi:[1,0]
    buffer_load_dwordx4 v[108:111], v4, s[20:23], s40 offen offset:3072
    v_cvt_pk_bf16_f32 v24, v248, v249
    v_cvt_pk_bf16_f32 v25, v250, v251
    v_cvt_pk_bf16_f32 v26, v252, v253
    v_cvt_pk_bf16_f32 v27, v254, v255
    ds_write_b128 v3, v[24:27] offset:256
    s_waitcnt vmcnt(16)
    v_lshlrev_b32 v248, 16, v28
    v_and_b32 v249, 0xffff0000, v28
    v_lshlrev_b32 v250, 16, v29
    v_and_b32 v251, 0xffff0000, v29
    s_add_u32 s40, s40, 4096
    buffer_load_dwordx4 v[112:115], v4, s[20:23], s40 offen offset:0
    v_lshlrev_b32 v252, 16, v30
    v_and_b32 v253, 0xffff0000, v30
    v_lshlrev_b32 v254, 16, v31
    v_and_b32 v255, 0xffff0000, v31
    v_pk_fma_f32 v[240:241], v[248:249], v[214:215], v[240:241] op_sel:[0,1,0] op_sel_hi:[1,1,1]
    v_pk_mul_f32 v[248:249], v[248:249], v[210:211] op_sel:[0,1] op_sel_hi:[1,1]
    v_pk_fma_f32 v[242:243], v[250:251], v[214:215], v[242:243] op_sel:[0,1,0] op_sel_hi:[1,1,1]
    v_pk_mul_f32 v[250:251], v[250:251], v[210:211] op_sel:[0,1] op_sel_hi:[1,1]
    v_pk_fma_f32 v[244:245], v[252:253], v[214:215], v[244:245] op_sel:[0,1,0] op_sel_hi:[1,1,1]
    v_pk_mul_f32 v[252:253], v[252:253], v[210:211] op_sel:[0,1] op_sel_hi:[1,1]
    buffer_load_dwordx4 v[116:119], v4, s[20:23], s40 offen offset:1024
    v_pk_fma_f32 v[246:247], v[254:255], v[214:215], v[246:247] op_sel:[0,1,0] op_sel_hi:[1,1,1]
    v_pk_mul_f32 v[254:255], v[254:255], v[210:211] op_sel:[0,1] op_sel_hi:[1,1]
    v_cvt_pk_bf16_f32 v28, v248, v249
    v_cvt_pk_bf16_f32 v29, v250, v251
    v_cvt_pk_bf16_f32 v30, v252, v253
    v_cvt_pk_bf16_f32 v31, v254, v255
    ds_write_b128 v3, v[28:31] offset:384
    s_waitcnt lgkmcnt(0)
    s_barrier
    ds_read_b64_tr_b16 v[176:177], v9 offset:0
    ds_read_b64_tr_b16 v[178:179], v9 offset:1024
    ds_read_b64_tr_b16 v[180:181], v10 offset:0
    ds_read_b64_tr_b16 v[182:183], v10 offset:1024
    ds_read_b64_tr_b16 v[184:185], v9 offset:2048
    ds_read_b64_tr_b16 v[186:187], v9 offset:3072
    ds_read_b64_tr_b16 v[188:189], v10 offset:2048
    ds_read_b64_tr_b16 v[190:191], v10 offset:3072
    s_waitcnt vmcnt(13) lgkmcnt(4)
    v_mfma_f32_32x32x16_bf16 v[128:143], v[176:179], v[80:83], 0
    ds_read_b64_tr_b16 v[192:193], v9 offset:4096
    ds_read_b64_tr_b16 v[194:195], v9 offset:5120
    buffer_load_dwordx4 v[120:123], v4, s[20:23], s40 offen offset:2048
    buffer_load_dwordx4 v[124:127], v4, s[20:23], s40 offen offset:3072
    v_lshlrev_b32 v248, 16, v32
    v_and_b32 v249, 0xffff0000, v32
    v_lshlrev_b32 v250, 16, v33
    v_and_b32 v251, 0xffff0000, v33
    v_lshlrev_b32 v252, 16, v34
    v_and_b32 v253, 0xffff0000, v34
    v_lshlrev_b32 v254, 16, v35
    v_and_b32 v255, 0xffff0000, v35
    v_fmac_f32 v240, v248, v220
    v_mul_f32 v248, v248, v216
    v_mfma_f32_32x32x16_bf16 v[144:159], v[180:183], v[80:83], 0
    ds_read_b64_tr_b16 v[196:197], v10 offset:4096
    ds_read_b64_tr_b16 v[198:199], v10 offset:5120
    v_fmac_f32 v241, v249, v220
    v_mul_f32 v249, v249, v216
    v_fmac_f32 v242, v250, v220
    v_mul_f32 v250, v250, v216
    v_fmac_f32 v243, v251, v220
    v_mul_f32 v251, v251, v216
    v_fmac_f32 v244, v252, v220
    v_mul_f32 v252, v252, v216
    v_fmac_f32 v245, v253, v220
    v_mul_f32 v253, v253, v216
    s_waitcnt vmcnt(14) lgkmcnt(4)
    v_mfma_f32_32x32x16_bf16 v[128:143], v[184:187], v[84:87], v[128:143]
    ds_read_b64_tr_b16 v[200:201], v9 offset:6144
    ds_read_b64_tr_b16 v[202:203], v9 offset:7168
    s_add_u32 s14, s41, 786432
    buffer_load_dwordx4 v[64:67], v11, s[32:35], s14 offen offset:0
    buffer_load_dwordx4 v[68:71], v11, s[32:35], s14 offen offset:2048
    v_fmac_f32 v246, v254, v220
    v_mul_f32 v254, v254, v216
    v_fmac_f32 v247, v255, v220
    v_mul_f32 v255, v255, v216
    v_cvt_pk_bf16_f32 v32, v248, v249
    v_cvt_pk_bf16_f32 v33, v250, v251
    v_cvt_pk_bf16_f32 v34, v252, v253
    v_cvt_pk_bf16_f32 v35, v254, v255
    ds_write_b128 v2, v[32:35] offset:16384
    v_mfma_f32_32x32x16_bf16 v[144:159], v[188:191], v[84:87], v[144:159]
    ds_read_b64_tr_b16 v[204:205], v10 offset:6144
    ds_read_b64_tr_b16 v[206:207], v10 offset:7168
    v_lshlrev_b32 v248, 16, v36
    v_and_b32 v249, 0xffff0000, v36
    v_lshlrev_b32 v250, 16, v37
    v_and_b32 v251, 0xffff0000, v37
    v_lshlrev_b32 v252, 16, v38
    v_and_b32 v253, 0xffff0000, v38
    v_lshlrev_b32 v254, 16, v39
    v_and_b32 v255, 0xffff0000, v39
    v_fmac_f32 v240, v248, v221
    v_mul_f32 v248, v248, v217
    s_waitcnt vmcnt(15) lgkmcnt(5)
    v_mfma_f32_32x32x16_bf16 v[128:143], v[192:195], v[88:91], v[128:143]
    ds_read_b64_tr_b16 v[176:177], v9 offset:8192
    ds_read_b64_tr_b16 v[178:179], v9 offset:9216
    s_add_u32 s14, s41, 790528
    buffer_load_dwordx4 v[72:75], v11, s[32:35], s14 offen offset:0
    buffer_load_dwordx4 v[76:79], v11, s[32:35], s14 offen offset:2048
    v_fmac_f32 v241, v249, v221
    v_mul_f32 v249, v249, v217
    v_fmac_f32 v242, v250, v221
    v_mul_f32 v250, v250, v217
    v_fmac_f32 v243, v251, v221
    v_mul_f32 v251, v251, v217
    v_fmac_f32 v244, v252, v221
    v_mul_f32 v252, v252, v217
    v_fmac_f32 v245, v253, v221
    v_mul_f32 v253, v253, v217
    v_mfma_f32_32x32x16_bf16 v[144:159], v[196:199], v[88:91], v[144:159]
    ds_read_b64_tr_b16 v[180:181], v10 offset:8192
    ds_read_b64_tr_b16 v[182:183], v10 offset:9216
    v_fmac_f32 v246, v254, v221
    v_mul_f32 v254, v254, v217
    v_fmac_f32 v247, v255, v221
    v_mul_f32 v255, v255, v217
    v_cvt_pk_bf16_f32 v36, v248, v249
    v_cvt_pk_bf16_f32 v37, v250, v251
    v_cvt_pk_bf16_f32 v38, v252, v253
    v_cvt_pk_bf16_f32 v39, v254, v255
    ds_write_b128 v2, v[36:39] offset:16512
    s_waitcnt vmcnt(16) lgkmcnt(5)
    v_mfma_f32_32x32x16_bf16 v[128:143], v[200:203], v[92:95], v[128:143]
    ds_read_b64_tr_b16 v[184:185], v9 offset:10240
    ds_read_b64_tr_b16 v[186:187], v9 offset:11264
    s_add_u32 s40, s40, 4096
    buffer_load_dwordx4 v[160:163], v4, s[20:23], s40 offen offset:0
    buffer_load_dwordx4 v[164:167], v4, s[20:23], s40 offen offset:1024
    v_lshlrev_b32 v248, 16, v40
    v_and_b32 v249, 0xffff0000, v40
    v_lshlrev_b32 v250, 16, v41
    v_and_b32 v251, 0xffff0000, v41
    v_lshlrev_b32 v252, 16, v42
    v_and_b32 v253, 0xffff0000, v42
    v_lshlrev_b32 v254, 16, v43
    v_and_b32 v255, 0xffff0000, v43
    v_fmac_f32 v240, v248, v222
    v_mul_f32 v248, v248, v218
    v_mfma_f32_32x32x16_bf16 v[144:159], v[204:207], v[92:95], v[144:159]
    ds_read_b64_tr_b16 v[188:189], v10 offset:10240
    ds_read_b64_tr_b16 v[190:191], v10 offset:11264
    v_fmac_f32 v241, v249, v222
    v_mul_f32 v249, v249, v218
    v_fmac_f32 v242, v250, v222
    v_mul_f32 v250, v250, v218
    v_fmac_f32 v243, v251, v222
    v_mul_f32 v251, v251, v218
    v_fmac_f32 v244, v252, v222
    v_mul_f32 v252, v252, v218
    v_fmac_f32 v245, v253, v222
    v_mul_f32 v253, v253, v218
    s_waitcnt vmcnt(17) lgkmcnt(5)
    v_mfma_f32_32x32x16_bf16 v[128:143], v[176:179], v[96:99], v[128:143]
    ds_read_b64_tr_b16 v[192:193], v9 offset:12288
    ds_read_b64_tr_b16 v[194:195], v9 offset:13312
    buffer_load_dwordx4 v[168:171], v4, s[20:23], s40 offen offset:2048
    buffer_load_dwordx4 v[172:175], v4, s[20:23], s40 offen offset:3072
    v_fmac_f32 v246, v254, v222
    v_mul_f32 v254, v254, v218
    v_fmac_f32 v247, v255, v222
    v_mul_f32 v255, v255, v218
    v_cvt_pk_bf16_f32 v40, v248, v249
    v_cvt_pk_bf16_f32 v41, v250, v251
    v_cvt_pk_bf16_f32 v42, v252, v253
    v_cvt_pk_bf16_f32 v43, v254, v255
    ds_write_b128 v3, v[40:43] offset:16640
    v_mfma_f32_32x32x16_bf16 v[144:159], v[180:183], v[96:99], v[144:159]
    ds_read_b64_tr_b16 v[196:197], v10 offset:12288
    ds_read_b64_tr_b16 v[198:199], v10 offset:13312
    v_lshlrev_b32 v248, 16, v44
    v_and_b32 v249, 0xffff0000, v44
    v_lshlrev_b32 v250, 16, v45
    v_and_b32 v251, 0xffff0000, v45
    v_lshlrev_b32 v252, 16, v46
    v_and_b32 v253, 0xffff0000, v46
    v_lshlrev_b32 v254, 16, v47
    v_and_b32 v255, 0xffff0000, v47
    v_fmac_f32 v240, v248, v223
    v_mul_f32 v248, v248, v219
    s_waitcnt vmcnt(18) lgkmcnt(5)
    v_mfma_f32_32x32x16_bf16 v[128:143], v[184:187], v[100:103], v[128:143]
    ds_read_b64_tr_b16 v[200:201], v9 offset:14336
    ds_read_b64_tr_b16 v[202:203], v9 offset:15360
    s_add_u32 s40, s40, 4096
    buffer_load_dwordx4 v[80:83], v4, s[20:23], s40 offen offset:0
    v_fmac_f32 v241, v249, v223
    v_mul_f32 v249, v249, v219
    v_fmac_f32 v242, v250, v223
    v_mul_f32 v250, v250, v219
    v_fmac_f32 v243, v251, v223
    v_mul_f32 v251, v251, v219
    v_fmac_f32 v244, v252, v223
    v_mul_f32 v252, v252, v219
    v_fmac_f32 v245, v253, v223
    v_mul_f32 v253, v253, v219
    v_mfma_f32_32x32x16_bf16 v[144:159], v[188:191], v[100:103], v[144:159]
    ds_read_b64_tr_b16 v[204:205], v10 offset:14336
    ds_read_b64_tr_b16 v[206:207], v10 offset:15360
    v_fmac_f32 v246, v254, v223
    v_mul_f32 v254, v254, v219
    v_fmac_f32 v247, v255, v223
    v_mul_f32 v255, v255, v219
    v_cvt_pk_bf16_f32 v44, v248, v249
    v_cvt_pk_bf16_f32 v45, v250, v251
    v_cvt_pk_bf16_f32 v46, v252, v253
    v_cvt_pk_bf16_f32 v47, v254, v255
    ds_write_b128 v3, v[44:47] offset:16768
    s_waitcnt lgkmcnt(0)
    s_barrier
    s_waitcnt vmcnt(14)
    v_mfma_f32_32x32x16_bf16 v[128:143], v[192:195], v[104:107], v[128:143]
    ds_read_b64_tr_b16 v[176:177], v9 offset:16384
    ds_read_b64_tr_b16 v[178:179], v9 offset:17408
    buffer_load_dwordx4 v[84:87], v4, s[20:23], s40 offen offset:1024
    v_mfma_f32_32x32x16_bf16 v[144:159], v[196:199], v[104:107], v[144:159]
    ds_read_b64_tr_b16 v[180:181], v10 offset:16384
    ds_read_b64_tr_b16 v[182:183], v10 offset:17408
    s_waitcnt vmcnt(14)
    v_mfma_f32_32x32x16_bf16 v[128:143], v[200:203], v[108:111], v[128:143]
    ds_read_b64_tr_b16 v[184:185], v9 offset:18432
    ds_read_b64_tr_b16 v[186:187], v9 offset:19456
    buffer_load_dwordx4 v[88:91], v4, s[20:23], s40 offen offset:2048
    v_mfma_f32_32x32x16_bf16 v[144:159], v[204:207], v[108:111], v[144:159]
    ds_read_b64_tr_b16 v[188:189], v10 offset:18432
    ds_read_b64_tr_b16 v[190:191], v10 offset:19456
    s_waitcnt vmcnt(14) lgkmcnt(4)
    v_mfma_f32_32x32x16_bf16 v[128:143], v[176:179], v[112:115], v[128:143]
    ds_read_b64_tr_b16 v[192:193], v9 offset:20480
    ds_read_b64_tr_b16 v[194:195], v9 offset:21504
    buffer_load_dwordx4 v[92:95], v4, s[20:23], s40 offen offset:3072
    v_lshlrev_b32 v248, 16, v48
    v_and_b32 v249, 0xffff0000, v48
    v_lshlrev_b32 v250, 16, v49
    v_and_b32 v251, 0xffff0000, v49
    v_lshlrev_b32 v252, 16, v50
    v_and_b32 v253, 0xffff0000, v50
    v_lshlrev_b32 v254, 16, v51
    v_and_b32 v255, 0xffff0000, v51
    v_fmac_f32 v240, v248, v228
    v_mul_f32 v248, v248, v224
    v_mfma_f32_32x32x16_bf16 v[144:159], v[180:183], v[112:115], v[144:159]
    ds_read_b64_tr_b16 v[196:197], v10 offset:20480
    ds_read_b64_tr_b16 v[198:199], v10 offset:21504
    v_fmac_f32 v241, v249, v228
    v_mul_f32 v249, v249, v224
    v_fmac_f32 v242, v250, v228
    v_mul_f32 v250, v250, v224
    v_fmac_f32 v243, v251, v228
    v_mul_f32 v251, v251, v224
    v_fmac_f32 v244, v252, v228
    v_mul_f32 v252, v252, v224
    v_fmac_f32 v245, v253, v228
    v_mul_f32 v253, v253, v224
    s_cmp_lg_u32 s8, 0
    s_cbranch_scc1 L_ka_attn_kernel_g_4
    v_and_b32 v12, 7, v1
    v_lshlrev_b32 v12, 10, v12
    v_mov_b32 v13, 0
    s_lshl_b32 s18, s2, 2
    s_add_u32 s18, s18, 204800
    s_waitcnt vmcnt(22)
    buffer_store_dword v13, v12, s[20:23], s18 offen sc0 sc1
L_ka_attn_kernel_g_4:
    s_waitcnt vmcnt(14) lgkmcnt(4)
    v_mfma_f32_32x32x16_bf16 v[128:143], v[184:187], v[116:119], v[128:143]
    ds_read_b64_tr_b16 v[200:201], v9 offset:22528
    ds_read_b64_tr_b16 v[202:203], v9 offset:23552
    s_add_u32 s40, s40, 4096
    buffer_load_dwordx4 v[96:99], v4, s[20:23], s40 offen offset:0
    v_fmac_f32 v246, v254, v228
    v_mul_f32 v254, v254, v224
    v_fmac_f32 v247, v255, v228
    v_mul_f32 v255, v255, v224
    v_cvt_pk_bf16_f32 v48, v248, v249
    v_cvt_pk_bf16_f32 v49, v250, v251
    v_cvt_pk_bf16_f32 v50, v252, v253
    v_cvt_pk_bf16_f32 v51, v254, v255
    ds_write_b128 v2, v[48:51] offset:32768
    v_mfma_f32_32x32x16_bf16 v[144:159], v[188:191], v[116:119], v[144:159]
    ds_read_b64_tr_b16 v[204:205], v10 offset:22528
    ds_read_b64_tr_b16 v[206:207], v10 offset:23552
    v_lshlrev_b32 v248, 16, v52
    v_and_b32 v249, 0xffff0000, v52
    v_lshlrev_b32 v250, 16, v53
    v_and_b32 v251, 0xffff0000, v53
    v_lshlrev_b32 v252, 16, v54
    v_and_b32 v253, 0xffff0000, v54
    v_lshlrev_b32 v254, 16, v55
    v_and_b32 v255, 0xffff0000, v55
    v_fmac_f32 v240, v248, v229
    v_mul_f32 v248, v248, v225
    s_waitcnt vmcnt(14) lgkmcnt(5)
    v_mfma_f32_32x32x16_bf16 v[128:143], v[192:195], v[120:123], v[128:143]
    ds_read_b64_tr_b16 v[176:177], v9 offset:24576
    ds_read_b64_tr_b16 v[178:179], v9 offset:25600
    buffer_load_dwordx4 v[100:103], v4, s[20:23], s40 offen offset:1024
    v_fmac_f32 v241, v249, v229
    v_mul_f32 v249, v249, v225
    v_fmac_f32 v242, v250, v229
    v_mul_f32 v250, v250, v225
    v_fmac_f32 v243, v251, v229
    v_mul_f32 v251, v251, v225
    v_fmac_f32 v244, v252, v229
    v_mul_f32 v252, v252, v225
    v_fmac_f32 v245, v253, v229
    v_mul_f32 v253, v253, v225
    v_mfma_f32_32x32x16_bf16 v[144:159], v[196:199], v[120:123], v[144:159]
    ds_read_b64_tr_b16 v[180:181], v10 offset:24576
    ds_read_b64_tr_b16 v[182:183], v10 offset:25600
    v_fmac_f32 v246, v254, v229
    v_mul_f32 v254, v254, v225
    v_fmac_f32 v247, v255, v229
    v_mul_f32 v255, v255, v225
    v_cvt_pk_bf16_f32 v52, v248, v249
    v_cvt_pk_bf16_f32 v53, v250, v251
    v_cvt_pk_bf16_f32 v54, v252, v253
    v_cvt_pk_bf16_f32 v55, v254, v255
    ds_write_b128 v2, v[52:55] offset:32896
    s_waitcnt vmcnt(14) lgkmcnt(5)
    v_mfma_f32_32x32x16_bf16 v[128:143], v[200:203], v[124:127], v[128:143]
    ds_read_b64_tr_b16 v[184:185], v9 offset:26624
    ds_read_b64_tr_b16 v[186:187], v9 offset:27648
    buffer_load_dwordx4 v[104:107], v4, s[20:23], s40 offen offset:2048
    v_lshlrev_b32 v248, 16, v56
    v_and_b32 v249, 0xffff0000, v56
    v_lshlrev_b32 v250, 16, v57
    v_and_b32 v251, 0xffff0000, v57
    v_lshlrev_b32 v252, 16, v58
    v_and_b32 v253, 0xffff0000, v58
    v_lshlrev_b32 v254, 16, v59
    v_and_b32 v255, 0xffff0000, v59
    v_fmac_f32 v240, v248, v230
    v_mul_f32 v248, v248, v226
    v_mfma_f32_32x32x16_bf16 v[144:159], v[204:207], v[124:127], v[144:159]
    ds_read_b64_tr_b16 v[188:189], v10 offset:26624
    ds_read_b64_tr_b16 v[190:191], v10 offset:27648
    v_fmac_f32 v241, v249, v230
    v_mul_f32 v249, v249, v226
    v_fmac_f32 v242, v250, v230
    v_mul_f32 v250, v250, v226
    v_fmac_f32 v243, v251, v230
    v_mul_f32 v251, v251, v226
    v_fmac_f32 v244, v252, v230
    v_mul_f32 v252, v252, v226
    v_fmac_f32 v245, v253, v230
    v_mul_f32 v253, v253, v226
    s_waitcnt vmcnt(10) lgkmcnt(5)
    v_mfma_f32_32x32x16_bf16 v[128:143], v[176:179], v[160:163], v[128:143]
    ds_read_b64_tr_b16 v[192:193], v9 offset:28672
    ds_read_b64_tr_b16 v[194:195], v9 offset:29696
    buffer_load_dwordx4 v[108:111], v4, s[20:23], s40 offen offset:3072
    v_fmac_f32 v246, v254, v230
    v_mul_f32 v254, v254, v226
    v_fmac_f32 v247, v255, v230
    v_mul_f32 v255, v255, v226
    v_cvt_pk_bf16_f32 v56, v248, v249
    v_cvt_pk_bf16_f32 v57, v250, v251
    v_cvt_pk_bf16_f32 v58, v252, v253
    v_cvt_pk_bf16_f32 v59, v254, v255
    ds_write_b128 v3, v[56:59] offset:33024
    v_mfma_f32_32x32x16_bf16 v[144:159], v[180:183], v[160:163], v[144:159]
    ds_read_b64_tr_b16 v[196:197], v10 offset:28672
    ds_read_b64_tr_b16 v[198:199], v10 offset:29696
    v_lshlrev_b32 v248, 16, v60
    v_and_b32 v249, 0xffff0000, v60
    v_lshlrev_b32 v250, 16, v61
    v_and_b32 v251, 0xffff0000, v61
    v_lshlrev_b32 v252, 16, v62
    v_and_b32 v253, 0xffff0000, v62
    v_lshlrev_b32 v254, 16, v63
    v_and_b32 v255, 0xffff0000, v63
    v_fmac_f32 v240, v248, v231
    v_mul_f32 v248, v248, v227
    s_waitcnt vmcnt(10) lgkmcnt(5)
    v_mfma_f32_32x32x16_bf16 v[128:143], v[184:187], v[164:167], v[128:143]
    ds_read_b64_tr_b16 v[200:201], v9 offset:30720
    ds_read_b64_tr_b16 v[202:203], v9 offset:31744
    s_add_u32 s40, s40, 4096
    buffer_load_dwordx4 v[112:115], v4, s[20:23], s40 offen offset:0
    v_fmac_f32 v241, v249, v231
    v_mul_f32 v249, v249, v227
    v_fmac_f32 v242, v250, v231
    v_mul_f32 v250, v250, v227
    v_fmac_f32 v243, v251, v231
    v_mul_f32 v251, v251, v227
    v_fmac_f32 v244, v252, v231
    v_mul_f32 v252, v252, v227
    v_fmac_f32 v245, v253, v231
    v_mul_f32 v253, v253, v227
    v_mfma_f32_32x32x16_bf16 v[144:159], v[188:191], v[164:167], v[144:159]
    ds_read_b64_tr_b16 v[204:205], v10 offset:30720
    ds_read_b64_tr_b16 v[206:207], v10 offset:31744
    v_fmac_f32 v246, v254, v231
    v_mul_f32 v254, v254, v227
    v_fmac_f32 v247, v255, v231
    v_mul_f32 v255, v255, v227
    v_cvt_pk_bf16_f32 v60, v248, v249
    v_cvt_pk_bf16_f32 v61, v250, v251
    v_cvt_pk_bf16_f32 v62, v252, v253
    v_cvt_pk_bf16_f32 v63, v254, v255
    ds_write_b128 v3, v[60:63] offset:33152
    s_waitcnt lgkmcnt(0)
    s_barrier
    s_waitcnt vmcnt(10)
    v_mfma_f32_32x32x16_bf16 v[128:143], v[192:195], v[168:171], v[128:143]
    ds_read_b64_tr_b16 v[176:177], v9 offset:32768
    ds_read_b64_tr_b16 v[178:179], v9 offset:33792
    buffer_load_dwordx4 v[116:119], v4, s[20:23], s40 offen offset:1024
    v_mfma_f32_32x32x16_bf16 v[144:159], v[196:199], v[168:171], v[144:159]
    ds_read_b64_tr_b16 v[180:181], v10 offset:32768
    ds_read_b64_tr_b16 v[182:183], v10 offset:33792
    s_waitcnt vmcnt(10)
    v_mfma_f32_32x32x16_bf16 v[128:143], v[200:203], v[172:175], v[128:143]
    ds_read_b64_tr_b16 v[184:185], v9 offset:34816
    ds_read_b64_tr_b16 v[186:187], v9 offset:35840
    buffer_load_dwordx4 v[120:123], v4, s[20:23], s40 offen offset:2048
    v_mfma_f32_32x32x16_bf16 v[144:159], v[204:207], v[172:175], v[144:159]
    ds_read_b64_tr_b16 v[188:189], v10 offset:34816
    ds_read_b64_tr_b16 v[190:191], v10 offset:35840
    s_waitcnt vmcnt(10) lgkmcnt(4)
    v_mfma_f32_32x32x16_bf16 v[128:143], v[176:179], v[80:83], v[128:143]
    ds_read_b64_tr_b16 v[192:193], v9 offset:36864
    ds_read_b64_tr_b16 v[194:195], v9 offset:37888
    buffer_load_dwordx4 v[124:127], v4, s[20:23], s40 offen offset:3072
    v_lshlrev_b32 v248, 16, v64
    v_and_b32 v249, 0xffff0000, v64
    v_lshlrev_b32 v250, 16, v65
    v_and_b32 v251, 0xffff0000, v65
    v_lshlrev_b32 v252, 16, v66
    v_and_b32 v253, 0xffff0000, v66
    v_lshlrev_b32 v254, 16, v67
    v_and_b32 v255, 0xffff0000, v67
    v_fmac_f32 v240, v248, v236
    v_mul_f32 v248, v248, v232
    v_mfma_f32_32x32x16_bf16 v[144:159], v[180:183], v[80:83], v[144:159]
    ds_read_b64_tr_b16 v[196:197], v10 offset:36864
    ds_read_b64_tr_b16 v[198:199], v10 offset:37888
    v_fmac_f32 v241, v249, v236
    v_mul_f32 v249, v249, v232
    v_fmac_f32 v242, v250, v236
    v_mul_f32 v250, v250, v232
    v_fmac_f32 v243, v251, v236
    v_mul_f32 v251, v251, v232
    v_fmac_f32 v244, v252, v236
    v_mul_f32 v252, v252, v232
    v_fmac_f32 v245, v253, v236
    v_mul_f32 v253, v253, v232
    s_waitcnt vmcnt(10) lgkmcnt(4)
    v_mfma_f32_32x32x16_bf16 v[128:143], v[184:187], v[84:87], v[128:143]
    ds_read_b64_tr_b16 v[200:201], v9 offset:38912
    ds_read_b64_tr_b16 v[202:203], v9 offset:39936
    s_add_u32 s40, s40, 4096
    buffer_load_dwordx4 v[160:163], v4, s[20:23], s40 offen offset:0
    v_fmac_f32 v246, v254, v236
    v_mul_f32 v254, v254, v232
    v_fmac_f32 v247, v255, v236
    v_mul_f32 v255, v255, v232
    v_cvt_pk_bf16_f32 v64, v248, v249
    v_cvt_pk_bf16_f32 v65, v250, v251
    v_cvt_pk_bf16_f32 v66, v252, v253
    v_cvt_pk_bf16_f32 v67, v254, v255
    ds_write_b128 v2, v[64:67] offset:49152
    v_mfma_f32_32x32x16_bf16 v[144:159], v[188:191], v[84:87], v[144:159]
    ds_read_b64_tr_b16 v[204:205], v10 offset:38912
    ds_read_b64_tr_b16 v[206:207], v10 offset:39936
    v_lshlrev_b32 v248, 16, v68
    v_and_b32 v249, 0xffff0000, v68
    v_lshlrev_b32 v250, 16, v69
    v_and_b32 v251, 0xffff0000, v69
    v_lshlrev_b32 v252, 16, v70
    v_and_b32 v253, 0xffff0000, v70
    v_lshlrev_b32 v254, 16, v71
    v_and_b32 v255, 0xffff0000, v71
    v_fmac_f32 v240, v248, v237
    v_mul_f32 v248, v248, v233
    s_waitcnt vmcnt(10) lgkmcnt(5)
    v_mfma_f32_32x32x16_bf16 v[128:143], v[192:195], v[88:91], v[128:143]
    ds_read_b64_tr_b16 v[176:177], v9 offset:40960
    ds_read_b64_tr_b16 v[178:179], v9 offset:41984
    buffer_load_dwordx4 v[164:167], v4, s[20:23], s40 offen offset:1024
    v_fmac_f32 v241, v249, v237
    v_mul_f32 v249, v249, v233
    v_fmac_f32 v242, v250, v237
    v_mul_f32 v250, v250, v233
    v_fmac_f32 v243, v251, v237
    v_mul_f32 v251, v251, v233
    v_fmac_f32 v244, v252, v237
    v_mul_f32 v252, v252, v233
    v_fmac_f32 v245, v253, v237
    v_mul_f32 v253, v253, v233
    v_mfma_f32_32x32x16_bf16 v[144:159], v[196:199], v[88:91], v[144:159]
    ds_read_b64_tr_b16 v[180:181], v10 offset:40960
    ds_read_b64_tr_b16 v[182:183], v10 offset:41984
    v_fmac_f32 v246, v254, v237
    v_mul_f32 v254, v254, v233
    v_fmac_f32 v247, v255, v237
    v_mul_f32 v255, v255, v233
    v_cvt_pk_bf16_f32 v68, v248, v249
    v_cvt_pk_bf16_f32 v69, v250, v251
    v_cvt_pk_bf16_f32 v70, v252, v253
    v_cvt_pk_bf16_f32 v71, v254, v255
    ds_write_b128 v2, v[68:71] offset:49280
    s_cmp_lg_u32 s8, 0
    s_cbranch_scc1 L_ka_attn_kernel_g_5
    s_and_b32 s18, s2, 7
    s_lshl_b32 s18, s18, 10
    s_add_u32 s18, s18, 204800
    buffer_load_dwordx4 v[224:227], v4, s[20:23], s18 offen sc0 sc1
L_ka_attn_kernel_g_5:
    s_waitcnt vmcnt(10) lgkmcnt(5)
    v_mfma_f32_32x32x16_bf16 v[128:143], v[200:203], v[92:95], v[128:143]
    ds_read_b64_tr_b16 v[184:185], v9 offset:43008
    ds_read_b64_tr_b16 v[186:187], v9 offset:44032
    buffer_load_dwordx4 v[168:171], v4, s[20:23], s40 offen offset:2048
    v_lshlrev_b32 v248, 16, v72
    v_and_b32 v249, 0xffff0000, v72
    v_lshlrev_b32 v250, 16, v73
    v_and_b32 v251, 0xffff0000, v73
    v_lshlrev_b32 v252, 16, v74
    v_and_b32 v253, 0xffff0000, v74
    v_lshlrev_b32 v254, 16, v75
    v_and_b32 v255, 0xffff0000, v75
    v_fmac_f32 v240, v248, v238
    v_mul_f32 v248, v248, v234
    v_mfma_f32_32x32x16_bf16 v[144:159], v[204:207], v[92:95], v[144:159]
    ds_read_b64_tr_b16 v[188:189], v10 offset:43008
    ds_read_b64_tr_b16 v[190:191], v10 offset:44032
    v_fmac_f32 v241, v249, v238
    v_mul_f32 v249, v249, v234
    v_fmac_f32 v242, v250, v238
    v_mul_f32 v250, v250, v234
    v_fmac_f32 v243, v251, v238
    v_mul_f32 v251, v251, v234
    v_fmac_f32 v244, v252, v238
    v_mul_f32 v252, v252, v234
    v_fmac_f32 v245, v253, v238
    v_mul_f32 v253, v253, v234
    s_waitcnt vmcnt(10) lgkmcnt(5)
    v_mfma_f32_32x32x16_bf16 v[128:143], v[176:179], v[96:99], v[128:143]
    ds_read_b64_tr_b16 v[192:193], v9 offset:45056
    ds_read_b64_tr_b16 v[194:195], v9 offset:46080
    buffer_load_dwordx4 v[172:175], v4, s[20:23], s40 offen offset:3072
    v_fmac_f32 v246, v254, v238
    v_mul_f32 v254, v254, v234
    v_fmac_f32 v247, v255, v238
    v_mul_f32 v255, v255, v234
    v_cvt_pk_bf16_f32 v72, v248, v249
    v_cvt_pk_bf16_f32 v73, v250, v251
    v_cvt_pk_bf16_f32 v74, v252, v253
    v_cvt_pk_bf16_f32 v75, v254, v255
    ds_write_b128 v3, v[72:75] offset:49408
    v_mfma_f32_32x32x16_bf16 v[144:159], v[180:183], v[96:99], v[144:159]
    ds_read_b64_tr_b16 v[196:197], v10 offset:45056
    ds_read_b64_tr_b16 v[198:199], v10 offset:46080
    v_lshlrev_b32 v248, 16, v76
    v_and_b32 v249, 0xffff0000, v76
    v_lshlrev_b32 v250, 16, v77
    v_and_b32 v251, 0xffff0000, v77
    v_lshlrev_b32 v252, 16, v78
    v_and_b32 v253, 0xffff0000, v78
    v_lshlrev_b32 v254, 16, v79
    v_and_b32 v255, 0xffff0000, v79
    v_fmac_f32 v240, v248, v239
    v_mul_f32 v248, v248, v235
    s_waitcnt vmcnt(10) lgkmcnt(5)
    v_mfma_f32_32x32x16_bf16 v[128:143], v[184:187], v[100:103], v[128:143]
    ds_read_b64_tr_b16 v[200:201], v9 offset:47104
    ds_read_b64_tr_b16 v[202:203], v9 offset:48128
    v_fmac_f32 v241, v249, v239
    v_mul_f32 v249, v249, v235
    v_fmac_f32 v242, v250, v239
    v_mul_f32 v250, v250, v235
    v_fmac_f32 v243, v251, v239
    v_mul_f32 v251, v251, v235
    v_fmac_f32 v244, v252, v239
    v_mul_f32 v252, v252, v235
    v_fmac_f32 v245, v253, v239
    v_mul_f32 v253, v253, v235
    v_mfma_f32_32x32x16_bf16 v[144:159], v[188:191], v[100:103], v[144:159]
    ds_read_b64_tr_b16 v[204:205], v10 offset:47104
    ds_read_b64_tr_b16 v[206:207], v10 offset:48128
    v_fmac_f32 v246, v254, v239
    v_mul_f32 v254, v254, v235
    v_fmac_f32 v247, v255, v239
    v_mul_f32 v255, v255, v235
    v_cvt_pk_bf16_f32 v76, v248, v249
    v_cvt_pk_bf16_f32 v77, v250, v251
    v_cvt_pk_bf16_f32 v78, v252, v253
    v_cvt_pk_bf16_f32 v79, v254, v255
    ds_write_b128 v3, v[76:79] offset:49536
    s_waitcnt lgkmcnt(0)
    s_cmp_lg_u32 s8, 0
    s_cbranch_scc1 L_ka_attn_kernel_g_6
    s_waitcnt vmcnt(2)
    v_max3_u32 v224, v224, v225, v226
    v_max_u32 v224, v224, v227
    v_cmp_eq_u32 vcc, -1, v224
    s_cbranch_vccz L_ka_attn_kernel_g_6
    s_mov_b32 s44, 0
L_ka_attn_kernel_poll_7:
    buffer_load_dwordx4 v[224:227], v4, s[20:23], s18 offen sc0 sc1
    s_add_u32 s44, s44, 1
    s_cmp_gt_u32 s44, 4000
    s_cbranch_scc1 L_ka_attn_kernel_got_8
    s_waitcnt vmcnt(0)
    v_max3_u32 v224, v224, v225, v226
    v_max_u32 v224, v224, v227
    v_cmp_eq_u32 vcc, -1, v224
    s_cbranch_vccnz L_ka_attn_kernel_poll_7
L_ka_attn_kernel_got_8:
    s_waitcnt vmcnt(0)
L_ka_attn_kernel_g_6:
    s_barrier
    s_waitcnt vmcnt(9)
    v_mfma_f32_32x32x16_bf16 v[128:143], v[192:195], v[104:107], v[128:143]
    ds_read_b64_tr_b16 v[176:177], v9 offset:49152
    ds_read_b64_tr_b16 v[178:179], v9 offset:50176
    v_permlane32_swap_b32 v240, v244
    v_permlane32_swap_b32 v241, v245
    v_permlane32_swap_b32 v242, v246
    v_mfma_f32_32x32x16_bf16 v[144:159], v[196:199], v[104:107], v[144:159]
    ds_read_b64_tr_b16 v[180:181], v10 offset:49152
    ds_read_b64_tr_b16 v[182:183], v10 offset:50176
    v_permlane32_swap_b32 v243, v247
    v_add_f32 v240, v240, v244
    s_waitcnt vmcnt(8)
    v_mfma_f32_32x32x16_bf16 v[128:143], v[200:203], v[108:111], v[128:143]
    ds_read_b64_tr_b16 v[184:185], v9 offset:51200
    ds_read_b64_tr_b16 v[186:187], v9 offset:52224
    v_add_f32 v241, v241, v245
    v_add_f32 v242, v242, v246
    v_add_f32 v243, v243, v247
    v_mfma_f32_32x32x16_bf16 v[144:159], v[204:207], v[108:111], v[144:159]
    ds_read_b64_tr_b16 v[188:189], v10 offset:51200
    ds_read_b64_tr_b16 v[190:191], v10 offset:52224
    v_and_b32 v12, 7, v1
    v_lshlrev_b32 v12, 5, v12
    v_permlane16_swap_b32 v240, v242
    v_permlane16_swap_b32 v241, v243
    s_mov_b32 s17, 9437184
    buffer_load_dwordx4 v[208:211], v4, s[20:23], s17 offen offset:0
    buffer_load_dwordx4 v[212:215], v4, s[20:23], s17 offen offset:1024
    s_waitcnt vmcnt(9) lgkmcnt(4)
    v_mfma_f32_32x32x16_bf16 v[128:143], v[176:179], v[112:115], v[128:143]
    ds_read_b64_tr_b16 v[192:193], v9 offset:53248
    ds_read_b64_tr_b16 v[194:195], v9 offset:54272
    v_add_f32 v240, v240, v242
    v_add_f32 v241, v241, v243
    v_lshl_add_u32 v12, v15, 4, v12
    v_bfe_u32 v13, v1, 4, 1
    v_lshl_add_u32 v12, v13, 3, v12
    s_lshl_b32 s16, s8, 8
    v_add_u32 v12, s16, v12
    v_mfma_f32_32x32x16_bf16 v[144:159], v[180:183], v[112:115], v[144:159]
    ds_read_b64_tr_b16 v[196:197], v10 offset:53248
    ds_read_b64_tr_b16 v[198:199], v10 offset:54272
    v_add_f32_dpp v240, v240, v240 row_ror:8 row_mask:0xf bank_mask:0xf
    v_add_f32_dpp v241, v241, v241 row_ror:8 row_mask:0xf bank_mask:0xf
    ds_write_b64 v12, v[240:241]
    s_lshl_b32 s46, s9, 17
    s_lshl_b32 s31, s3, 12
    s_add_u32 s46, s46, s31
    s_add_u32 s46, s46, 9437184
    s_lshl_b32 s28, s9, 16
    s_add_u32 s29, s28, 16384
    s_add_u32 s28, s28, 49152
    s_waitcnt vmcnt(8) lgkmcnt(5)
    v_mfma_f32_32x32x16_bf16 v[128:143], v[184:187], v[116:119], v[128:143]
    ds_read_b64_tr_b16 v[200:201], v9 offset:55296
    ds_read_b64_tr_b16 v[202:203], v9 offset:56320
    v_bfe_u32 v14, v1, 1, 1
    v_cmp_eq_u32 vcc, 0, v14
    v_mov_b32 v13, 0x3f803f80
    v_and_b32 v14, 1, v1
    v_cndmask_b32 v216, 0, v13, vcc
    v_cndmask_b32 v217, 0, v13, vcc
    v_mfma_f32_32x32x16_bf16 v[144:159], v[188:191], v[116:119], v[144:159]
    ds_read_b64_tr_b16 v[204:205], v10 offset:55296
    ds_read_b64_tr_b16 v[206:207], v10 offset:56320
    v_cndmask_b32 v218, v13, 0, vcc
    v_cndmask_b32 v219, v13, 0, vcc
    v_cmp_eq_u32 vcc, 0, v14
    v_mov_b32 v14, 0x44444444
    v_mov_b32 v13, 0xeeeeeeee
    s_add_u32 m0, s29, s31
    s_nop 0
    buffer_load_dwordx4 v4, s[20:23], s46 offen offset:0 lds
    buffer_load_dwordx4 v4, s[20:23], s46 offen offset:1024 lds
    buffer_load_dwordx4 v4, s[20:23], s46 offen offset:2048 lds
    buffer_load_dwordx4 v4, s[20:23], s46 offen offset:3072 lds
    s_add_u32 s46, s46, 16384
    s_waitcnt vmcnt(11) lgkmcnt(5)
    v_mfma_f32_32x32x16_bf16 v[128:143], v[192:195], v[120:123], v[128:143]
    ds_read_b64_tr_b16 v[176:177], v9 offset:57344
    ds_read_b64_tr_b16 v[178:179], v9 offset:58368
    v_cndmask_b32 v220, v13, v14, vcc
    s_mov_b32 s45, 0
    s_lshl_b32 s16, s8, 12
    v_add_u32 v11, s16, v4
    v_add_u32 v3, 131072, v11
    v_xor_b32 v2, 0x4000, v3
    v_mfma_f32_32x32x16_bf16 v[144:159], v[196:199], v[120:123], v[144:159]
    ds_read_b64_tr_b16 v[180:181], v10 offset:57344
    ds_read_b64_tr_b16 v[182:183], v10 offset:58368
    s_add_u32 s16, s42, 32768
    v_add_u32 v11, s16, v4
    v_lshlrev_b32 v15, 4, v15
    s_lshl_b32 s16, s9, 7
    v_add_u32 v15, s16, v15
    s_waitcnt vmcnt(10) lgkmcnt(4)
    v_mfma_f32_32x32x16_bf16 v[128:143], v[200:203], v[124:127], v[128:143]
    ds_read_b64_tr_b16 v[184:185], v9 offset:59392
    ds_read_b64_tr_b16 v[186:187], v9 offset:60416
    v_mfma_f32_32x32x16_bf16 v[144:159], v[204:207], v[124:127], v[144:159]
    ds_read_b64_tr_b16 v[188:189], v10 offset:59392
    ds_read_b64_tr_b16 v[190:191], v10 offset:60416
    s_barrier
    s_cmp_lg_u32 s8, 1
    s_cbranch_scc1 L_ka_attn_kernel_bf_9
    v_lshlrev_b32 v12, 2, v1
    ds_read2st64_b32 v[240:241], v12 offset0:0 offset1:1
    ds_read2st64_b32 v[242:243], v12 offset0:2 offset1:3
    ds_read2st64_b32 v[244:245], v12 offset0:4 offset1:5
    ds_read2st64_b32 v[246:247], v12 offset0:6 offset1:7
    s_waitcnt lgkmcnt(0)
    v_pk_add_f32 v[240:241], v[240:241], v[242:243]
    v_pk_add_f32 v[244:245], v[244:245], v[246:247]
    v_pk_add_f32 v[240:241], v[240:241], v[244:245]
    v_add_f32 v240, v240, v241
    ds_write_b32 v12, v240 offset:3072
L_ka_attn_kernel_bf_9:
    s_waitcnt vmcnt(9) lgkmcnt(4)
    v_mfma_f32_32x32x16_bf16 v[128:143], v[176:179], v[160:163], v[128:143]
    ds_read_b64_tr_b16 v[192:193], v9 offset:61440
    ds_read_b64_tr_b16 v[194:195], v9 offset:62464
    v_mfma_f32_32x32x16_bf16 v[144:159], v[180:183], v[160:163], v[144:159]
    ds_read_b64_tr_b16 v[196:197], v10 offset:61440
    ds_read_b64_tr_b16 v[198:199], v10 offset:62464
    s_waitcnt vmcnt(8) lgkmcnt(4)
    v_mfma_f32_32x32x16_bf16 v[128:143], v[184:187], v[164:167], v[128:143]
    ds_read_b64_tr_b16 v[200:201], v9 offset:63488
    ds_read_b64_tr_b16 v[202:203], v9 offset:64512
    v_mfma_f32_32x32x16_bf16 v[144:159], v[188:191], v[164:167], v[144:159]
    ds_read_b64_tr_b16 v[204:205], v10 offset:63488
    ds_read_b64_tr_b16 v[206:207], v10 offset:64512
    s_waitcnt vmcnt(7) lgkmcnt(4)
    v_mfma_f32_32x32x16_bf16 v[128:143], v[192:195], v[168:171], v[128:143]
    v_mfma_f32_32x32x16_bf16 v[144:159], v[196:199], v[168:171], v[144:159]
    s_waitcnt vmcnt(6) lgkmcnt(0)
    v_mfma_f32_32x32x16_bf16 v[128:143], v[200:203], v[172:175], v[128:143]
    v_mfma_f32_32x32x16_bf16 v[144:159], v[204:207], v[172:175], v[144:159]
    s_nop 11
    ds_write_b128 v3, v[144:147] offset:0
    ds_write_b128 v3, v[148:151] offset:1024
    ds_write_b128 v3, v[152:155] offset:2048
    ds_write_b128 v3, v[156:159] offset:3072
    s_waitcnt lgkmcnt(0)
    s_barrier
    ds_read_b128 v[144:147], v2 offset:0
    ds_read_b128 v[148:151], v2 offset:1024
    ds_read_b128 v[152:155], v2 offset:2048
    ds_read_b128 v[156:159], v2 offset:3072
    s_add_u32 m0, s28, s31
    s_nop 0
    buffer_load_dwordx4 v4, s[20:23], s46 offen offset:0 lds
    buffer_load_dwordx4 v4, s[20:23], s46 offen offset:1024 lds
    buffer_load_dwordx4 v4, s[20:23], s46 offen offset:2048 lds
    buffer_load_dwordx4 v4, s[20:23], s46 offen offset:3072 lds
    s_add_u32 s46, s46, 16384
    ds_read_b128 v[96:99], v15 offset:3072
    ds_read_b128 v[100:103], v15 offset:3104
    ds_read_b128 v[104:107], v15 offset:3136
    ds_read_b128 v[108:111], v15 offset:3168
    v_xor_b32 v12, 0x10000, v11
    s_waitcnt lgkmcnt(3)
    v_pk_add_f32 v[128:129], v[128:129], v[144:145]
    v_pk_add_f32 v[130:131], v[130:131], v[146:147]
    v_pk_add_f32 v[128:129], v[128:129], v[96:97]
    v_pk_add_f32 v[130:131], v[130:131], v[98:99]
    v_cvt_pk_bf16_f32 v80, v128, v129
    v_cvt_pk_bf16_f32 v81, v130, v131
    s_waitcnt lgkmcnt(2)
    v_pk_add_f32 v[132:133], v[132:133], v[148:149]
    v_pk_add_f32 v[134:135], v[134:135], v[150:151]
    v_pk_add_f32 v[132:133], v[132:133], v[100:101]
    v_pk_add_f32 v[134:135], v[134:135], v[102:103]
    v_cvt_pk_bf16_f32 v82, v132, v133
    v_cvt_pk_bf16_f32 v83, v134, v135
    s_waitcnt lgkmcnt(1)
    v_pk_add_f32 v[136:137], v[136:137], v[152:153]
    v_pk_add_f32 v[138:139], v[138:139], v[154:155]
    v_pk_add_f32 v[136:137], v[136:137], v[104:105]
    v_pk_add_f32 v[138:139], v[138:139], v[106:107]
    v_cvt_pk_bf16_f32 v84, v136, v137
    v_cvt_pk_bf16_f32 v85, v138, v139
    s_waitcnt lgkmcnt(0)
    v_pk_add_f32 v[140:141], v[140:141], v[156:157]
    v_pk_add_f32 v[142:143], v[142:143], v[158:159]
    v_pk_add_f32 v[140:141], v[140:141], v[108:109]
    v_pk_add_f32 v[142:143], v[142:143], v[110:111]
    v_cvt_pk_bf16_f32 v86, v140, v141
    v_cvt_pk_bf16_f32 v87, v142, v143
    ds_write_b128 v11, v[80:83] offset:0
    ds_write_b128 v11, v[84:87] offset:1024
    s_waitcnt vmcnt(8)
    v_mfma_f32_32x32x16_bf16 v[144:159], v[208:211], v[80:83], 0
    v_mfma_f32_32x32x16_bf16 v[144:159], v[212:215], v[84:87], v[144:159]
    s_nop 11
    v_max3_f32 v14, v144, v145, v146
    v_max_f32 v14, v14, v159
    v_max3_f32 v14, v14, v147, v148
    v_max3_f32 v14, v14, v149, v150
    v_max3_f32 v14, v14, v151, v152
    v_max3_f32 v14, v14, v153, v154
    v_max3_f32 v14, v14, v155, v156
    v_max3_f32 v14, v14, v157, v158
    v_mov_b32 v15, v14
    s_nop 1
    v_permlane32_swap_b32 v14, v15
    v_max_f32 v14, v14, v15
    v_sub_f32 v14, 0xc2c00000, v14
    ds_write_b32 v11, v14 offset:2048
    v_mov_b32 v96, v14
    v_mov_b32 v97, v14
    v_mov_b64 v[98:99], v[96:97]
    v_mov_b64 v[100:101], v[96:97]
    v_mov_b64 v[102:103], v[96:97]
    v_mov_b64 v[104:105], v[96:97]
    v_mov_b64 v[106:107], v[96:97]
    v_mov_b64 v[108:109], v[96:97]
    v_mov_b64 v[110:111], v[96:97]
    v_mov_b64 v[208:209], 0
    v_mov_b64 v[210:211], 0
    v_mov_b64 v[212:213], 0
    v_mov_b64 v[214:215], 0
    s_waitcnt vmcnt(4)
    s_waitcnt lgkmcnt(0)
    s_barrier
    ds_read_b32 v13, v12 offset:2048
    ds_read_b128 v[88:91], v12 offset:0
    ds_read_b128 v[92:95], v12 offset:1024
    s_waitcnt lgkmcnt(2)
    v_mov_b32 v112, v13
    v_mov_b32 v113, v13
    v_mov_b64 v[114:115], v[112:113]
    v_mov_b64 v[116:117], v[112:113]
    v_mov_b64 v[118:119], v[112:113]
    v_mov_b64 v[120:121], v[112:113]
    v_mov_b64 v[122:123], v[112:113]
    v_mov_b64 v[124:125], v[112:113]
    v_mov_b64 v[126:127], v[112:113]
    s_waitcnt lgkmcnt(0)
L_ka_attn_kernel_main_10:
    v_add_u32 v221, s29, v4
    s_mov_b32 s47, s29
    s_lshl_b32 s29, s9, 14
    s_add_u32 s29, s29, 131072
    s_mov_b32 s30, s42
    ds_read_b128 v[16:19], v221 offset:0
    ds_read_b128 v[20:23], v221 offset:1024
    ds_read_b128 v[32:35], v221 offset:4096
    ds_read_b128 v[36:39], v221 offset:5120
    ds_read_b128 v[24:27], v221 offset:2048
    ds_read_b128 v[28:31], v221 offset:3072
    ds_read_b128 v[40:43], v221 offset:6144
    ds_read_b128 v[44:47], v221 offset:7168
    s_add_u32 m0, s29, s31
    s_nop 0
    buffer_load_dwordx4 v4, s[20:23], s46 offen offset:0 lds
    buffer_load_dwordx4 v4, s[20:23], s46 offen offset:1024 lds
    buffer_load_dwordx4 v4, s[20:23], s46 offen offset:2048 lds
    buffer_load_dwordx4 v4, s[20:23], s46 offen offset:3072 lds
    s_add_u32 s46, s46, 16384
    s_lshl_b32 s38, s36, 10
    s_and_b32 s37, s36, 3
    s_lshr_b32 s16, s36, 3
    s_lshl_b32 s16, s16, 2
    s_add_u32 s37, s37, s16
    s_lshl_b32 s37, s37, 10
    v_add_u32 v254, s38, v4
    s_lshr_b32 s16, s2, 3
    s_lshl_b32 s16, s16, 3
    s_add_u32 s16, s16, s8
    s_and_b32 s17, s2, 1
    s_lshl_b32 s14, s16, 11
    s_lshl_b32 s18, s17, 10
    s_add_u32 s14, s14, s18
    s_add_u32 s14, s14, 384
    s_bfe_u32 s18, s2, 0x20001
    s_lshl_b32 s39, s18, 20
    s_add_u32 s39, s39, s14
    s_lshl_b32 s18, s18, 8
    s_add_u32 s16, s16, s18
    s_mul_i32 s15, s16, 12288
    s_lshl_b32 s17, s17, 12
    s_add_u32 s15, s15, s17
    s_add_u32 s15, s15, 4480
    buffer_load_dwordx4 v[222:225], v4, s[60:63], s38 offen
    buffer_load_dwordx4 v[222:225], v254, s[52:55], 0 offen
    v_add_u32 v254, 0x200000, v254
    s_waitcnt lgkmcnt(6)
    v_mfma_f32_32x32x16_bf16 v[128:143], v[16:19], v[80:83], v[96:111]
    v_mfma_f32_32x32x16_bf16 v[128:143], v[20:23], v[84:87], v[128:143]
    v_mov_b64 v[176:177], 0
    v_mov_b64 v[178:179], 0
    v_mov_b64 v[180:181], 0
    v_mov_b64 v[182:183], 0
    v_mov_b64 v[184:185], 0
    v_mov_b64 v[186:187], 0
    v_mov_b64 v[188:189], 0
    v_mov_b64 v[190:191], 0
    v_mov_b64 v[192:193], 0
    v_mov_b64 v[194:195], 0
    v_mov_b64 v[196:197], 0
    v_mov_b64 v[198:199], 0
    v_mov_b64 v[200:201], 0
    v_mov_b64 v[202:203], 0
    v_mov_b64 v[204:205], 0
    v_mov_b64 v[206:207], 0
    v_mfma_f32_32x32x16_bf16 v[144:159], v[16:19], v[88:91], v[112:127]
    v_exp_f32 v128, v128
    v_exp_f32 v129, v129
    v_exp_f32 v130, v130
    v_mfma_f32_32x32x16_bf16 v[144:159], v[20:23], v[92:95], v[144:159]
    v_exp_f32 v131, v131
    v_cvt_pk_bf16_f32 v160, v128, v129
    v_exp_f32 v132, v132
    v_exp_f32 v133, v133
    v_cvt_pk_bf16_f32 v161, v130, v131
    v_exp_f32 v134, v134
    v_exp_f32 v135, v135
    v_cvt_pk_bf16_f32 v162, v132, v133
    v_exp_f32 v136, v136
    v_exp_f32 v137, v137
    v_cvt_pk_bf16_f32 v163, v134, v135
    v_exp_f32 v138, v138
    v_exp_f32 v139, v139
    v_cvt_pk_bf16_f32 v164, v136, v137
    v_exp_f32 v140, v140
    v_exp_f32 v141, v141
    v_cvt_pk_bf16_f32 v165, v138, v139
    v_exp_f32 v142, v142
    v_exp_f32 v143, v143
    v_cvt_pk_bf16_f32 v166, v140, v141
    v_cvt_pk_bf16_f32 v167, v142, v143
    s_waitcnt vmcnt(6)
    s_mov_b32 s44, 5
.p2align 6
L_ka_attn_kernel_attA_11:
    s_waitcnt lgkmcnt(4)
    s_waitcnt lgkmcnt(2)
    v_mfma_f32_32x32x16_bf16 v[128:143], v[32:35], v[80:83], v[96:111]
    v_exp_f32 v144, v144
    v_exp_f32 v145, v145
    v_exp_f32 v146, v146
    v_mfma_f32_32x32x16_bf16 v[128:143], v[36:39], v[84:87], v[128:143]
    v_exp_f32 v147, v147
    v_cvt_pk_bf16_f32 v168, v144, v145
    v_exp_f32 v148, v148
    v_exp_f32 v149, v149
    v_mfma_f32_32x32x16_bf16 v[176:191], v[24:27], v[160:163], v[176:191]
    v_cvt_pk_bf16_f32 v169, v146, v147
    v_exp_f32 v150, v150
    ds_read_b128 v[48:51], v221 offset:8192
    ds_read_b128 v[52:55], v221 offset:9216
    v_exp_f32 v151, v151
    v_cvt_pk_bf16_f32 v170, v148, v149
    v_exp_f32 v152, v152
    v_mfma_f32_32x32x16_bf16 v[176:191], v[28:31], v[164:167], v[176:191]
    v_exp_f32 v153, v153
    v_cvt_pk_bf16_f32 v171, v150, v151
    v_exp_f32 v154, v154
    v_exp_f32 v155, v155
    v_cvt_pk_bf16_f32 v172, v152, v153
    v_smfmac_f32_16x16x64_bf16 v[208:211], v[216:219], v[160:167], v220
    v_exp_f32 v156, v156
    v_exp_f32 v157, v157
    v_cvt_pk_bf16_f32 v173, v154, v155
    v_exp_f32 v158, v158
    v_exp_f32 v159, v159
    v_cvt_pk_bf16_f32 v174, v156, v157
    v_cvt_pk_bf16_f32 v175, v158, v159
    v_mfma_f32_32x32x16_bf16 v[144:159], v[32:35], v[88:91], v[112:127]
    v_exp_f32 v128, v128
    v_exp_f32 v129, v129
    v_exp_f32 v130, v130
    v_mfma_f32_32x32x16_bf16 v[144:159], v[36:39], v[92:95], v[144:159]
    v_exp_f32 v131, v131
    v_cvt_pk_bf16_f32 v160, v128, v129
    v_exp_f32 v132, v132
    v_exp_f32 v133, v133
    v_mfma_f32_32x32x16_bf16 v[192:207], v[24:27], v[168:171], v[192:207]
    v_cvt_pk_bf16_f32 v161, v130, v131
    v_exp_f32 v134, v134
    ds_read_b128 v[56:59], v221 offset:10240
    ds_read_b128 v[60:63], v221 offset:11264
    v_exp_f32 v135, v135
    v_cvt_pk_bf16_f32 v162, v132, v133
    v_exp_f32 v136, v136
    v_mfma_f32_32x32x16_bf16 v[192:207], v[28:31], v[172:175], v[192:207]
    v_exp_f32 v137, v137
    v_cvt_pk_bf16_f32 v163, v134, v135
    v_exp_f32 v138, v138
    v_exp_f32 v139, v139
    v_cvt_pk_bf16_f32 v164, v136, v137
    v_smfmac_f32_16x16x64_bf16 v[212:215], v[216:219], v[168:175], v220
    v_exp_f32 v140, v140
    v_exp_f32 v141, v141
    v_cvt_pk_bf16_f32 v165, v138, v139
    v_exp_f32 v142, v142
    v_exp_f32 v143, v143
    v_cvt_pk_bf16_f32 v166, v140, v141
    v_cvt_pk_bf16_f32 v167, v142, v143
    s_waitcnt lgkmcnt(4)
    s_waitcnt lgkmcnt(2)
    v_mfma_f32_32x32x16_bf16 v[128:143], v[48:51], v[80:83], v[96:111]
    v_exp_f32 v144, v144
    v_exp_f32 v145, v145
    v_exp_f32 v146, v146
    v_mfma_f32_32x32x16_bf16 v[128:143], v[52:55], v[84:87], v[128:143]
    v_exp_f32 v147, v147
    v_cvt_pk_bf16_f32 v168, v144, v145
    v_exp_f32 v148, v148
    v_exp_f32 v149, v149
    v_mfma_f32_32x32x16_bf16 v[176:191], v[40:43], v[160:163], v[176:191]
    v_cvt_pk_bf16_f32 v169, v146, v147
    v_exp_f32 v150, v150
    ds_read_b128 v[64:67], v221 offset:12288
    ds_read_b128 v[68:71], v221 offset:13312
    v_exp_f32 v151, v151
    v_cvt_pk_bf16_f32 v170, v148, v149
    v_exp_f32 v152, v152
    v_mfma_f32_32x32x16_bf16 v[176:191], v[44:47], v[164:167], v[176:191]
    v_exp_f32 v153, v153
    v_cvt_pk_bf16_f32 v171, v150, v151
    v_exp_f32 v154, v154
    v_exp_f32 v155, v155
    v_cvt_pk_bf16_f32 v172, v152, v153
    v_smfmac_f32_16x16x64_bf16 v[208:211], v[216:219], v[160:167], v220
    v_exp_f32 v156, v156
    v_exp_f32 v157, v157
    v_cvt_pk_bf16_f32 v173, v154, v155
    v_exp_f32 v158, v158
    v_exp_f32 v159, v159
    v_cvt_pk_bf16_f32 v174, v156, v157
    v_cvt_pk_bf16_f32 v175, v158, v159
    v_mfma_f32_32x32x16_bf16 v[144:159], v[48:51], v[88:91], v[112:127]
    v_exp_f32 v128, v128
    v_exp_f32 v129, v129
    v_exp_f32 v130, v130
    v_mfma_f32_32x32x16_bf16 v[144:159], v[52:55], v[92:95], v[144:159]
    v_exp_f32 v131, v131
    v_cvt_pk_bf16_f32 v160, v128, v129
    v_exp_f32 v132, v132
    v_exp_f32 v133, v133
    v_mfma_f32_32x32x16_bf16 v[192:207], v[40:43], v[168:171], v[192:207]
    v_cvt_pk_bf16_f32 v161, v130, v131
    v_exp_f32 v134, v134
    ds_read_b128 v[72:75], v221 offset:14336
    ds_read_b128 v[76:79], v221 offset:15360
    v_exp_f32 v135, v135
    v_cvt_pk_bf16_f32 v162, v132, v133
    v_exp_f32 v136, v136
    v_mfma_f32_32x32x16_bf16 v[192:207], v[44:47], v[172:175], v[192:207]
    v_exp_f32 v137, v137
    v_cvt_pk_bf16_f32 v163, v134, v135
    v_exp_f32 v138, v138
    v_exp_f32 v139, v139
    v_cvt_pk_bf16_f32 v164, v136, v137
    v_smfmac_f32_16x16x64_bf16 v[212:215], v[216:219], v[168:175], v220
    v_exp_f32 v140, v140
    v_exp_f32 v141, v141
    v_cvt_pk_bf16_f32 v165, v138, v139
    v_exp_f32 v142, v142
    v_exp_f32 v143, v143
    v_cvt_pk_bf16_f32 v166, v140, v141
    v_cvt_pk_bf16_f32 v167, v142, v143
    s_waitcnt lgkmcnt(4)
    s_waitcnt lgkmcnt(2)
    v_mfma_f32_32x32x16_bf16 v[128:143], v[64:67], v[80:83], v[96:111]
    v_exp_f32 v144, v144
    v_exp_f32 v145, v145
    v_exp_f32 v146, v146
    v_mfma_f32_32x32x16_bf16 v[128:143], v[68:71], v[84:87], v[128:143]
    v_exp_f32 v147, v147
    v_cvt_pk_bf16_f32 v168, v144, v145
    v_exp_f32 v148, v148
    v_exp_f32 v149, v149
    v_mfma_f32_32x32x16_bf16 v[176:191], v[56:59], v[160:163], v[176:191]
    v_cvt_pk_bf16_f32 v169, v146, v147
    v_exp_f32 v150, v150
    s_waitcnt vmcnt(10)
    s_waitcnt lgkmcnt(0)
    s_barrier
    v_add_u32 v221, s28, v4
    s_add_u32 m0, s47, s31
    s_nop 0
    buffer_load_dwordx4 v4, s[20:23], s46 offen offset:0 lds
    buffer_load_dwordx4 v4, s[20:23], s46 offen offset:1024 lds
    buffer_load_dwordx4 v4, s[20:23], s46 offen offset:2048 lds
    buffer_load_dwordx4 v4, s[20:23], s46 offen offset:3072 lds
    s_add_u32 s46, s46, 16384
    s_mov_b32 s16, s47
    s_mov_b32 s47, s28
    s_mov_b32 s28, s29
    s_mov_b32 s29, s16
    ds_read_b128 v[16:19], v221 offset:0
    ds_read_b128 v[20:23], v221 offset:1024
    v_exp_f32 v151, v151
    v_cvt_pk_bf16_f32 v170, v148, v149
    v_exp_f32 v152, v152
    v_mfma_f32_32x32x16_bf16 v[176:191], v[60:63], v[164:167], v[176:191]
    v_exp_f32 v153, v153
    v_cvt_pk_bf16_f32 v171, v150, v151
    v_exp_f32 v154, v154
    v_exp_f32 v155, v155
    v_cvt_pk_bf16_f32 v172, v152, v153
    v_smfmac_f32_16x16x64_bf16 v[208:211], v[216:219], v[160:167], v220
    v_exp_f32 v156, v156
    v_exp_f32 v157, v157
    v_cvt_pk_bf16_f32 v173, v154, v155
    v_exp_f32 v158, v158
    v_exp_f32 v159, v159
    v_cvt_pk_bf16_f32 v174, v156, v157
    v_cvt_pk_bf16_f32 v175, v158, v159
    v_mfma_f32_32x32x16_bf16 v[144:159], v[64:67], v[88:91], v[112:127]
    v_exp_f32 v128, v128
    v_exp_f32 v129, v129
    v_exp_f32 v130, v130
    v_mfma_f32_32x32x16_bf16 v[144:159], v[68:71], v[92:95], v[144:159]
    v_exp_f32 v131, v131
    v_cvt_pk_bf16_f32 v160, v128, v129
    v_exp_f32 v132, v132
    v_exp_f32 v133, v133
    v_mfma_f32_32x32x16_bf16 v[192:207], v[56:59], v[168:171], v[192:207]
    v_cvt_pk_bf16_f32 v161, v130, v131
    v_exp_f32 v134, v134
    ds_read_b128 v[24:27], v221 offset:2048
    ds_read_b128 v[28:31], v221 offset:3072
    buffer_load_dwordx4 v[222:225], v254, s[52:55], 0 offen
    v_add_u32 v254, 0x200000, v254
    buffer_load_dword v222, off, s[60:63], s14
    s_add_u32 s14, s14, 0x80000
    s_and_b32 s14, s14, 0x1fffff
    buffer_load_dword v222, off, s[56:59], s15
    s_add_u32 s15, s15, 1024
    s_min_u32 s15, s15, 12582908
    buffer_load_dwordx4 v[222:225], v4, s[48:51], s37 offen
    s_add_u32 s37, s37, 0x100000
    v_exp_f32 v135, v135
    v_cvt_pk_bf16_f32 v162, v132, v133
    v_exp_f32 v136, v136
    v_mfma_f32_32x32x16_bf16 v[192:207], v[60:63], v[172:175], v[192:207]
    v_exp_f32 v137, v137
    v_cvt_pk_bf16_f32 v163, v134, v135
    v_exp_f32 v138, v138
    v_exp_f32 v139, v139
    v_cvt_pk_bf16_f32 v164, v136, v137
    v_smfmac_f32_16x16x64_bf16 v[212:215], v[216:219], v[168:175], v220
    v_exp_f32 v140, v140
    v_exp_f32 v141, v141
    v_cvt_pk_bf16_f32 v165, v138, v139
    v_exp_f32 v142, v142
    v_exp_f32 v143, v143
    v_cvt_pk_bf16_f32 v166, v140, v141
    v_cvt_pk_bf16_f32 v167, v142, v143
    s_waitcnt lgkmcnt(2)
    v_mfma_f32_32x32x16_bf16 v[128:143], v[16:19], v[80:83], v[96:111]
    v_exp_f32 v144, v144
    v_exp_f32 v145, v145
    v_exp_f32 v146, v146
    v_mfma_f32_32x32x16_bf16 v[128:143], v[20:23], v[84:87], v[128:143]
    v_exp_f32 v147, v147
    v_cvt_pk_bf16_f32 v168, v144, v145
    v_exp_f32 v148, v148
    v_exp_f32 v149, v149
    v_mfma_f32_32x32x16_bf16 v[176:191], v[72:75], v[160:163], v[176:191]
    v_cvt_pk_bf16_f32 v169, v146, v147
    v_exp_f32 v150, v150
    ds_read_b128 v[32:35], v221 offset:4096
    ds_read_b128 v[36:39], v221 offset:5120
    v_exp_f32 v151, v151
    v_cvt_pk_bf16_f32 v170, v148, v149
    v_exp_f32 v152, v152
    v_mfma_f32_32x32x16_bf16 v[176:191], v[76:79], v[164:167], v[176:191]
    v_exp_f32 v153, v153
    v_cvt_pk_bf16_f32 v171, v150, v151
    v_exp_f32 v154, v154
    v_exp_f32 v155, v155
    v_cvt_pk_bf16_f32 v172, v152, v153
    v_smfmac_f32_16x16x64_bf16 v[208:211], v[216:219], v[160:167], v220
    v_exp_f32 v156, v156
    v_exp_f32 v157, v157
    v_cvt_pk_bf16_f32 v173, v154, v155
    v_exp_f32 v158, v158
    v_exp_f32 v159, v159
    v_cvt_pk_bf16_f32 v174, v156, v157
    v_cvt_pk_bf16_f32 v175, v158, v159
    v_mfma_f32_32x32x16_bf16 v[144:159], v[16:19], v[88:91], v[112:127]
    v_exp_f32 v128, v128
    v_exp_f32 v129, v129
    v_exp_f32 v130, v130
    v_mfma_f32_32x32x16_bf16 v[144:159], v[20:23], v[92:95], v[144:159]
    v_exp_f32 v131, v131
    v_cvt_pk_bf16_f32 v160, v128, v129
    v_exp_f32 v132, v132
    v_exp_f32 v133, v133
    v_mfma_f32_32x32x16_bf16 v[192:207], v[72:75], v[168:171], v[192:207]
    v_cvt_pk_bf16_f32 v161, v130, v131
    v_exp_f32 v134, v134
    ds_read_b128 v[40:43], v221 offset:6144
    ds_read_b128 v[44:47], v221 offset:7168
    v_exp_f32 v135, v135
    v_cvt_pk_bf16_f32 v162, v132, v133
    v_exp_f32 v136, v136
    v_mfma_f32_32x32x16_bf16 v[192:207], v[76:79], v[172:175], v[192:207]
    v_exp_f32 v137, v137
    v_cvt_pk_bf16_f32 v163, v134, v135
    v_exp_f32 v138, v138
    v_exp_f32 v139, v139
    v_cvt_pk_bf16_f32 v164, v136, v137
    v_smfmac_f32_16x16x64_bf16 v[212:215], v[216:219], v[168:175], v220
    v_exp_f32 v140, v140
    v_exp_f32 v141, v141
    v_cvt_pk_bf16_f32 v165, v138, v139
    v_exp_f32 v142, v142
    v_exp_f32 v143, v143
    v_cvt_pk_bf16_f32 v166, v140, v141
    v_cvt_pk_bf16_f32 v167, v142, v143
    s_sub_u32 s44, s44, 1
    s_cmp_lg_u32 s44, 0
    s_cbranch_scc1 L_ka_attn_kernel_attA_11
    s_bfe_u32 s16, s2, 0x20001
    s_lshl_b32 s16, s16, 3
    s_add_u32 s16, s16, s8
    s_lshl_b32 s16, s16, 5
    v_lshrrev_b32 v11, 3, v1
    v_lshl_add_u32 v11, v11, 2, s16
    v_mul_u32_u24 v254, 12288, v11
    v_and_b32 v12, 7, v1
    v_lshl_add_u32 v254, v12, 4, v254
    s_bfe_u32 s17, s2, 0x50003
    s_xor_b32 s17, s17, 4
    s_and_b32 s18, s2, 1
    s_lshl_b32 s18, s18, 5
    s_add_u32 s17, s17, s18
    s_lshl_b32 s17, s17, 7
    s_add_u32 s17, s17, 4096
    v_lshlrev_b32 v11, 1, v11
    s_mov_b32 s16, 196608
    s_mov_b32 m0, s42
    s_mov_b32 s40, s41
    buffer_load_dwordx2 v[242:243], v11, s[20:23], s16 offen
    buffer_load_dwordx4 v[226:229], v254, s[56:59], s17 offen
    s_add_u32 s17, s17, 12288
    buffer_load_dwordx4 v[230:233], v254, s[56:59], s17 offen
    s_add_u32 s17, s17, 12288
    buffer_load_dwordx4 v[234:237], v254, s[56:59], s17 offen
    s_add_u32 s17, s17, 12288
    buffer_load_dwordx4 v[238:241], v254, s[56:59], s17 offen
    s_mov_b32 s44, 2
.p2align 6
L_ka_attn_kernel_attB_12:
    s_waitcnt lgkmcnt(4)
    s_waitcnt lgkmcnt(2)
    v_mfma_f32_32x32x16_bf16 v[128:143], v[32:35], v[80:83], v[96:111]
    v_exp_f32 v144, v144
    v_exp_f32 v145, v145
    v_exp_f32 v146, v146
    v_mfma_f32_32x32x16_bf16 v[128:143], v[36:39], v[84:87], v[128:143]
    v_exp_f32 v147, v147
    v_cvt_pk_bf16_f32 v168, v144, v145
    v_exp_f32 v148, v148
    v_exp_f32 v149, v149
    v_mfma_f32_32x32x16_bf16 v[176:191], v[24:27], v[160:163], v[176:191]
    v_cvt_pk_bf16_f32 v169, v146, v147
    v_exp_f32 v150, v150
    ds_read_b128 v[48:51], v221 offset:8192
    ds_read_b128 v[52:55], v221 offset:9216
    v_exp_f32 v151, v151
    v_cvt_pk_bf16_f32 v170, v148, v149
    v_exp_f32 v152, v152
    v_mfma_f32_32x32x16_bf16 v[176:191], v[28:31], v[164:167], v[176:191]
    v_exp_f32 v153, v153
    v_cvt_pk_bf16_f32 v171, v150, v151
    v_exp_f32 v154, v154
    v_exp_f32 v155, v155
    v_cvt_pk_bf16_f32 v172, v152, v153
    v_smfmac_f32_16x16x64_bf16 v[208:211], v[216:219], v[160:167], v220
    v_exp_f32 v156, v156
    v_exp_f32 v157, v157
    v_cvt_pk_bf16_f32 v173, v154, v155
    v_exp_f32 v158, v158
    v_exp_f32 v159, v159
    v_cvt_pk_bf16_f32 v174, v156, v157
    v_cvt_pk_bf16_f32 v175, v158, v159
    v_mfma_f32_32x32x16_bf16 v[144:159], v[32:35], v[88:91], v[112:127]
    v_exp_f32 v128, v128
    v_exp_f32 v129, v129
    v_exp_f32 v130, v130
    v_mfma_f32_32x32x16_bf16 v[144:159], v[36:39], v[92:95], v[144:159]
    v_exp_f32 v131, v131
    v_cvt_pk_bf16_f32 v160, v128, v129
    v_exp_f32 v132, v132
    v_exp_f32 v133, v133
    v_mfma_f32_32x32x16_bf16 v[192:207], v[24:27], v[168:171], v[192:207]
    v_cvt_pk_bf16_f32 v161, v130, v131
    v_exp_f32 v134, v134
    ds_read_b128 v[56:59], v221 offset:10240
    ds_read_b128 v[60:63], v221 offset:11264
    buffer_load_dwordx4 v5, s[60:63], s40 offen offset:0 lds
    v_exp_f32 v135, v135
    v_cvt_pk_bf16_f32 v162, v132, v133
    v_exp_f32 v136, v136
    v_mfma_f32_32x32x16_bf16 v[192:207], v[28:31], v[172:175], v[192:207]
    v_exp_f32 v137, v137
    v_cvt_pk_bf16_f32 v163, v134, v135
    v_exp_f32 v138, v138
    v_exp_f32 v139, v139
    v_cvt_pk_bf16_f32 v164, v136, v137
    v_smfmac_f32_16x16x64_bf16 v[212:215], v[216:219], v[168:175], v220
    v_exp_f32 v140, v140
    v_exp_f32 v141, v141
    v_cvt_pk_bf16_f32 v165, v138, v139
    v_exp_f32 v142, v142
    v_exp_f32 v143, v143
    v_cvt_pk_bf16_f32 v166, v140, v141
    v_cvt_pk_bf16_f32 v167, v142, v143
    s_waitcnt lgkmcnt(4)
    s_waitcnt lgkmcnt(2)
    v_mfma_f32_32x32x16_bf16 v[128:143], v[48:51], v[80:83], v[96:111]
    v_exp_f32 v144, v144
    v_exp_f32 v145, v145
    v_exp_f32 v146, v146
    v_mfma_f32_32x32x16_bf16 v[128:143], v[52:55], v[84:87], v[128:143]
    v_exp_f32 v147, v147
    v_cvt_pk_bf16_f32 v168, v144, v145
    v_exp_f32 v148, v148
    v_exp_f32 v149, v149
    v_mfma_f32_32x32x16_bf16 v[176:191], v[40:43], v[160:163], v[176:191]
    v_cvt_pk_bf16_f32 v169, v146, v147
    v_exp_f32 v150, v150
    ds_read_b128 v[64:67], v221 offset:12288
    ds_read_b128 v[68:71], v221 offset:13312
    v_exp_f32 v151, v151
    v_cvt_pk_bf16_f32 v170, v148, v149
    v_exp_f32 v152, v152
    v_mfma_f32_32x32x16_bf16 v[176:191], v[44:47], v[164:167], v[176:191]
    v_exp_f32 v153, v153
    v_cvt_pk_bf16_f32 v171, v150, v151
    v_exp_f32 v154, v154
    v_exp_f32 v155, v155
    v_cvt_pk_bf16_f32 v172, v152, v153
    v_smfmac_f32_16x16x64_bf16 v[208:211], v[216:219], v[160:167], v220
    v_exp_f32 v156, v156
    v_exp_f32 v157, v157
    v_cvt_pk_bf16_f32 v173, v154, v155
    v_exp_f32 v158, v158
    v_exp_f32 v159, v159
    v_cvt_pk_bf16_f32 v174, v156, v157
    v_cvt_pk_bf16_f32 v175, v158, v159
    v_mfma_f32_32x32x16_bf16 v[144:159], v[48:51], v[88:91], v[112:127]
    v_exp_f32 v128, v128
    v_exp_f32 v129, v129
    v_exp_f32 v130, v130
    v_mfma_f32_32x32x16_bf16 v[144:159], v[52:55], v[92:95], v[144:159]
    v_exp_f32 v131, v131
    v_cvt_pk_bf16_f32 v160, v128, v129
    v_exp_f32 v132, v132
    v_exp_f32 v133, v133
    v_mfma_f32_32x32x16_bf16 v[192:207], v[40:43], v[168:171], v[192:207]
    v_cvt_pk_bf16_f32 v161, v130, v131
    v_exp_f32 v134, v134
    ds_read_b128 v[72:75], v221 offset:14336
    ds_read_b128 v[76:79], v221 offset:15360
    buffer_load_dwordx4 v6, s[60:63], s40 offen offset:1024 lds
    v_exp_f32 v135, v135
    v_cvt_pk_bf16_f32 v162, v132, v133
    v_exp_f32 v136, v136
    v_mfma_f32_32x32x16_bf16 v[192:207], v[44:47], v[172:175], v[192:207]
    v_exp_f32 v137, v137
    v_cvt_pk_bf16_f32 v163, v134, v135
    v_exp_f32 v138, v138
    v_exp_f32 v139, v139
    v_cvt_pk_bf16_f32 v164, v136, v137
    v_smfmac_f32_16x16x64_bf16 v[212:215], v[216:219], v[168:175], v220
    v_exp_f32 v140, v140
    v_exp_f32 v141, v141
    v_cvt_pk_bf16_f32 v165, v138, v139
    v_exp_f32 v142, v142
    v_exp_f32 v143, v143
    v_cvt_pk_bf16_f32 v166, v140, v141
    v_cvt_pk_bf16_f32 v167, v142, v143
    s_waitcnt lgkmcnt(4)
    s_waitcnt lgkmcnt(2)
    v_mfma_f32_32x32x16_bf16 v[128:143], v[64:67], v[80:83], v[96:111]
    v_exp_f32 v144, v144
    v_exp_f32 v145, v145
    v_exp_f32 v146, v146
    v_mfma_f32_32x32x16_bf16 v[128:143], v[68:71], v[84:87], v[128:143]
    v_exp_f32 v147, v147
    v_cvt_pk_bf16_f32 v168, v144, v145
    v_exp_f32 v148, v148
    v_exp_f32 v149, v149
    v_mfma_f32_32x32x16_bf16 v[176:191], v[56:59], v[160:163], v[176:191]
    v_cvt_pk_bf16_f32 v169, v146, v147
    v_exp_f32 v150, v150
    s_waitcnt vmcnt(16)
    s_waitcnt lgkmcnt(0)
    s_barrier
    v_add_u32 v221, s28, v4
    s_mov_b32 s16, s47
    s_mov_b32 s47, s28
    s_mov_b32 s28, s29
    s_mov_b32 s29, s16
    ds_read_b128 v[16:19], v221 offset:0
    ds_read_b128 v[20:23], v221 offset:1024
    v_exp_f32 v151, v151
    v_cvt_pk_bf16_f32 v170, v148, v149
    v_exp_f32 v152, v152
    v_mfma_f32_32x32x16_bf16 v[176:191], v[60:63], v[164:167], v[176:191]
    v_exp_f32 v153, v153
    v_cvt_pk_bf16_f32 v171, v150, v151
    v_exp_f32 v154, v154
    v_exp_f32 v155, v155
    v_cvt_pk_bf16_f32 v172, v152, v153
    v_smfmac_f32_16x16x64_bf16 v[208:211], v[216:219], v[160:167], v220
    v_exp_f32 v156, v156
    v_exp_f32 v157, v157
    v_cvt_pk_bf16_f32 v173, v154, v155
    v_exp_f32 v158, v158
    v_exp_f32 v159, v159
    v_cvt_pk_bf16_f32 v174, v156, v157
    v_cvt_pk_bf16_f32 v175, v158, v159
    v_mfma_f32_32x32x16_bf16 v[144:159], v[64:67], v[88:91], v[112:127]
    v_exp_f32 v128, v128
    v_exp_f32 v129, v129
    v_exp_f32 v130, v130
    v_mfma_f32_32x32x16_bf16 v[144:159], v[68:71], v[92:95], v[144:159]
    v_exp_f32 v131, v131
    v_cvt_pk_bf16_f32 v160, v128, v129
    v_exp_f32 v132, v132
    v_exp_f32 v133, v133
    v_mfma_f32_32x32x16_bf16 v[192:207], v[56:59], v[168:171], v[192:207]
    v_cvt_pk_bf16_f32 v161, v130, v131
    v_exp_f32 v134, v134
    ds_read_b128 v[24:27], v221 offset:2048
    ds_read_b128 v[28:31], v221 offset:3072
    buffer_load_dwordx4 v[222:225], v4, s[48:51], s37 offen
    s_add_u32 s37, s37, 0x100000
    buffer_load_dwordx4 v7, s[60:63], s40 offen offset:2048 lds
    v_exp_f32 v135, v135
    v_cvt_pk_bf16_f32 v162, v132, v133
    v_exp_f32 v136, v136
    v_mfma_f32_32x32x16_bf16 v[192:207], v[60:63], v[172:175], v[192:207]
    v_exp_f32 v137, v137
    v_cvt_pk_bf16_f32 v163, v134, v135
    v_exp_f32 v138, v138
    v_exp_f32 v139, v139
    v_cvt_pk_bf16_f32 v164, v136, v137
    v_smfmac_f32_16x16x64_bf16 v[212:215], v[216:219], v[168:175], v220
    v_exp_f32 v140, v140
    v_exp_f32 v141, v141
    v_cvt_pk_bf16_f32 v165, v138, v139
    v_exp_f32 v142, v142
    v_exp_f32 v143, v143
    v_cvt_pk_bf16_f32 v166, v140, v141
    v_cvt_pk_bf16_f32 v167, v142, v143
    s_waitcnt lgkmcnt(2)
    v_mfma_f32_32x32x16_bf16 v[128:143], v[16:19], v[80:83], v[96:111]
    v_exp_f32 v144, v144
    v_exp_f32 v145, v145
    v_exp_f32 v146, v146
    v_mfma_f32_32x32x16_bf16 v[128:143], v[20:23], v[84:87], v[128:143]
    v_exp_f32 v147, v147
    v_cvt_pk_bf16_f32 v168, v144, v145
    v_exp_f32 v148, v148
    v_exp_f32 v149, v149
    v_mfma_f32_32x32x16_bf16 v[176:191], v[72:75], v[160:163], v[176:191]
    v_cvt_pk_bf16_f32 v169, v146, v147
    v_exp_f32 v150, v150
    ds_read_b128 v[32:35], v221 offset:4096
    ds_read_b128 v[36:39], v221 offset:5120
    v_exp_f32 v151, v151
    v_cvt_pk_bf16_f32 v170, v148, v149
    v_exp_f32 v152, v152
    v_mfma_f32_32x32x16_bf16 v[176:191], v[76:79], v[164:167], v[176:191]
    v_exp_f32 v153, v153
    v_cvt_pk_bf16_f32 v171, v150, v151
    v_exp_f32 v154, v154
    v_exp_f32 v155, v155
    v_cvt_pk_bf16_f32 v172, v152, v153
    v_smfmac_f32_16x16x64_bf16 v[208:211], v[216:219], v[160:167], v220
    v_exp_f32 v156, v156
    v_exp_f32 v157, v157
    v_cvt_pk_bf16_f32 v173, v154, v155
    v_exp_f32 v158, v158
    v_exp_f32 v159, v159
    v_cvt_pk_bf16_f32 v174, v156, v157
    v_cvt_pk_bf16_f32 v175, v158, v159
    v_mfma_f32_32x32x16_bf16 v[144:159], v[16:19], v[88:91], v[112:127]
    v_exp_f32 v128, v128
    v_exp_f32 v129, v129
    v_exp_f32 v130, v130
    v_mfma_f32_32x32x16_bf16 v[144:159], v[20:23], v[92:95], v[144:159]
    v_exp_f32 v131, v131
    v_cvt_pk_bf16_f32 v160, v128, v129
    v_exp_f32 v132, v132
    v_exp_f32 v133, v133
    v_mfma_f32_32x32x16_bf16 v[192:207], v[72:75], v[168:171], v[192:207]
    v_cvt_pk_bf16_f32 v161, v130, v131
    v_exp_f32 v134, v134
    ds_read_b128 v[40:43], v221 offset:6144
    ds_read_b128 v[44:47], v221 offset:7168
    buffer_load_dwordx4 v8, s[60:63], s40 offen offset:3072 lds
    s_add_u32 m0, m0, 32768
    s_add_u32 s40, s40, 524288
    v_exp_f32 v135, v135
    v_cvt_pk_bf16_f32 v162, v132, v133
    v_exp_f32 v136, v136
    v_mfma_f32_32x32x16_bf16 v[192:207], v[76:79], v[172:175], v[192:207]
    v_exp_f32 v137, v137
    v_cvt_pk_bf16_f32 v163, v134, v135
    v_exp_f32 v138, v138
    v_exp_f32 v139, v139
    v_cvt_pk_bf16_f32 v164, v136, v137
    v_smfmac_f32_16x16x64_bf16 v[212:215], v[216:219], v[168:175], v220
    v_exp_f32 v140, v140
    v_exp_f32 v141, v141
    v_cvt_pk_bf16_f32 v165, v138, v139
    v_exp_f32 v142, v142
    v_exp_f32 v143, v143
    v_cvt_pk_bf16_f32 v166, v140, v141
    v_cvt_pk_bf16_f32 v167, v142, v143
    s_sub_u32 s44, s44, 1
    s_cmp_lg_u32 s44, 0
    s_cbranch_scc1 L_ka_attn_kernel_attB_12
    s_add_u32 m0, s42, 16384
    s_add_u32 s40, s41, 262144
    s_waitcnt vmcnt(5)
    s_mov_b32 s16, 0x05040100
    s_mov_b32 s17, 0x07060302
    v_and_b32 v13, 31, v1
    v_lshlrev_b32 v13, 11, v13
    v_lshrrev_b32 v12, 5, v1
    v_lshl_add_u32 v13, v12, 3, v13
    s_lshl_b32 s38, s43, 16
    s_lshl_b32 s18, s13, 7
    s_add_u32 s38, s38, s18
    s_lshl_b32 s18, s9, 6
    s_add_u32 s38, s38, s18
    s_waitcnt vmcnt(10)
    s_waitcnt lgkmcnt(4)
    s_waitcnt lgkmcnt(2)
    v_mfma_f32_32x32x16_bf16 v[128:143], v[32:35], v[80:83], v[96:111]
    v_exp_f32 v144, v144
    v_exp_f32 v145, v145
    v_exp_f32 v146, v146
    v_perm_b32 v252, v230, v226, s16
    v_mfma_f32_32x32x16_bf16 v[128:143], v[36:39], v[84:87], v[128:143]
    v_exp_f32 v147, v147
    v_cvt_pk_bf16_f32 v168, v144, v145
    v_exp_f32 v148, v148
    v_perm_b32 v253, v230, v226, s17
    v_exp_f32 v149, v149
    v_mfma_f32_32x32x16_bf16 v[176:191], v[24:27], v[160:163], v[176:191]
    v_cvt_pk_bf16_f32 v169, v146, v147
    v_exp_f32 v150, v150
    v_dot2_f32_bf16 v244, v252, v242, 0
    ds_read_b128 v[48:51], v221 offset:8192
    ds_read_b128 v[52:55], v221 offset:9216
    buffer_load_dwordx2 v[16:17], v13, s[24:27], s38 offen offset:0
    buffer_load_dwordx2 v[18:19], v13, s[24:27], s38 offen offset:16
    buffer_load_dwordx2 v[20:21], v13, s[24:27], s38 offen offset:32
    buffer_load_dwordx2 v[22:23], v13, s[24:27], s38 offen offset:48
    v_exp_f32 v151, v151
    v_cvt_pk_bf16_f32 v170, v148, v149
    v_exp_f32 v152, v152
    v_dot2_f32_bf16 v245, v253, v242, 0
    v_mfma_f32_32x32x16_bf16 v[176:191], v[28:31], v[164:167], v[176:191]
    v_exp_f32 v153, v153
    v_cvt_pk_bf16_f32 v171, v150, v151
    v_exp_f32 v154, v154
    v_perm_b32 v252, v231, v227, s16
    v_exp_f32 v155, v155
    v_cvt_pk_bf16_f32 v172, v152, v153
    v_smfmac_f32_16x16x64_bf16 v[208:211], v[216:219], v[160:167], v220
    v_exp_f32 v156, v156
    v_perm_b32 v253, v231, v227, s17
    v_exp_f32 v157, v157
    v_cvt_pk_bf16_f32 v173, v154, v155
    v_exp_f32 v158, v158
    v_dot2_f32_bf16 v246, v252, v242, 0
    v_exp_f32 v159, v159
    v_cvt_pk_bf16_f32 v174, v156, v157
    v_cvt_pk_bf16_f32 v175, v158, v159
    v_dot2_f32_bf16 v247, v253, v242, 0
    v_mfma_f32_32x32x16_bf16 v[144:159], v[32:35], v[88:91], v[112:127]
    v_exp_f32 v128, v128
    v_exp_f32 v129, v129
    v_exp_f32 v130, v130
    v_perm_b32 v252, v232, v228, s16
    v_mfma_f32_32x32x16_bf16 v[144:159], v[36:39], v[92:95], v[144:159]
    v_exp_f32 v131, v131
    v_cvt_pk_bf16_f32 v160, v128, v129
    v_exp_f32 v132, v132
    v_perm_b32 v253, v232, v228, s17
    v_exp_f32 v133, v133
    v_mfma_f32_32x32x16_bf16 v[192:207], v[24:27], v[168:171], v[192:207]
    v_cvt_pk_bf16_f32 v161, v130, v131
    v_exp_f32 v134, v134
    v_dot2_f32_bf16 v248, v252, v242, 0
    ds_read_b128 v[56:59], v221 offset:10240
    ds_read_b128 v[60:63], v221 offset:11264
    buffer_load_dwordx4 v5, s[60:63], s40 offen offset:0 lds
    buffer_load_dwordx4 v6, s[60:63], s40 offen offset:1024 lds
    v_exp_f32 v135, v135
    v_cvt_pk_bf16_f32 v162, v132, v133
    v_exp_f32 v136, v136
    v_dot2_f32_bf16 v249, v253, v242, 0
    v_mfma_f32_32x32x16_bf16 v[192:207], v[28:31], v[172:175], v[192:207]
    v_exp_f32 v137, v137
    v_cvt_pk_bf16_f32 v163, v134, v135
    v_exp_f32 v138, v138
    v_perm_b32 v252, v233, v229, s16
    v_exp_f32 v139, v139
    v_cvt_pk_bf16_f32 v164, v136, v137
    v_smfmac_f32_16x16x64_bf16 v[212:215], v[216:219], v[168:175], v220
    v_exp_f32 v140, v140
    v_perm_b32 v253, v233, v229, s17
    v_exp_f32 v141, v141
    v_cvt_pk_bf16_f32 v165, v138, v139
    v_exp_f32 v142, v142
    v_dot2_f32_bf16 v250, v252, v242, 0
    v_exp_f32 v143, v143
    v_cvt_pk_bf16_f32 v166, v140, v141
    v_cvt_pk_bf16_f32 v167, v142, v143
    v_dot2_f32_bf16 v251, v253, v242, 0
    s_waitcnt lgkmcnt(4)
    s_waitcnt lgkmcnt(2)
    v_mfma_f32_32x32x16_bf16 v[128:143], v[48:51], v[80:83], v[96:111]
    v_exp_f32 v144, v144
    v_exp_f32 v145, v145
    v_exp_f32 v146, v146
    v_perm_b32 v252, v238, v234, s16
    v_mfma_f32_32x32x16_bf16 v[128:143], v[52:55], v[84:87], v[128:143]
    v_exp_f32 v147, v147
    v_cvt_pk_bf16_f32 v168, v144, v145
    v_exp_f32 v148, v148
    v_perm_b32 v253, v238, v234, s17
    v_exp_f32 v149, v149
    v_mfma_f32_32x32x16_bf16 v[176:191], v[40:43], v[160:163], v[176:191]
    v_cvt_pk_bf16_f32 v169, v146, v147
    v_exp_f32 v150, v150
    v_dot2_f32_bf16 v244, v252, v243, v244
    ds_read_b128 v[64:67], v221 offset:12288
    ds_read_b128 v[68:71], v221 offset:13312
    v_exp_f32 v151, v151
    v_cvt_pk_bf16_f32 v170, v148, v149
    v_exp_f32 v152, v152
    v_dot2_f32_bf16 v245, v253, v243, v245
    v_mfma_f32_32x32x16_bf16 v[176:191], v[44:47], v[164:167], v[176:191]
    v_exp_f32 v153, v153
    v_cvt_pk_bf16_f32 v171, v150, v151
    v_exp_f32 v154, v154
    v_perm_b32 v252, v239, v235, s16
    v_exp_f32 v155, v155
    v_cvt_pk_bf16_f32 v172, v152, v153
    v_smfmac_f32_16x16x64_bf16 v[208:211], v[216:219], v[160:167], v220
    v_exp_f32 v156, v156
    v_perm_b32 v253, v239, v235, s17
    v_exp_f32 v157, v157
    v_cvt_pk_bf16_f32 v173, v154, v155
    v_exp_f32 v158, v158
    v_dot2_f32_bf16 v246, v252, v243, v246
    v_exp_f32 v159, v159
    v_cvt_pk_bf16_f32 v174, v156, v157
    v_cvt_pk_bf16_f32 v175, v158, v159
    v_dot2_f32_bf16 v247, v253, v243, v247
    v_mfma_f32_32x32x16_bf16 v[144:159], v[48:51], v[88:91], v[112:127]
    v_exp_f32 v128, v128
    v_exp_f32 v129, v129
    v_exp_f32 v130, v130
    v_perm_b32 v252, v240, v236, s16
    v_mfma_f32_32x32x16_bf16 v[144:159], v[52:55], v[92:95], v[144:159]
    v_exp_f32 v131, v131
    v_cvt_pk_bf16_f32 v160, v128, v129
    v_exp_f32 v132, v132
    v_perm_b32 v253, v240, v236, s17
    v_exp_f32 v133, v133
    v_mfma_f32_32x32x16_bf16 v[192:207], v[40:43], v[168:171], v[192:207]
    v_cvt_pk_bf16_f32 v161, v130, v131
    v_exp_f32 v134, v134
    v_dot2_f32_bf16 v248, v252, v243, v248
    ds_read_b128 v[72:75], v221 offset:14336
    ds_read_b128 v[76:79], v221 offset:15360
    buffer_load_dwordx4 v7, s[60:63], s40 offen offset:2048 lds
    buffer_load_dwordx4 v8, s[60:63], s40 offen offset:3072 lds
    s_add_u32 s40, s40, 524288
    buffer_load_dwordx4 v[24:27], v5, s[60:63], s40 offen offset:0
    buffer_load_dwordx4 v[28:31], v6, s[60:63], s40 offen offset:1024
    v_exp_f32 v135, v135
    v_cvt_pk_bf16_f32 v162, v132, v133
    v_exp_f32 v136, v136
    v_dot2_f32_bf16 v249, v253, v243, v249
    v_mfma_f32_32x32x16_bf16 v[192:207], v[44:47], v[172:175], v[192:207]
    v_exp_f32 v137, v137
    v_cvt_pk_bf16_f32 v163, v134, v135
    v_exp_f32 v138, v138
    v_perm_b32 v252, v241, v237, s16
    v_exp_f32 v139, v139
    v_cvt_pk_bf16_f32 v164, v136, v137
    v_smfmac_f32_16x16x64_bf16 v[212:215], v[216:219], v[168:175], v220
    v_exp_f32 v140, v140
    v_perm_b32 v253, v241, v237, s17
    v_exp_f32 v141, v141
    v_cvt_pk_bf16_f32 v165, v138, v139
    v_exp_f32 v142, v142
    v_dot2_f32_bf16 v250, v252, v243, v250
    v_exp_f32 v143, v143
    v_cvt_pk_bf16_f32 v166, v140, v141
    v_cvt_pk_bf16_f32 v167, v142, v143
    v_dot2_f32_bf16 v251, v253, v243, v251
    s_waitcnt lgkmcnt(4)
    s_waitcnt lgkmcnt(2)
    v_mfma_f32_32x32x16_bf16 v[128:143], v[64:67], v[80:83], v[96:111]
    v_exp_f32 v144, v144
    v_exp_f32 v145, v145
    v_exp_f32 v146, v146
    v_permlane32_swap_b32 v244, v248
    v_mfma_f32_32x32x16_bf16 v[128:143], v[68:71], v[84:87], v[128:143]
    v_exp_f32 v147, v147
    v_cvt_pk_bf16_f32 v168, v144, v145
    v_exp_f32 v148, v148
    v_permlane32_swap_b32 v245, v249
    v_exp_f32 v149, v149
    v_mfma_f32_32x32x16_bf16 v[176:191], v[56:59], v[160:163], v[176:191]
    v_cvt_pk_bf16_f32 v169, v146, v147
    v_exp_f32 v150, v150
    v_permlane32_swap_b32 v246, v250
    s_waitcnt lgkmcnt(0)
    s_barrier
    buffer_load_dwordx4 v[32:35], v7, s[60:63], s40 offen offset:2048
    buffer_load_dwordx4 v[36:39], v8, s[60:63], s40 offen offset:3072
    v_exp_f32 v151, v151
    v_cvt_pk_bf16_f32 v170, v148, v149
    v_exp_f32 v152, v152
    v_permlane32_swap_b32 v247, v251
    v_mfma_f32_32x32x16_bf16 v[176:191], v[60:63], v[164:167], v[176:191]
    v_exp_f32 v153, v153
    v_cvt_pk_bf16_f32 v171, v150, v151
    v_exp_f32 v154, v154
    v_add_f32 v244, v244, v248
    v_exp_f32 v155, v155
    v_cvt_pk_bf16_f32 v172, v152, v153
    v_smfmac_f32_16x16x64_bf16 v[208:211], v[216:219], v[160:167], v220
    v_exp_f32 v156, v156
    v_add_f32 v245, v245, v249
    v_exp_f32 v157, v157
    v_cvt_pk_bf16_f32 v173, v154, v155
    v_exp_f32 v158, v158
    v_add_f32 v246, v246, v250
    v_exp_f32 v159, v159
    v_cvt_pk_bf16_f32 v174, v156, v157
    v_cvt_pk_bf16_f32 v175, v158, v159
    v_add_f32 v247, v247, v251
    v_mfma_f32_32x32x16_bf16 v[144:159], v[64:67], v[88:91], v[112:127]
    v_exp_f32 v128, v128
    v_exp_f32 v129, v129
    v_exp_f32 v130, v130
    v_permlane16_swap_b32 v244, v246
    v_mfma_f32_32x32x16_bf16 v[144:159], v[68:71], v[92:95], v[144:159]
    v_exp_f32 v131, v131
    v_cvt_pk_bf16_f32 v160, v128, v129
    v_exp_f32 v132, v132
    v_permlane16_swap_b32 v245, v247
    v_exp_f32 v133, v133
    v_mfma_f32_32x32x16_bf16 v[192:207], v[56:59], v[168:171], v[192:207]
    v_cvt_pk_bf16_f32 v161, v130, v131
    v_exp_f32 v134, v134
    v_add_f32 v244, v244, v246
    v_exp_f32 v135, v135
    v_cvt_pk_bf16_f32 v162, v132, v133
    v_exp_f32 v136, v136
    v_add_f32 v245, v245, v247
    v_mfma_f32_32x32x16_bf16 v[192:207], v[60:63], v[172:175], v[192:207]
    v_exp_f32 v137, v137
    v_cvt_pk_bf16_f32 v163, v134, v135
    v_exp_f32 v138, v138
    v_add_f32_dpp v244, v244, v244 row_ror:8 row_mask:0xf bank_mask:0xf
    v_exp_f32 v139, v139
    v_cvt_pk_bf16_f32 v164, v136, v137
    v_smfmac_f32_16x16x64_bf16 v[212:215], v[216:219], v[168:175], v220
    v_exp_f32 v140, v140
    v_add_f32_dpp v245, v245, v245 row_ror:8 row_mask:0xf bank_mask:0xf
    v_exp_f32 v141, v141
    v_cvt_pk_bf16_f32 v165, v138, v139
    v_exp_f32 v142, v142
    v_exp_f32 v143, v143
    v_cvt_pk_bf16_f32 v166, v140, v141
    v_cvt_pk_bf16_f32 v167, v142, v143
    v_mfma_f32_32x32x16_bf16 v[176:191], v[72:75], v[160:163], v[176:191]
    v_exp_f32 v144, v144
    v_exp_f32 v145, v145
    v_exp_f32 v146, v146
    v_mfma_f32_32x32x16_bf16 v[176:191], v[76:79], v[164:167], v[176:191]
    v_exp_f32 v147, v147
    v_cvt_pk_bf16_f32 v168, v144, v145
    v_exp_f32 v148, v148
    v_exp_f32 v149, v149
    v_smfmac_f32_16x16x64_bf16 v[208:211], v[216:219], v[160:167], v220
    v_cvt_pk_bf16_f32 v169, v146, v147
    v_exp_f32 v150, v150
    v_exp_f32 v151, v151
    v_cvt_pk_bf16_f32 v170, v148, v149
    v_exp_f32 v152, v152
    v_exp_f32 v153, v153
    v_cvt_pk_bf16_f32 v171, v150, v151
    v_exp_f32 v154, v154
    v_exp_f32 v155, v155
    v_cvt_pk_bf16_f32 v172, v152, v153
    v_exp_f32 v156, v156
    v_exp_f32 v157, v157
    v_cvt_pk_bf16_f32 v173, v154, v155
    v_exp_f32 v158, v158
    v_exp_f32 v159, v159
    v_cvt_pk_bf16_f32 v174, v156, v157
    v_cvt_pk_bf16_f32 v175, v158, v159
    v_mfma_f32_32x32x16_bf16 v[192:207], v[72:75], v[168:171], v[192:207]
    v_lshlrev_b32 v56, 2, v1
    v_smfmac_f32_16x16x64_bf16 v[212:215], v[216:219], v[168:175], v220
    v_mfma_f32_32x32x16_bf16 v[192:207], v[76:79], v[172:175], v[192:207]
    s_lshl_b32 s16, s8, 8
    s_add_u32 s16, s16, 114688
    v_add_u32 v57, s16, v56
    v_xor_b32 v58, 0x400, v57
    s_lshl_b32 s17, s8, 2
    s_add_u32 s17, s17, 114688
    v_mov_b32 v59, s17
    v_and_b32 v60, 7, v1
    v_lshlrev_b32 v60, 5, v60
    v_lshrrev_b32 v11, 5, v1
    v_lshl_add_u32 v60, v11, 4, v60
    v_bfe_u32 v11, v1, 4, 1
    v_lshl_add_u32 v60, v11, 3, v60
    v_add_u32 v60, s16, v60
    v_cmp_eq_u32 vcc, 0, v11
    ds_write_b64 v60, v[244:245] offset:4096
    v_add_f32 v208, v208, v209
    v_add_f32 v209, v210, v211
    v_add_f32 v212, v212, v213
    v_add_f32 v213, v214, v215
    v_cndmask_b32 v12, v209, v208, vcc
    v_cndmask_b32 v13, v213, v212, vcc
    v_add_f32 v15, v12, v13
    s_mov_b32 s16, 0x5f000000
    v_cmp_nlt_f32 vcc, v15, s16
    s_nop 1
    s_or_b32 s16, vcc_lo, vcc_hi
    v_mov_b32 v15, s16
    ds_write_b32 v59, v15 offset:2048
    ds_write_b128 v3, v[192:195] offset:0
    ds_write_b128 v3, v[196:199] offset:1024
    ds_write_b128 v3, v[200:203] offset:2048
    ds_write_b128 v3, v[204:207] offset:3072
    ds_write_b32 v57, v13 offset:0
    s_waitcnt lgkmcnt(0)
    s_barrier
    v_mov_b32 v59, 114688
    ds_read_b128 v[48:51], v59 offset:2048
    ds_read_b128 v[52:55], v59 offset:2064
    ds_read_b32 v13, v58 offset:0
    ds_read_b128 v[128:131], v2 offset:0
    ds_read_b128 v[132:135], v2 offset:1024
    ds_read_b128 v[136:139], v2 offset:2048
    ds_read_b128 v[140:143], v2 offset:3072
    s_waitcnt lgkmcnt(5)
    v_or3_b32 v48, v48, v49, v50
    v_or3_b32 v51, v51, v52, v53
    v_or3_b32 v48, v48, v54, v55
    v_or_b32 v48, v48, v51
    s_nop 0
    v_readfirstlane_b32 s16, v48
    s_cmp_lg_u32 s45, 0
    s_cbranch_scc1 L_ka_attn_kernel_fin_13
    s_cmp_eq_u32 s16, 0
    s_cbranch_scc1 L_ka_attn_kernel_fin_13
    s_waitcnt lgkmcnt(0)
    s_mov_b32 s45, 1
    s_mov_b32 s44, 32
    s_lshl_b32 s46, s9, 17
    s_add_u32 s46, s46, 9437184
    s_mov_b32 s47, s46
    v_mov_b32 v12, 0xff800000
    v_mov_b32 v13, 0xff800000
L_ka_attn_kernel_mx_14:
    buffer_load_dwordx4 v[16:19], v4, s[20:23], s46 offen offset:0
    buffer_load_dwordx4 v[20:23], v4, s[20:23], s46 offen offset:1024
    s_add_u32 s46, s46, 4096
    s_waitcnt vmcnt(0)
    v_mfma_f32_32x32x16_bf16 v[128:143], v[16:19], v[80:83], 0
    v_mfma_f32_32x32x16_bf16 v[128:143], v[20:23], v[84:87], v[128:143]
    v_mfma_f32_32x32x16_bf16 v[144:159], v[16:19], v[88:91], 0
    v_mfma_f32_32x32x16_bf16 v[144:159], v[20:23], v[92:95], v[144:159]
    s_nop 11
    v_max3_f32 v12, v12, v128, v129
    v_max3_f32 v12, v12, v130, v143
    v_max3_f32 v12, v12, v131, v132
    v_max3_f32 v12, v12, v133, v134
    v_max3_f32 v12, v12, v135, v136
    v_max3_f32 v12, v12, v137, v138
    v_max3_f32 v12, v12, v139, v140
    v_max3_f32 v12, v12, v141, v142
    v_max3_f32 v13, v13, v144, v145
    v_max3_f32 v13, v13, v146, v159
    v_max3_f32 v13, v13, v147, v148
    v_max3_f32 v13, v13, v149, v150
    v_max3_f32 v13, v13, v151, v152
    v_max3_f32 v13, v13, v153, v154
    v_max3_f32 v13, v13, v155, v156
    v_max3_f32 v13, v13, v157, v158
    s_sub_u32 s44, s44, 1
    s_cmp_lg_u32 s44, 0
    s_cbranch_scc1 L_ka_attn_kernel_mx_14
    v_lshlrev_b32 v14, 3, v1
    s_lshl_b32 s16, s8, 9
    s_add_u32 s16, s16, 114688
    v_add_u32 v14, s16, v14
    v_xor_b32 v11, 0x800, v14
    ds_write_b64 v14, v[12:13] offset:8192
    s_waitcnt lgkmcnt(0)
    s_barrier
    ds_read_b64 v[14:15], v11 offset:8192
    s_waitcnt lgkmcnt(0)
    v_max_f32 v12, v12, v15
    v_max_f32 v13, v13, v14
    v_mov_b32 v14, v12
    v_mov_b32 v15, v13
    s_nop 1
    v_permlane32_swap_b32 v12, v14
    v_permlane32_swap_b32 v13, v15
    v_max_f32 v12, v12, v14
    v_max_f32 v13, v13, v15
    v_sub_f32 v12, 0, v12
    v_sub_f32 v13, 0, v13
    v_mov_b32 v96, v12
    v_mov_b32 v97, v12
    v_mov_b32 v98, v12
    v_mov_b32 v99, v12
    v_mov_b32 v100, v12
    v_mov_b32 v101, v12
    v_mov_b32 v102, v12
    v_mov_b32 v103, v12
    v_mov_b32 v104, v12
    v_mov_b32 v105, v12
    v_mov_b32 v106, v12
    v_mov_b32 v107, v12
    v_mov_b32 v108, v12
    v_mov_b32 v109, v12
    v_mov_b32 v110, v12
    v_mov_b32 v111, v12
    v_mov_b32 v112, v13
    v_mov_b32 v113, v13
    v_mov_b32 v114, v13
    v_mov_b32 v115, v13
    v_mov_b32 v116, v13
    v_mov_b32 v117, v13
    v_mov_b32 v118, v13
    v_mov_b32 v119, v13
    v_mov_b32 v120, v13
    v_mov_b32 v121, v13
    v_mov_b32 v122, v13
    v_mov_b32 v123, v13
    v_mov_b32 v124, v13
    v_mov_b32 v125, v13
    v_mov_b32 v126, v13
    v_mov_b32 v127, v13
    v_mov_b32 v208, 0
    v_mov_b32 v209, 0
    v_mov_b32 v210, 0
    v_mov_b32 v211, 0
    v_mov_b32 v212, 0
    v_mov_b32 v213, 0
    v_mov_b32 v214, 0
    v_mov_b32 v215, 0
    s_barrier
    s_lshl_b32 s46, s9, 17
    s_lshl_b32 s31, s3, 12
    s_add_u32 s46, s46, s31
    s_add_u32 s46, s46, 9437184
    s_lshl_b32 s28, s9, 16
    s_add_u32 s29, s28, 16384
    s_add_u32 s28, s28, 49152
    s_add_u32 m0, s29, s31
    s_nop 0
    buffer_load_dwordx4 v4, s[20:23], s46 offen offset:0 lds
    buffer_load_dwordx4 v4, s[20:23], s46 offen offset:1024 lds
    buffer_load_dwordx4 v4, s[20:23], s46 offen offset:2048 lds
    buffer_load_dwordx4 v4, s[20:23], s46 offen offset:3072 lds
    s_add_u32 s46, s46, 16384
    s_add_u32 m0, s28, s31
    s_nop 0
    buffer_load_dwordx4 v4, s[20:23], s46 offen offset:0 lds
    buffer_load_dwordx4 v4, s[20:23], s46 offen offset:1024 lds
    buffer_load_dwordx4 v4, s[20:23], s46 offen offset:2048 lds
    buffer_load_dwordx4 v4, s[20:23], s46 offen offset:3072 lds
    s_add_u32 s46, s46, 16384
    s_waitcnt vmcnt(0)
    s_barrier
    s_branch L_ka_attn_kernel_main_10
L_ka_attn_kernel_fin_13:
    s_waitcnt lgkmcnt(4)
    v_add_f32 v12, v12, v13
    v_rcp_f32 v12, v12
    s_lshl_b32 s19, s43, 16
    s_lshl_b32 s17, s13, 12
    s_add_u32 s19, s19, s17
    s_lshl_b32 s17, s9, 11
    s_add_u32 s19, s19, s17
    s_add_u32 s16, s19, 10485760
    s_waitcnt lgkmcnt(2)
    v_pk_add_f32 v[176:177], v[176:177], v[128:129]
    v_pk_add_f32 v[178:179], v[178:179], v[130:131]
    v_pk_add_f32 v[180:181], v[180:181], v[132:133]
    v_pk_add_f32 v[182:183], v[182:183], v[134:135]
    v_pk_mul_f32 v[176:177], v[176:177], v[12:13] op_sel_hi:[1,0]
    v_pk_mul_f32 v[178:179], v[178:179], v[12:13] op_sel_hi:[1,0]
    v_pk_mul_f32 v[180:181], v[180:181], v[12:13] op_sel_hi:[1,0]
    v_pk_mul_f32 v[182:183], v[182:183], v[12:13] op_sel_hi:[1,0]
    v_cvt_pk_bf16_f32 v176, v176, v177
    v_cvt_pk_bf16_f32 v177, v178, v179
    v_cvt_pk_bf16_f32 v178, v180, v181
    v_cvt_pk_bf16_f32 v179, v182, v183
    buffer_store_dwordx4 v[176:179], v4, s[20:23], s16 offen offset:0 sc1
    s_waitcnt lgkmcnt(0)
    v_pk_add_f32 v[184:185], v[184:185], v[136:137]
    v_pk_add_f32 v[186:187], v[186:187], v[138:139]
    v_pk_add_f32 v[188:189], v[188:189], v[140:141]
    v_pk_add_f32 v[190:191], v[190:191], v[142:143]
    v_pk_mul_f32 v[184:185], v[184:185], v[12:13] op_sel_hi:[1,0]
    v_pk_mul_f32 v[186:187], v[186:187], v[12:13] op_sel_hi:[1,0]
    v_pk_mul_f32 v[188:189], v[188:189], v[12:13] op_sel_hi:[1,0]
    v_pk_mul_f32 v[190:191], v[190:191], v[12:13] op_sel_hi:[1,0]
    v_cvt_pk_bf16_f32 v184, v184, v185
    v_cvt_pk_bf16_f32 v185, v186, v187
    v_cvt_pk_bf16_f32 v186, v188, v189
    v_cvt_pk_bf16_f32 v187, v190, v191
    buffer_store_dwordx4 v[184:187], v4, s[20:23], s16 offen offset:1024 sc1
    s_cmp_lg_u32 s8, 7
    s_cbranch_scc1 L_ka_attn_kernel_e_15
    v_add_u32 v57, 118784, v56
    ds_read2st64_b32 v[48:49], v57 offset0:0 offset1:1
    ds_read2st64_b32 v[50:51], v57 offset0:2 offset1:3
    ds_read2st64_b32 v[52:53], v57 offset0:4 offset1:5
    ds_read2st64_b32 v[54:55], v57 offset0:6 offset1:7
    s_bfe_u32 s16, s2, 0x20001
    s_mul_i32 s16, s16, 24576
    s_bfe_u32 s17, s2, 0x50003
    s_xor_b32 s17, s17, 4
    s_and_b32 s18, s2, 1
    s_lshl_b32 s18, s18, 5
    s_add_u32 s17, s17, s18
    s_lshl_b32 s17, s17, 8
    s_add_u32 s16, s16, s17
    s_add_u32 s16, s16, 8192
    s_waitcnt lgkmcnt(0)
    v_add_f32 v48, v48, v49
    v_add_f32 v50, v50, v51
    v_add_f32 v52, v52, v53
    v_add_f32 v54, v54, v55
    v_add_f32 v48, v48, v50
    v_add_f32 v52, v52, v54
    v_add_f32 v48, v48, v52
    buffer_store_dword v48, v56, s[20:23], s16 offen sc1
L_ka_attn_kernel_e_15:
    v_and_b32 v14, 31, v1
    v_lshlrev_b32 v14, 2, v14
    v_lshrrev_b32 v13, 5, v1
    v_lshlrev_b32 v212, 4, v13
    s_lshl_b32 s16, s9, 7
    v_add_u32 v212, s16, v212
    v_and_b32 v12, 15, v1
    v_lshrrev_b32 v13, 4, v1
    v_mul_u32_u24 v15, 24576, v13
    v_lshl_add_u32 v15, v12, 4, v15
    v_lshl_add_u32 v214, v12, 2, v13
    v_lshlrev_b32 v214, 2, v214
    v_lshlrev_b32 v12, 7, v12
    v_mov_b32 v13, 0
    s_mul_i32 s16, s8, 11
    s_lshr_b32 s16, s16, 5
    s_mul_i32 s16, s16, 3
    s_sub_u32 s16, s8, s16
    s_lshl_b32 s17, s16, 8
    v_add_u32 v213, s17, v214
    s_cmp_eq_u32 s16, 2
    s_cselect_b32 s38, 1.0, 0
    s_lshl_b32 s18, s16, 12
    s_lshl_b32 s17, s13, 8
    s_add_u32 s18, s18, s17
    s_add_u32 s18, s18, 8192
    s_add_u32 s16, s42, 49152
    v_add_u32 v11, s16, v4
    s_lshl_b32 s39, s12, 11
    s_add_u32 s39, s39, 270336
    s_lshl_b32 s17, s13, 7
    s_add_u32 s46, s39, s17
    s_lshl_b32 s40, s43, 16
    s_lshl_b32 s16, s9, 15
    s_add_u32 s40, s40, s16
    s_add_u32 s40, s40, 10485760
    s_waitcnt vmcnt(0) lgkmcnt(0)
    s_barrier
    s_cmp_lg_u32 s8, 0
    s_cbranch_scc1 L_ka_attn_kernel_d_16
    buffer_store_dword v13, v14, s[20:23], s46 offen sc0 sc1
L_ka_attn_kernel_d_16:
    ds_write_b128 v11, v[24:27] offset:0
    ds_write_b128 v11, v[28:31] offset:1024
    ds_write_b128 v11, v[32:35] offset:2048
    ds_write_b128 v11, v[36:39] offset:3072
    s_cmp_lg_u32 s8, 7
    s_cbranch_scc1 L_ka_attn_kernel_f_17
    s_mov_b32 s44, 0
L_ka_attn_kernel_poll_18:
    buffer_load_dword v14, v12, s[20:23], s39 offen sc0 sc1
    s_add_u32 s44, s44, 1
    s_cmp_gt_u32 s44, 4000
    s_cbranch_scc1 L_ka_attn_kernel_got_19
    s_waitcnt vmcnt(0)
    v_cmp_eq_u32 vcc, -1, v14
    s_cbranch_vccnz L_ka_attn_kernel_poll_18
L_ka_attn_kernel_got_19:
L_ka_attn_kernel_f_17:
    s_waitcnt lgkmcnt(0)
    s_barrier
    buffer_load_dwordx4 v[80:83], v4, s[20:23], s40 offen offset:0
    buffer_load_dwordx4 v[84:87], v4, s[20:23], s40 offen offset:1024
    buffer_load_dwordx4 v[88:91], v4, s[20:23], s40 offen offset:2048
    buffer_load_dwordx4 v[92:95], v4, s[20:23], s40 offen offset:3072
    s_add_u32 s40, s40, 4096
    buffer_load_dwordx4 v[96:99], v4, s[20:23], s40 offen offset:0
    buffer_load_dwordx4 v[100:103], v4, s[20:23], s40 offen offset:1024
    buffer_load_dwordx4 v[104:107], v4, s[20:23], s40 offen offset:2048
    buffer_load_dwordx4 v[108:111], v4, s[20:23], s40 offen offset:3072
    s_add_u32 s40, s40, 4096
    buffer_load_dwordx4 v[112:115], v4, s[20:23], s40 offen offset:0
    buffer_load_dwordx4 v[116:119], v4, s[20:23], s40 offen offset:1024
    buffer_load_dwordx4 v[120:123], v4, s[20:23], s40 offen offset:2048
    ds_read_b64_tr_b16 v[176:177], v9 offset:0
    ds_read_b64_tr_b16 v[178:179], v9 offset:1024
    ds_read_b64_tr_b16 v[180:181], v10 offset:0
    ds_read_b64_tr_b16 v[182:183], v10 offset:1024
    ds_read_b64_tr_b16 v[184:185], v9 offset:2048
    ds_read_b64_tr_b16 v[186:187], v9 offset:3072
    ds_read_b64_tr_b16 v[188:189], v10 offset:2048
    ds_read_b64_tr_b16 v[190:191], v10 offset:3072
    s_waitcnt vmcnt(10) lgkmcnt(4)
    v_mfma_f32_32x32x16_bf16 v[128:143], v[176:179], v[80:83], 0
    ds_read_b64_tr_b16 v[192:193], v9 offset:4096
    ds_read_b64_tr_b16 v[194:195], v9 offset:5120
    buffer_load_dwordx4 v[124:127], v4, s[20:23], s40 offen offset:3072
    v_mfma_f32_32x32x16_bf16 v[144:159], v[180:183], v[80:83], 0
    ds_read_b64_tr_b16 v[196:197], v10 offset:4096
    ds_read_b64_tr_b16 v[198:199], v10 offset:5120
    s_waitcnt vmcnt(10) lgkmcnt(4)
    v_mfma_f32_32x32x16_bf16 v[128:143], v[184:187], v[84:87], v[128:143]
    ds_read_b64_tr_b16 v[200:201], v9 offset:6144
    ds_read_b64_tr_b16 v[202:203], v9 offset:7168
    s_add_u32 s40, s40, 4096
    buffer_load_dwordx4 v[160:163], v4, s[20:23], s40 offen offset:0
    v_mfma_f32_32x32x16_bf16 v[144:159], v[188:191], v[84:87], v[144:159]
    ds_read_b64_tr_b16 v[204:205], v10 offset:6144
    ds_read_b64_tr_b16 v[206:207], v10 offset:7168
    s_waitcnt vmcnt(10) lgkmcnt(4)
    v_mfma_f32_32x32x16_bf16 v[128:143], v[192:195], v[88:91], v[128:143]
    ds_read_b64_tr_b16 v[176:177], v9 offset:8192
    ds_read_b64_tr_b16 v[178:179], v9 offset:9216
    buffer_load_dwordx4 v[164:167], v4, s[20:23], s40 offen offset:1024
    v_mfma_f32_32x32x16_bf16 v[144:159], v[196:199], v[88:91], v[144:159]
    ds_read_b64_tr_b16 v[180:181], v10 offset:8192
    ds_read_b64_tr_b16 v[182:183], v10 offset:9216
    s_waitcnt vmcnt(10) lgkmcnt(4)
    v_mfma_f32_32x32x16_bf16 v[128:143], v[200:203], v[92:95], v[128:143]
    ds_read_b64_tr_b16 v[184:185], v9 offset:10240
    ds_read_b64_tr_b16 v[186:187], v9 offset:11264
    buffer_load_dwordx4 v[168:171], v4, s[20:23], s40 offen offset:2048
    v_mfma_f32_32x32x16_bf16 v[144:159], v[204:207], v[92:95], v[144:159]
    ds_read_b64_tr_b16 v[188:189], v10 offset:10240
    ds_read_b64_tr_b16 v[190:191], v10 offset:11264
    s_waitcnt vmcnt(10) lgkmcnt(4)
    v_mfma_f32_32x32x16_bf16 v[128:143], v[176:179], v[96:99], v[128:143]
    ds_read_b64_tr_b16 v[192:193], v9 offset:12288
    ds_read_b64_tr_b16 v[194:195], v9 offset:13312
    buffer_load_dwordx4 v[172:175], v4, s[20:23], s40 offen offset:3072
    v_mfma_f32_32x32x16_bf16 v[144:159], v[180:183], v[96:99], v[144:159]
    ds_read_b64_tr_b16 v[196:197], v10 offset:12288
    ds_read_b64_tr_b16 v[198:199], v10 offset:13312
    s_waitcnt vmcnt(10) lgkmcnt(4)
    v_mfma_f32_32x32x16_bf16 v[128:143], v[184:187], v[100:103], v[128:143]
    ds_read_b64_tr_b16 v[200:201], v9 offset:14336
    ds_read_b64_tr_b16 v[202:203], v9 offset:15360
    s_add_u32 s40, s40, 4096
    buffer_load_dwordx4 v[80:83], v4, s[20:23], s40 offen offset:0
    v_mfma_f32_32x32x16_bf16 v[144:159], v[188:191], v[100:103], v[144:159]
    ds_read_b64_tr_b16 v[204:205], v10 offset:14336
    ds_read_b64_tr_b16 v[206:207], v10 offset:15360
    s_waitcnt vmcnt(10) lgkmcnt(4)
    v_mfma_f32_32x32x16_bf16 v[128:143], v[192:195], v[104:107], v[128:143]
    ds_read_b64_tr_b16 v[176:177], v9 offset:16384
    ds_read_b64_tr_b16 v[178:179], v9 offset:17408
    buffer_load_dwordx4 v[84:87], v4, s[20:23], s40 offen offset:1024
    v_mfma_f32_32x32x16_bf16 v[144:159], v[196:199], v[104:107], v[144:159]
    ds_read_b64_tr_b16 v[180:181], v10 offset:16384
    ds_read_b64_tr_b16 v[182:183], v10 offset:17408
    s_waitcnt vmcnt(10) lgkmcnt(4)
    v_mfma_f32_32x32x16_bf16 v[128:143], v[200:203], v[108:111], v[128:143]
    ds_read_b64_tr_b16 v[184:185], v9 offset:18432
    ds_read_b64_tr_b16 v[186:187], v9 offset:19456
    buffer_load_dwordx4 v[88:91], v4, s[20:23], s40 offen offset:2048
    v_mfma_f32_32x32x16_bf16 v[144:159], v[204:207], v[108:111], v[144:159]
    ds_read_b64_tr_b16 v[188:189], v10 offset:18432
    ds_read_b64_tr_b16 v[190:191], v10 offset:19456
    s_waitcnt vmcnt(10) lgkmcnt(4)
    v_mfma_f32_32x32x16_bf16 v[128:143], v[176:179], v[112:115], v[128:143]
    ds_read_b64_tr_b16 v[192:193], v9 offset:20480
    ds_read_b64_tr_b16 v[194:195], v9 offset:21504
    buffer_load_dwordx4 v[92:95], v4, s[20:23], s40 offen offset:3072
    v_mfma_f32_32x32x16_bf16 v[144:159], v[180:183], v[112:115], v[144:159]
    ds_read_b64_tr_b16 v[196:197], v10 offset:20480
    ds_read_b64_tr_b16 v[198:199], v10 offset:21504
    s_waitcnt vmcnt(10) lgkmcnt(4)
    v_mfma_f32_32x32x16_bf16 v[128:143], v[184:187], v[116:119], v[128:143]
    ds_read_b64_tr_b16 v[200:201], v9 offset:22528
    ds_read_b64_tr_b16 v[202:203], v9 offset:23552
    s_add_u32 s40, s40, 4096
    buffer_load_dwordx4 v[96:99], v4, s[20:23], s40 offen offset:0
    v_mfma_f32_32x32x16_bf16 v[144:159], v[188:191], v[116:119], v[144:159]
    ds_read_b64_tr_b16 v[204:205], v10 offset:22528
    ds_read_b64_tr_b16 v[206:207], v10 offset:23552
    s_waitcnt vmcnt(10) lgkmcnt(4)
    v_mfma_f32_32x32x16_bf16 v[128:143], v[192:195], v[120:123], v[128:143]
    ds_read_b64_tr_b16 v[176:177], v9 offset:24576
    ds_read_b64_tr_b16 v[178:179], v9 offset:25600
    buffer_load_dwordx4 v[100:103], v4, s[20:23], s40 offen offset:1024
    v_mfma_f32_32x32x16_bf16 v[144:159], v[196:199], v[120:123], v[144:159]
    ds_read_b64_tr_b16 v[180:181], v10 offset:24576
    ds_read_b64_tr_b16 v[182:183], v10 offset:25600
    buffer_load_dwordx4 v[208:211], v15, s[20:23], s18 offen sc0 sc1
    s_waitcnt vmcnt(11) lgkmcnt(4)
    v_mfma_f32_32x32x16_bf16 v[128:143], v[200:203], v[124:127], v[128:143]
    ds_read_b64_tr_b16 v[184:185], v9 offset:26624
    ds_read_b64_tr_b16 v[186:187], v9 offset:27648
    buffer_load_dwordx4 v[104:107], v4, s[20:23], s40 offen offset:2048
    v_mfma_f32_32x32x16_bf16 v[144:159], v[204:207], v[124:127], v[144:159]
    ds_read_b64_tr_b16 v[188:189], v10 offset:26624
    ds_read_b64_tr_b16 v[190:191], v10 offset:27648
    s_waitcnt vmcnt(11) lgkmcnt(4)
    v_mfma_f32_32x32x16_bf16 v[128:143], v[176:179], v[160:163], v[128:143]
    ds_read_b64_tr_b16 v[192:193], v9 offset:28672
    ds_read_b64_tr_b16 v[194:195], v9 offset:29696
    buffer_load_dwordx4 v[108:111], v4, s[20:23], s40 offen offset:3072
    v_mfma_f32_32x32x16_bf16 v[144:159], v[180:183], v[160:163], v[144:159]
    ds_read_b64_tr_b16 v[196:197], v10 offset:28672
    ds_read_b64_tr_b16 v[198:199], v10 offset:29696
    s_waitcnt vmcnt(11) lgkmcnt(4)
    v_mfma_f32_32x32x16_bf16 v[128:143], v[184:187], v[164:167], v[128:143]
    ds_read_b64_tr_b16 v[200:201], v9 offset:30720
    ds_read_b64_tr_b16 v[202:203], v9 offset:31744
    s_add_u32 s40, s40, 4096
    buffer_load_dwordx4 v[112:115], v4, s[20:23], s40 offen offset:0
    v_mfma_f32_32x32x16_bf16 v[144:159], v[188:191], v[164:167], v[144:159]
    ds_read_b64_tr_b16 v[204:205], v10 offset:30720
    ds_read_b64_tr_b16 v[206:207], v10 offset:31744
    s_waitcnt vmcnt(11) lgkmcnt(4)
    v_mfma_f32_32x32x16_bf16 v[128:143], v[192:195], v[168:171], v[128:143]
    ds_read_b64_tr_b16 v[176:177], v9 offset:32768
    ds_read_b64_tr_b16 v[178:179], v9 offset:33792
    buffer_load_dwordx4 v[116:119], v4, s[20:23], s40 offen offset:1024
    v_mfma_f32_32x32x16_bf16 v[144:159], v[196:199], v[168:171], v[144:159]
    ds_read_b64_tr_b16 v[180:181], v10 offset:32768
    ds_read_b64_tr_b16 v[182:183], v10 offset:33792
    s_waitcnt vmcnt(11) lgkmcnt(4)
    v_mfma_f32_32x32x16_bf16 v[128:143], v[200:203], v[172:175], v[128:143]
    ds_read_b64_tr_b16 v[184:185], v9 offset:34816
    ds_read_b64_tr_b16 v[186:187], v9 offset:35840
    buffer_load_dwordx4 v[120:123], v4, s[20:23], s40 offen offset:2048
    v_mfma_f32_32x32x16_bf16 v[144:159], v[204:207], v[172:175], v[144:159]
    ds_read_b64_tr_b16 v[188:189], v10 offset:34816
    ds_read_b64_tr_b16 v[190:191], v10 offset:35840
    s_waitcnt vmcnt(11) lgkmcnt(4)
    v_mfma_f32_32x32x16_bf16 v[128:143], v[176:179], v[80:83], v[128:143]
    ds_read_b64_tr_b16 v[192:193], v9 offset:36864
    ds_read_b64_tr_b16 v[194:195], v9 offset:37888
    buffer_load_dwordx4 v[124:127], v4, s[20:23], s40 offen offset:3072
    v_mfma_f32_32x32x16_bf16 v[144:159], v[180:183], v[80:83], v[144:159]
    ds_read_b64_tr_b16 v[196:197], v10 offset:36864
    ds_read_b64_tr_b16 v[198:199], v10 offset:37888
    s_waitcnt vmcnt(11) lgkmcnt(4)
    v_mfma_f32_32x32x16_bf16 v[128:143], v[184:187], v[84:87], v[128:143]
    ds_read_b64_tr_b16 v[200:201], v9 offset:38912
    ds_read_b64_tr_b16 v[202:203], v9 offset:39936
    s_add_u32 s40, s40, 4096
    buffer_load_dwordx4 v[160:163], v4, s[20:23], s40 offen offset:0
    v_mfma_f32_32x32x16_bf16 v[144:159], v[188:191], v[84:87], v[144:159]
    ds_read_b64_tr_b16 v[204:205], v10 offset:38912
    ds_read_b64_tr_b16 v[206:207], v10 offset:39936
    s_waitcnt vmcnt(11) lgkmcnt(4)
    v_mfma_f32_32x32x16_bf16 v[128:143], v[192:195], v[88:91], v[128:143]
    ds_read_b64_tr_b16 v[176:177], v9 offset:40960
    ds_read_b64_tr_b16 v[178:179], v9 offset:41984
    buffer_load_dwordx4 v[164:167], v4, s[20:23], s40 offen offset:1024
    v_mfma_f32_32x32x16_bf16 v[144:159], v[196:199], v[88:91], v[144:159]
    ds_read_b64_tr_b16 v[180:181], v10 offset:40960
    ds_read_b64_tr_b16 v[182:183], v10 offset:41984
    s_waitcnt vmcnt(11) lgkmcnt(4)
    v_mfma_f32_32x32x16_bf16 v[128:143], v[200:203], v[92:95], v[128:143]
    ds_read_b64_tr_b16 v[184:185], v9 offset:43008
    ds_read_b64_tr_b16 v[186:187], v9 offset:44032
    buffer_load_dwordx4 v[168:171], v4, s[20:23], s40 offen offset:2048
    v_mfma_f32_32x32x16_bf16 v[144:159], v[204:207], v[92:95], v[144:159]
    ds_read_b64_tr_b16 v[188:189], v10 offset:43008
    ds_read_b64_tr_b16 v[190:191], v10 offset:44032
    s_waitcnt vmcnt(11) lgkmcnt(4)
    v_mfma_f32_32x32x16_bf16 v[128:143], v[176:179], v[96:99], v[128:143]
    ds_read_b64_tr_b16 v[192:193], v9 offset:45056
    ds_read_b64_tr_b16 v[194:195], v9 offset:46080
    buffer_load_dwordx4 v[172:175], v4, s[20:23], s40 offen offset:3072
    v_mfma_f32_32x32x16_bf16 v[144:159], v[180:183], v[96:99], v[144:159]
    ds_read_b64_tr_b16 v[196:197], v10 offset:45056
    ds_read_b64_tr_b16 v[198:199], v10 offset:46080
    s_waitcnt vmcnt(11) lgkmcnt(4)
    v_mfma_f32_32x32x16_bf16 v[128:143], v[184:187], v[100:103], v[128:143]
    ds_read_b64_tr_b16 v[200:201], v9 offset:47104
    ds_read_b64_tr_b16 v[202:203], v9 offset:48128
    v_mfma_f32_32x32x16_bf16 v[144:159], v[188:191], v[100:103], v[144:159]
    ds_read_b64_tr_b16 v[204:205], v10 offset:47104
    ds_read_b64_tr_b16 v[206:207], v10 offset:48128
    s_waitcnt vmcnt(9) lgkmcnt(4)
    v_mfma_f32_32x32x16_bf16 v[128:143], v[192:195], v[104:107], v[128:143]
    ds_read_b64_tr_b16 v[176:177], v9 offset:49152
    ds_read_b64_tr_b16 v[178:179], v9 offset:50176
    v_mfma_f32_32x32x16_bf16 v[144:159], v[196:199], v[104:107], v[144:159]
    ds_read_b64_tr_b16 v[180:181], v10 offset:49152
    ds_read_b64_tr_b16 v[182:183], v10 offset:50176
    s_barrier
    v_max3_u32 v14, v208, v209, v210
    v_max_u32 v14, v14, v211
    v_cmp_eq_u32 vcc, -1, v14
    s_cbranch_vccz L_ka_attn_kernel_mok_21
    s_mov_b32 s44, 0
L_ka_attn_kernel_mp_20:
    buffer_load_dwordx4 v[208:211], v15, s[20:23], s18 offen sc0 sc1
    s_add_u32 s44, s44, 1
    s_waitcnt vmcnt(0)
    s_cmp_gt_u32 s44, 4000
    s_cbranch_scc1 L_ka_attn_kernel_mok_21
    v_max3_u32 v14, v208, v209, v210
    v_max_u32 v14, v14, v211
    v_cmp_eq_u32 vcc, -1, v14
    s_cbranch_vccnz L_ka_attn_kernel_mp_20
L_ka_attn_kernel_mok_21:
    v_permlane32_swap_b32 v208, v210
    v_permlane32_swap_b32 v209, v211
    v_add_f32 v208, v208, v210
    v_add_f32 v209, v209, v211
    s_nop 1
    v_permlane16_swap_b32 v208, v209
    v_add_f32 v208, v208, v209
    v_cvt_pk_bf16_f32 v208, v208, v208
    v_lshlrev_b32 v208, 16, v208
    v_add_f32 v208, s38, v208
    v_cvt_pk_bf16_f32 v208, v208, v208
    v_lshlrev_b32 v208, 16, v208
    ds_write_b32 v213, v208
    s_waitcnt vmcnt(8) lgkmcnt(5)
    v_mfma_f32_32x32x16_bf16 v[128:143], v[200:203], v[108:111], v[128:143]
    ds_read_b64_tr_b16 v[184:185], v9 offset:51200
    ds_read_b64_tr_b16 v[186:187], v9 offset:52224
    v_mfma_f32_32x32x16_bf16 v[144:159], v[204:207], v[108:111], v[144:159]
    ds_read_b64_tr_b16 v[188:189], v10 offset:51200
    ds_read_b64_tr_b16 v[190:191], v10 offset:52224
    s_waitcnt vmcnt(7) lgkmcnt(5)
    v_mfma_f32_32x32x16_bf16 v[128:143], v[176:179], v[112:115], v[128:143]
    ds_read_b64_tr_b16 v[192:193], v9 offset:53248
    ds_read_b64_tr_b16 v[194:195], v9 offset:54272
    v_mfma_f32_32x32x16_bf16 v[144:159], v[180:183], v[112:115], v[144:159]
    ds_read_b64_tr_b16 v[196:197], v10 offset:53248
    ds_read_b64_tr_b16 v[198:199], v10 offset:54272
    s_waitcnt vmcnt(6) lgkmcnt(4)
    v_mfma_f32_32x32x16_bf16 v[128:143], v[184:187], v[116:119], v[128:143]
    ds_read_b64_tr_b16 v[200:201], v9 offset:55296
    ds_read_b64_tr_b16 v[202:203], v9 offset:56320
    v_mfma_f32_32x32x16_bf16 v[144:159], v[188:191], v[116:119], v[144:159]
    ds_read_b64_tr_b16 v[204:205], v10 offset:55296
    ds_read_b64_tr_b16 v[206:207], v10 offset:56320
    s_waitcnt vmcnt(5) lgkmcnt(4)
    v_mfma_f32_32x32x16_bf16 v[128:143], v[192:195], v[120:123], v[128:143]
    ds_read_b64_tr_b16 v[176:177], v9 offset:57344
    ds_read_b64_tr_b16 v[178:179], v9 offset:58368
    v_mfma_f32_32x32x16_bf16 v[144:159], v[196:199], v[120:123], v[144:159]
    ds_read_b64_tr_b16 v[180:181], v10 offset:57344
    ds_read_b64_tr_b16 v[182:183], v10 offset:58368
    s_waitcnt vmcnt(4) lgkmcnt(4)
    v_mfma_f32_32x32x16_bf16 v[128:143], v[200:203], v[124:127], v[128:143]
    ds_read_b64_tr_b16 v[184:185], v9 offset:59392
    ds_read_b64_tr_b16 v[186:187], v9 offset:60416
    v_mfma_f32_32x32x16_bf16 v[144:159], v[204:207], v[124:127], v[144:159]
    ds_read_b64_tr_b16 v[188:189], v10 offset:59392
    ds_read_b64_tr_b16 v[190:191], v10 offset:60416
    s_waitcnt vmcnt(3) lgkmcnt(4)
    v_mfma_f32_32x32x16_bf16 v[128:143], v[176:179], v[160:163], v[128:143]
    ds_read_b64_tr_b16 v[192:193], v9 offset:61440
    ds_read_b64_tr_b16 v[194:195], v9 offset:62464
    v_mfma_f32_32x32x16_bf16 v[144:159], v[180:183], v[160:163], v[144:159]
    ds_read_b64_tr_b16 v[196:197], v10 offset:61440
    ds_read_b64_tr_b16 v[198:199], v10 offset:62464
    s_waitcnt vmcnt(2) lgkmcnt(4)
    v_mfma_f32_32x32x16_bf16 v[128:143], v[184:187], v[164:167], v[128:143]
    ds_read_b64_tr_b16 v[200:201], v9 offset:63488
    ds_read_b64_tr_b16 v[202:203], v9 offset:64512
    v_mfma_f32_32x32x16_bf16 v[144:159], v[188:191], v[164:167], v[144:159]
    ds_read_b64_tr_b16 v[204:205], v10 offset:63488
    ds_read_b64_tr_b16 v[206:207], v10 offset:64512
    s_waitcnt vmcnt(1) lgkmcnt(4)
    v_mfma_f32_32x32x16_bf16 v[128:143], v[192:195], v[168:171], v[128:143]
    v_mfma_f32_32x32x16_bf16 v[144:159], v[196:199], v[168:171], v[144:159]
    s_waitcnt vmcnt(0) lgkmcnt(0)
    v_mfma_f32_32x32x16_bf16 v[128:143], v[200:203], v[172:175], v[128:143]
    v_mfma_f32_32x32x16_bf16 v[144:159], v[204:207], v[172:175], v[144:159]
    s_nop 11
    ds_write_b128 v3, v[144:147] offset:0
    ds_write_b128 v3, v[148:151] offset:1024
    ds_write_b128 v3, v[152:155] offset:2048
    ds_write_b128 v3, v[156:159] offset:3072
    s_waitcnt lgkmcnt(0)
    s_barrier
    ds_read_b128 v[144:147], v2 offset:0
    ds_read_b128 v[148:151], v2 offset:1024
    ds_read_b128 v[152:155], v2 offset:2048
    ds_read_b128 v[156:159], v2 offset:3072
    ds_read_b128 v[24:27], v212 offset:0
    ds_read_b128 v[28:31], v212 offset:32
    ds_read_b128 v[32:35], v212 offset:64
    ds_read_b128 v[36:39], v212 offset:96
    v_mov_b32 v5, 0x3f803f80
    v_lshlrev_b32 v11, 2, v1
    s_lshl_b32 s17, s43, 12
    s_add_u32 s17, s17, 524288
    s_lshl_b32 s16, s9, 11
    s_add_u32 s16, s16, s17
    s_lshl_b32 s37, s13, 8
    s_add_u32 s17, s17, s37
    s_add_u32 s18, s19, 14680064
    s_add_u32 s19, s19, 18874368
    s_lshl_b32 s37, s8, 8
    s_add_u32 s37, s37, 2048
    v_add_u32 v12, s37, v11
    v_xor_b32 v13, 0x400, v12
    v_add_u32 v214, s37, v214
    s_waitcnt lgkmcnt(3)
    v_lshlrev_b32 v14, 16, v16
    v_and_b32 v15, 0xffff0000, v16
    v_pk_add_f32 v[128:129], v[128:129], v[144:145]
    v_pk_fma_f32 v[14:15], v[128:129], v[24:25], v[14:15]
    v_cvt_pk_bf16_f32 v72, v14, v15
    v_lshlrev_b32 v14, 16, v17
    v_and_b32 v15, 0xffff0000, v17
    v_pk_add_f32 v[130:131], v[130:131], v[146:147]
    v_pk_fma_f32 v[14:15], v[130:131], v[26:27], v[14:15]
    v_dot2_f32_bf16 v6, v72, v5, 0
    v_dot2_f32_bf16 v8, v72, v72, 0
    v_cvt_pk_bf16_f32 v73, v14, v15
    s_waitcnt lgkmcnt(2)
    v_lshlrev_b32 v14, 16, v18
    v_and_b32 v15, 0xffff0000, v18
    v_pk_add_f32 v[132:133], v[132:133], v[148:149]
    v_pk_fma_f32 v[14:15], v[132:133], v[28:29], v[14:15]
    v_dot2_f32_bf16 v7, v73, v5, 0
    v_dot2_f32_bf16 v9, v73, v73, 0
    v_cvt_pk_bf16_f32 v74, v14, v15
    v_lshlrev_b32 v14, 16, v19
    v_and_b32 v15, 0xffff0000, v19
    v_pk_add_f32 v[134:135], v[134:135], v[150:151]
    v_pk_fma_f32 v[14:15], v[134:135], v[30:31], v[14:15]
    v_dot2_f32_bf16 v6, v74, v5, v6
    v_dot2_f32_bf16 v8, v74, v74, v8
    v_cvt_pk_bf16_f32 v75, v14, v15
    s_waitcnt lgkmcnt(1)
    v_lshlrev_b32 v14, 16, v20
    v_and_b32 v15, 0xffff0000, v20
    v_pk_add_f32 v[136:137], v[136:137], v[152:153]
    v_pk_fma_f32 v[14:15], v[136:137], v[32:33], v[14:15]
    v_dot2_f32_bf16 v7, v75, v5, v7
    v_dot2_f32_bf16 v9, v75, v75, v9
    v_cvt_pk_bf16_f32 v76, v14, v15
    v_lshlrev_b32 v14, 16, v21
    v_and_b32 v15, 0xffff0000, v21
    v_pk_add_f32 v[138:139], v[138:139], v[154:155]
    v_pk_fma_f32 v[14:15], v[138:139], v[34:35], v[14:15]
    v_dot2_f32_bf16 v6, v76, v5, v6
    v_dot2_f32_bf16 v8, v76, v76, v8
    v_cvt_pk_bf16_f32 v77, v14, v15
    s_waitcnt lgkmcnt(0)
    v_lshlrev_b32 v14, 16, v22
    v_and_b32 v15, 0xffff0000, v22
    v_pk_add_f32 v[140:141], v[140:141], v[156:157]
    v_pk_fma_f32 v[14:15], v[140:141], v[36:37], v[14:15]
    v_dot2_f32_bf16 v7, v77, v5, v7
    v_dot2_f32_bf16 v9, v77, v77, v9
    v_cvt_pk_bf16_f32 v78, v14, v15
    v_lshlrev_b32 v14, 16, v23
    v_and_b32 v15, 0xffff0000, v23
    v_pk_add_f32 v[142:143], v[142:143], v[158:159]
    v_pk_fma_f32 v[14:15], v[142:143], v[38:39], v[14:15]
    v_dot2_f32_bf16 v6, v78, v5, v6
    v_dot2_f32_bf16 v8, v78, v78, v8
    v_cvt_pk_bf16_f32 v79, v14, v15
    v_dot2_f32_bf16 v7, v79, v5, v7
    v_dot2_f32_bf16 v9, v79, v79, v9
    buffer_store_dwordx4 v[72:75], v4, s[20:23], s18 offen offset:0 sc1
    buffer_store_dwordx4 v[76:79], v4, s[20:23], s18 offen offset:1024 sc1
    s_nop 0
    v_add_f32 v6, v6, v7
    v_add_f32 v8, v8, v9
    s_nop 1
    v_permlane32_swap_b32 v6, v8
    v_add_f32 v6, v6, v8
    ds_write_b32 v12, v6
    s_waitcnt lgkmcnt(0)
    s_barrier
    s_cmp_lg_u32 s9, 0
    s_cbranch_scc1 L_ka_attn_kernel_s_22
    ds_read_b32 v7, v13
    s_waitcnt lgkmcnt(0)
    v_add_f32 v6, v6, v7
    buffer_store_dword v6, v11, s[20:23], s17 offen sc0 sc1
L_ka_attn_kernel_s_22:
    ds_read_b128 v[40:43], v212 offset:512
    ds_read_b128 v[44:47], v212 offset:544
    ds_read_b128 v[48:51], v212 offset:576
    ds_read_b128 v[52:55], v212 offset:608
    ds_read_b128 v[56:59], v212 offset:256
    ds_read_b128 v[60:63], v212 offset:288
    ds_read_b128 v[64:67], v212 offset:320
    ds_read_b128 v[68:71], v212 offset:352
    v_lshlrev_b32 v128, 16, v72
    v_and_b32 v129, 0xffff0000, v72
    v_lshlrev_b32 v130, 16, v73
    v_and_b32 v131, 0xffff0000, v73
    v_lshlrev_b32 v132, 16, v74
    v_and_b32 v133, 0xffff0000, v74
    v_lshlrev_b32 v134, 16, v75
    v_and_b32 v135, 0xffff0000, v75
    v_lshlrev_b32 v136, 16, v76
    v_and_b32 v137, 0xffff0000, v76
    v_lshlrev_b32 v138, 16, v77
    v_and_b32 v139, 0xffff0000, v77
    v_lshlrev_b32 v140, 16, v78
    v_and_b32 v141, 0xffff0000, v78
    v_lshlrev_b32 v142, 16, v79
    v_and_b32 v143, 0xffff0000, v79
    s_mov_b32 s44, 0
    s_waitcnt vmcnt(0)
    buffer_load_dwordx4 v[176:179], v4, s[20:23], s16 offen offset:0
    buffer_load_dwordx4 v[180:183], v4, s[20:23], s16 offen offset:1024
    s_waitcnt vmcnt(0)
    v_max3_u32 v6, v176, v177, v178
    v_max3_u32 v7, v179, v180, v181
    v_max3_u32 v6, v6, v182, v183
    v_max_u32 v6, v6, v7
    v_cmp_eq_u32 vcc, -1, v6
    s_cbranch_vccz L_ka_attn_kernel_got_24
L_ka_attn_kernel_poll_23:
    buffer_load_dwordx4 v[176:179], v4, s[20:23], s16 offen offset:0 sc0 sc1
    buffer_load_dwordx4 v[180:183], v4, s[20:23], s16 offen offset:1024 sc0 sc1
    s_add_u32 s44, s44, 1
    s_cmp_gt_u32 s44, 4000
    s_cbranch_scc1 L_ka_attn_kernel_got_24
    s_waitcnt vmcnt(0)
    v_max3_u32 v6, v176, v177, v178
    v_max3_u32 v7, v179, v180, v181
    v_max3_u32 v6, v6, v182, v183
    v_max_u32 v6, v6, v7
    v_cmp_eq_u32 vcc, -1, v6
    s_cbranch_vccnz L_ka_attn_kernel_poll_23
L_ka_attn_kernel_got_24:
    s_waitcnt vmcnt(0) lgkmcnt(0)
    v_pk_add_f32 v[176:177], v[176:177], v[180:181]
    v_pk_add_f32 v[178:179], v[178:179], v[182:183]
    s_nop 1
    v_permlane32_swap_b32 v176, v178
    v_permlane32_swap_b32 v177, v179
    v_add_f32 v176, v176, v178
    v_add_f32 v177, v177, v179
    s_nop 1
    v_permlane16_swap_b32 v176, v177
    v_add_f32 v6, v176, v177
    ds_write_b32 v214, v6 offset:2048
    s_waitcnt lgkmcnt(0)
    s_barrier
    ds_read_b32 v6, v12 offset:2048
    ds_read_b32 v7, v13 offset:2048
    s_waitcnt lgkmcnt(0)
    v_add_f32 v7, v6, v7
    v_mul_f32 v6, 0x3a800000, v7
    v_mul_f32 v7, 0x3a800000, v7
    s_nop 1
    v_permlane32_swap_b32 v6, v7
    v_fma_f32 v7, -v6, v6, v7
    v_max_f32 v7, 0, v7
    v_add_f32 v7, 0x3727c5ac, v7
    v_rsq_f32 v8, v7
    s_nop 0
    v_mul_f32 v6, -v6, v8
    v_pk_fma_f32 v[128:129], v[128:129], v[8:9], v[6:7] op_sel_hi:[1,0,0]
    v_pk_fma_f32 v[128:129], v[128:129], v[40:41], v[56:57]
    v_cvt_pk_bf16_f32 v16, v128, v129
    v_pk_fma_f32 v[130:131], v[130:131], v[8:9], v[6:7] op_sel_hi:[1,0,0]
    v_pk_fma_f32 v[130:131], v[130:131], v[42:43], v[58:59]
    v_cvt_pk_bf16_f32 v17, v130, v131
    v_pk_fma_f32 v[132:133], v[132:133], v[8:9], v[6:7] op_sel_hi:[1,0,0]
    v_pk_fma_f32 v[132:133], v[132:133], v[44:45], v[60:61]
    v_cvt_pk_bf16_f32 v18, v132, v133
    v_pk_fma_f32 v[134:135], v[134:135], v[8:9], v[6:7] op_sel_hi:[1,0,0]
    v_pk_fma_f32 v[134:135], v[134:135], v[46:47], v[62:63]
    v_cvt_pk_bf16_f32 v19, v134, v135
    buffer_store_dwordx4 v[16:19], v4, s[20:23], s19 offen offset:0 sc1
    v_pk_fma_f32 v[136:137], v[136:137], v[8:9], v[6:7] op_sel_hi:[1,0,0]
    v_pk_fma_f32 v[136:137], v[136:137], v[48:49], v[64:65]
    v_cvt_pk_bf16_f32 v20, v136, v137
    v_pk_fma_f32 v[138:139], v[138:139], v[8:9], v[6:7] op_sel_hi:[1,0,0]
    v_pk_fma_f32 v[138:139], v[138:139], v[50:51], v[66:67]
    v_cvt_pk_bf16_f32 v21, v138, v139
    v_pk_fma_f32 v[140:141], v[140:141], v[8:9], v[6:7] op_sel_hi:[1,0,0]
    v_pk_fma_f32 v[140:141], v[140:141], v[52:53], v[68:69]
    v_cvt_pk_bf16_f32 v22, v140, v141
    v_pk_fma_f32 v[142:143], v[142:143], v[8:9], v[6:7] op_sel_hi:[1,0,0]
    v_pk_fma_f32 v[142:143], v[142:143], v[54:55], v[70:71]
    v_cvt_pk_bf16_f32 v23, v142, v143
    buffer_store_dwordx4 v[20:23], v4, s[20:23], s19 offen offset:1024 sc1
L_ka_attn_kernel_end:
    s_endpgm
.p2align 8
.globl k4_glu_kernel
.type k4_glu_kernel,@function
k4_glu_kernel:
    s_cmp_ge_u32 s2, 256
    s_cbranch_scc1 L_k4_glu_kernel_end
    s_load_dwordx2 s[4:5], s[0:1], 48
    s_load_dwordx2 s[6:7], s[0:1], 56
    s_load_dwordx2 s[8:9], s[0:1], 104
    s_load_dwordx2 s[10:11], s[0:1], 88
    s_load_dwordx2 s[56:57], s[0:1], 64
    v_lshrrev_b32 v2, 6, v0
    v_and_b32 v1, 63, v0
    v_readfirstlane_b32 s3, v2
    s_and_b32 s14, s2, 7
    s_lshr_b32 s15, s2, 3
    s_and_b32 s12, s14, 1
    s_lshl_b32 s12, s12, 2
    s_lshr_b32 s16, s15, 3
    s_add_u32 s12, s12, s16
    s_lshr_b32 s13, s14, 1
    s_lshl_b32 s13, s13, 3
    s_and_b32 s16, s15, 7
    s_add_u32 s13, s13, s16
    v_and_b32 v3, 15, v1
    v_bfe_u32 v5, v1, 4, 1
    v_lshrrev_b32 v6, 5, v1
    v_lshlrev_b32 v4, 4, v3
    v_lshl_add_u32 v4, v5, 9, v4
    v_lshl_add_u32 v4, v6, 10, v4
    s_lshl_b32 s43, s12, 3
    s_lshl_b32 s16, s3, 1
    s_add_u32 s43, s43, s16
    s_lshl_b32 s40, s43, 16
    s_add_u32 s41, s40, 65536
    v_lshrrev_b32 v7, 2, v3
    v_lshl_add_u32 v7, v5, 2, v7
    v_lshl_add_u32 v7, v6, 4, v7
    v_mul_u32_u24 v7, 224, v7
    v_and_b32 v8, 3, v3
    v_lshl_add_u32 v7, v8, 3, v7
    v_add_u32 v7, 49152, v7
    v_add_u32 v8, 57344, v7
    s_and_b32 s16, s3, 1
    s_mul_i32 s17, s16, 229376
    s_mul_i32 s18, s13, 224
    s_add_u32 s17, s17, s18
    s_lshr_b32 s18, s3, 1
    s_mul_i32 s42, s18, 14336
    s_mul_i32 s19, s16, 7168
    s_add_u32 s42, s42, s19
    s_add_u32 s42, s42, 49152
    s_mov_b32 s46, 0
    v_add_u32 v16, 0, v1
    v_mul_u32_u24 v17, 4682, v16
    v_lshrrev_b32 v17, 16, v17
    v_mul_u32_u24 v18, 14, v17
    v_sub_u32 v18, v16, v18
    v_mul_u32_u24 v17, 7168, v17
    v_lshl_add_u32 v17, v18, 4, v17
    v_add_u32 v17, s17, v17
    v_subrev_u32 v9, 0, v17
    v_add_u32 v16, 64, v1
    v_mul_u32_u24 v17, 4682, v16
    v_lshrrev_b32 v17, 16, v17
    v_mul_u32_u24 v18, 14, v17
    v_sub_u32 v18, v16, v18
    v_mul_u32_u24 v17, 7168, v17
    v_lshl_add_u32 v17, v18, 4, v17
    v_add_u32 v17, s17, v17
    v_subrev_u32 v10, 1024, v17
    v_add_u32 v16, 128, v1
    v_mul_u32_u24 v17, 4682, v16
    v_lshrrev_b32 v17, 16, v17
    v_mul_u32_u24 v18, 14, v17
    v_sub_u32 v18, v16, v18
    v_mul_u32_u24 v17, 7168, v17
    v_lshl_add_u32 v17, v18, 4, v17
    v_add_u32 v17, s17, v17
    v_subrev_u32 v11, 2048, v17
    v_add_u32 v16, 192, v1
    v_mul_u32_u24 v17, 4682, v16
    v_lshrrev_b32 v17, 16, v17
    v_mul_u32_u24 v18, 14, v17
    v_sub_u32 v18, v16, v18
    v_mul_u32_u24 v17, 7168, v17
    v_lshl_add_u32 v17, v18, 4, v17
    v_add_u32 v17, s17, v17
    v_subrev_u32 v12, 3072, v17
    v_add_u32 v16, 256, v1
    v_mul_u32_u24 v17, 4682, v16
    v_lshrrev_b32 v17, 16, v17
    v_mul_u32_u24 v18, 14, v17
    v_sub_u32 v18, v16, v18
    v_mul_u32_u24 v17, 7168, v17
    v_lshl_add_u32 v17, v18, 4, v17
    v_add_u32 v17, s17, v17
    v_subrev_u32 v13, 0, v17
    v_add_u32 v16, 320, v1
    v_mul_u32_u24 v17, 4682, v16
    v_lshrrev_b32 v17, 16, v17
    v_mul_u32_u24 v18, 14, v17
    v_sub_u32 v18, v16, v18
    v_mul_u32_u24 v17, 7168, v17
    v_lshl_add_u32 v17, v18, 4, v17
    v_add_u32 v17, s17, v17
    v_subrev_u32 v14, 1024, v17
    v_add_u32 v16, 384, v1
    v_mul_u32_u24 v17, 4682, v16
    v_lshrrev_b32 v17, 16, v17
    v_mul_u32_u24 v18, 14, v17
    v_sub_u32 v18, v16, v18
    v_mul_u32_u24 v17, 7168, v17
    v_lshl_add_u32 v17, v18, 4, v17
    v_add_u32 v17, s17, v17
    v_subrev_u32 v15, 2048, v17
    s_bfe_u32 s53, s2, 65536
    s_lshr_b32 s16, s2, 5
    s_bfe_u32 s54, s2, 65537
    s_lshl_b32 s54, s54, 3
    s_add_u32 s54, s54, s16
    s_bfe_u32 s55, s2, 65538
    s_lshl_b32 s55, s55, 2
    s_bfe_u32 s16, s2, 0x20003
    s_add_u32 s55, s55, s16
    s_mul_i32 s60, s53, 3670016
    s_lshl_b32 s61, s3, 13
    v_lshrrev_b32 v16, 4, v1
    v_lshlrev_b32 v17, 1, v16
    v_xor_b32 v17, v17, v3
    v_lshlrev_b32 v17, 4, v17
    v_lshl_add_u32 v17, v16, 11, v17
    s_lshl_b32 s16, s3, 16
    s_lshl_b32 s17, s55, 8
    s_add_u32 s16, s16, s17
    v_add_u32 v21, s16, v17
    v_xor_b32 v17, 128, v21
    v_add_u32 v22, 7168, v17
    v_add_u32 v23, 14336, v21
    v_add_u32 v24, 21504, v17
    s_lshl_b32 s62, s12, 12
    s_lshl_b32 s17, s13, 4
    s_add_u32 s62, s62, s17
    s_xor_b32 s63, s62, 16384
    s_lshr_b32 s16, s54, 1
    s_lshl_b32 s16, s16, 12
    s_add_u32 s62, s62, 237568
    s_lshl_b32 s17, s53, 8
    s_add_u32 s16, s16, s17
    v_lshlrev_b32 v25, 4, v3
    v_add_u32 v25, s16, v25
    v_mov_b32 v16, s63
    v_cmp_lt_u32 vcc, 15, v1
    s_nop 1
    v_cndmask_b32 v25, v25, v16, vcc
    s_lshr_b32 s16, s2, 3
    s_lshl_b32 s16, s16, 2
    s_add_u32 s16, s16, s3
    s_mul_i32 s16, s16, 12288
    s_add_u32 s16, s16, s60
    s_bfe_u32 s17, s2, 0x10002
    s_lshl_b32 s17, s17, 10
    s_add_u32 s16, s16, s17
    s_add_u32 s16, s16, 2148532608
    v_min_u32 v26, 2, v1
    v_lshlrev_b32 v26, 12, v26
    v_add_u32 v26, s16, v26
    s_waitcnt lgkmcnt(0)
    s_cmp_eq_u32 s18, 0
    s_cselect_b32 s4, s4, s6
    s_cselect_b32 s5, s5, s7
    s_add_u32 s20, s8, 0x1200000
    s_addc_u32 s21, s9, 0
    s_mov_b32 s22, 0x400000
    s_mov_b32 s23, 0x20000
    s_mov_b32 s24, s4
    s_mov_b32 s25, s5
    s_mov_b32 s26, 0x700000
    s_mov_b32 s27, 0x20000
    s_add_u32 s28, s8, 0x1600000
    s_addc_u32 s29, s9, 0
    s_mov_b32 s30, 0xe00000
    s_mov_b32 s31, 0x20000
    s_mov_b32 s36, s8
    s_mov_b32 s37, s9
    s_mov_b32 s38, 0x100000
    s_mov_b32 s39, 0x20000
    s_mov_b32 s58, 7340032
    s_mov_b32 s59, 0x20000
    s_add_u32 m0, s42, 0
    s_nop 0
    buffer_load_dwordx4 v9, s[24:27], s46 offen offset:0 lds
    buffer_load_dwordx4 v10, s[24:27], s46 offen offset:1024 lds
    buffer_load_dwordx4 v11, s[24:27], s46 offen offset:2048 lds
    buffer_load_dwordx4 v12, s[24:27], s46 offen offset:3072 lds
    s_add_u32 m0, m0, 4096
    s_nop 0
    buffer_load_dwordx4 v13, s[24:27], s46 offen offset:0 lds
    buffer_load_dwordx4 v14, s[24:27], s46 offen offset:1024 lds
    buffer_load_dwordx4 v15, s[24:27], s46 offen offset:2048 lds
    buffer_load_dwordx4 a[112:115], v4, s[20:23], s40 offen offset:0
    buffer_load_dwordx4 a[116:119], v4, s[20:23], s40 offen offset:256
    buffer_load_dwordx4 a[120:123], v4, s[20:23], s41 offen offset:0
    buffer_load_dwordx4 a[124:127], v4, s[20:23], s41 offen offset:256
    s_add_u32 m0, s42, 28672
    s_add_u32 s46, s46, 458752
    buffer_load_dwordx4 v9, s[24:27], s46 offen offset:0 lds
    buffer_load_dwordx4 v10, s[24:27], s46 offen offset:1024 lds
    buffer_load_dwordx4 v11, s[24:27], s46 offen offset:2048 lds
    buffer_load_dwordx4 v12, s[24:27], s46 offen offset:3072 lds
    buffer_load_dwordx4 a[128:131], v4, s[20:23], s40 offen offset:2048
    buffer_load_dwordx4 a[132:135], v4, s[20:23], s40 offen offset:2304
    buffer_load_dwordx4 a[136:139], v4, s[20:23], s41 offen offset:2048
    buffer_load_dwordx4 a[140:143], v4, s[20:23], s41 offen offset:2304
    s_waitcnt vmcnt(12)
    s_barrier
    ds_read_b64_tr_b16 a[0:1], v7 offset:0
    ds_read_b64_tr_b16 a[2:3], v7 offset:1792
    ds_read_b64_tr_b16 a[4:5], v7 offset:32
    ds_read_b64_tr_b16 a[6:7], v7 offset:1824
    ds_read_b64_tr_b16 a[8:9], v7 offset:64
    ds_read_b64_tr_b16 a[10:11], v7 offset:1856
    ds_read_b64_tr_b16 a[12:13], v7 offset:96
    ds_read_b64_tr_b16 a[14:15], v7 offset:1888
    ds_read_b64_tr_b16 a[16:17], v7 offset:128
    ds_read_b64_tr_b16 a[18:19], v7 offset:1920
    ds_read_b64_tr_b16 a[20:21], v7 offset:160
    ds_read_b64_tr_b16 a[22:23], v7 offset:1952
    ds_read_b64_tr_b16 a[24:25], v7 offset:192
    ds_read_b64_tr_b16 a[26:27], v7 offset:1984
    ds_read_b64_tr_b16 a[28:29], v7 offset:14336
    ds_read_b64_tr_b16 a[30:31], v7 offset:16128
    ds_read_b64_tr_b16 a[32:33], v7 offset:14368
    ds_read_b64_tr_b16 a[34:35], v7 offset:16160
    ds_read_b64_tr_b16 a[36:37], v7 offset:14400
    ds_read_b64_tr_b16 a[38:39], v7 offset:16192
    ds_read_b64_tr_b16 a[40:41], v7 offset:14432
    ds_read_b64_tr_b16 a[42:43], v7 offset:16224
    ds_read_b64_tr_b16 a[44:45], v7 offset:14464
    ds_read_b64_tr_b16 a[46:47], v7 offset:16256
    ds_read_b64_tr_b16 a[48:49], v7 offset:14496
    ds_read_b64_tr_b16 a[50:51], v7 offset:16288
    ds_read_b64_tr_b16 a[52:53], v7 offset:14528
    ds_read_b64_tr_b16 a[54:55], v7 offset:16320
    s_waitcnt vmcnt(8) lgkmcnt(15)
    v_mfma_f32_16x16x32_bf16 v[32:35], a[0:3], a[112:115], 0
    v_mfma_f32_16x16x32_bf16 v[48:51], a[4:7], a[112:115], 0
    v_mfma_f32_16x16x32_bf16 v[64:67], a[8:11], a[112:115], 0
    ds_read_b64_tr_b16 a[56:57], v7 offset:7168
    v_mfma_f32_16x16x32_bf16 v[80:83], a[12:15], a[112:115], 0
    ds_read_b64_tr_b16 a[58:59], v7 offset:8960
    s_add_u32 m0, m0, 4096
    s_nop 0
    buffer_load_dwordx4 v13, s[24:27], s46 offen offset:0 lds
    v_mfma_f32_16x16x32_bf16 v[96:99], a[16:19], a[112:115], 0
    v_mfma_f32_16x16x32_bf16 v[112:115], a[20:23], a[112:115], 0
    ds_read_b64_tr_b16 a[60:61], v7 offset:7200
    s_waitcnt lgkmcnt(15)
    v_mfma_f32_16x16x32_bf16 v[128:131], a[24:27], a[112:115], 0
    ds_read_b64_tr_b16 a[62:63], v7 offset:8992
    v_mfma_f32_16x16x32_bf16 v[144:147], a[28:31], a[112:115], 0
    s_add_u32 s40, s40, 4096
    s_add_u32 s41, s41, 4096
    buffer_load_dwordx4 a[144:147], v4, s[20:23], s40 offen offset:0
    s_waitcnt lgkmcnt(14)
    v_mfma_f32_16x16x32_bf16 v[160:163], a[32:35], a[112:115], 0
    ds_read_b64_tr_b16 a[64:65], v7 offset:7232
    s_waitcnt lgkmcnt(13)
    v_mfma_f32_16x16x32_bf16 v[176:179], a[36:39], a[112:115], 0
    ds_read_b64_tr_b16 a[66:67], v7 offset:9024
    s_waitcnt lgkmcnt(12)
    v_mfma_f32_16x16x32_bf16 v[192:195], a[40:43], a[112:115], 0
    s_waitcnt lgkmcnt(10)
    v_mfma_f32_16x16x32_bf16 v[208:211], a[44:47], a[112:115], 0
    ds_read_b64_tr_b16 a[68:69], v7 offset:7264
    buffer_load_dwordx4 v14, s[24:27], s46 offen offset:1024 lds
    s_waitcnt lgkmcnt(9)
    v_mfma_f32_16x16x32_bf16 v[224:227], a[48:51], a[112:115], 0
    ds_read_b64_tr_b16 a[70:71], v7 offset:9056
    s_waitcnt lgkmcnt(8)
    v_mfma_f32_16x16x32_bf16 v[240:243], a[52:55], a[112:115], 0
    v_mfma_f32_16x16x32_bf16 v[36:39], a[0:3], a[116:119], 0
    ds_read_b64_tr_b16 a[72:73], v7 offset:7296
    v_mfma_f32_16x16x32_bf16 v[52:55], a[4:7], a[116:119], 0
    ds_read_b64_tr_b16 a[74:75], v7 offset:9088
    buffer_load_dwordx4 a[148:151], v4, s[20:23], s40 offen offset:256
    v_mfma_f32_16x16x32_bf16 v[68:71], a[8:11], a[116:119], 0
    v_mfma_f32_16x16x32_bf16 v[84:87], a[12:15], a[116:119], 0
    ds_read_b64_tr_b16 a[76:77], v7 offset:7328
    v_mfma_f32_16x16x32_bf16 v[100:103], a[16:19], a[116:119], 0
    ds_read_b64_tr_b16 a[78:79], v7 offset:9120
    v_mfma_f32_16x16x32_bf16 v[116:119], a[20:23], a[116:119], 0
    buffer_load_dwordx4 v15, s[24:27], s46 offen offset:2048 lds
    v_mfma_f32_16x16x32_bf16 v[132:135], a[24:27], a[116:119], 0
    ds_read_b64_tr_b16 a[80:81], v7 offset:7360
    v_mfma_f32_16x16x32_bf16 v[148:151], a[28:31], a[116:119], 0
    ds_read_b64_tr_b16 a[82:83], v7 offset:9152
    v_mfma_f32_16x16x32_bf16 v[164:167], a[32:35], a[116:119], 0
    v_mfma_f32_16x16x32_bf16 v[180:183], a[36:39], a[116:119], 0
    ds_read_b64_tr_b16 a[84:85], v7 offset:21504
    buffer_load_dwordx4 a[152:155], v4, s[20:23], s41 offen offset:0
    v_mfma_f32_16x16x32_bf16 v[196:199], a[40:43], a[116:119], 0
    ds_read_b64_tr_b16 a[86:87], v7 offset:23296
    v_mfma_f32_16x16x32_bf16 v[212:215], a[44:47], a[116:119], 0
    v_mfma_f32_16x16x32_bf16 v[228:231], a[48:51], a[116:119], 0
    ds_read_b64_tr_b16 a[88:89], v7 offset:21536
    v_mfma_f32_16x16x32_bf16 v[244:247], a[52:55], a[116:119], 0
    ds_read_b64_tr_b16 a[90:91], v7 offset:23328
    buffer_load_dwordx4 a[156:159], v4, s[20:23], s41 offen offset:256
    v_mfma_f32_16x16x32_bf16 v[40:43], a[0:3], a[120:123], 0
    v_mfma_f32_16x16x32_bf16 v[56:59], a[4:7], a[120:123], 0
    ds_read_b64_tr_b16 a[92:93], v7 offset:21568
    v_mfma_f32_16x16x32_bf16 v[72:75], a[8:11], a[120:123], 0
    ds_read_b64_tr_b16 a[94:95], v7 offset:23360
    v_mfma_f32_16x16x32_bf16 v[88:91], a[12:15], a[120:123], 0
    s_add_u32 m0, s42, 57344
    s_add_u32 s46, s46, 458752
    buffer_load_dwordx4 v9, s[24:27], s46 offen offset:0 lds
    v_mfma_f32_16x16x32_bf16 v[104:107], a[16:19], a[120:123], 0
    ds_read_b64_tr_b16 a[96:97], v7 offset:21600
    v_mfma_f32_16x16x32_bf16 v[120:123], a[20:23], a[120:123], 0
    ds_read_b64_tr_b16 a[98:99], v7 offset:23392
    v_mfma_f32_16x16x32_bf16 v[136:139], a[24:27], a[120:123], 0
    v_mfma_f32_16x16x32_bf16 v[152:155], a[28:31], a[120:123], 0
    ds_read_b64_tr_b16 a[100:101], v7 offset:21632
    buffer_load_dwordx4 a[160:163], v4, s[20:23], s40 offen offset:2048
    v_mfma_f32_16x16x32_bf16 v[168:171], a[32:35], a[120:123], 0
    ds_read_b64_tr_b16 a[102:103], v7 offset:23424
    v_mfma_f32_16x16x32_bf16 v[184:187], a[36:39], a[120:123], 0
    v_mfma_f32_16x16x32_bf16 v[200:203], a[40:43], a[120:123], 0
    ds_read_b64_tr_b16 a[104:105], v7 offset:21664
    v_mfma_f32_16x16x32_bf16 v[216:219], a[44:47], a[120:123], 0
    ds_read_b64_tr_b16 a[106:107], v7 offset:23456
    buffer_load_dwordx4 v10, s[24:27], s46 offen offset:1024 lds
    v_mfma_f32_16x16x32_bf16 v[232:235], a[48:51], a[120:123], 0
    v_mfma_f32_16x16x32_bf16 v[248:251], a[52:55], a[120:123], 0
    ds_read_b64_tr_b16 a[108:109], v7 offset:21696
    v_mfma_f32_16x16x32_bf16 v[44:47], a[0:3], a[124:127], 0
    ds_read_b64_tr_b16 a[110:111], v7 offset:23488
    v_mfma_f32_16x16x32_bf16 v[60:63], a[4:7], a[124:127], 0
    buffer_load_dwordx4 a[164:167], v4, s[20:23], s40 offen offset:2304
    v_mfma_f32_16x16x32_bf16 v[76:79], a[8:11], a[124:127], 0
    v_mfma_f32_16x16x32_bf16 v[92:95], a[12:15], a[124:127], 0
    v_mfma_f32_16x16x32_bf16 v[108:111], a[16:19], a[124:127], 0
    v_mfma_f32_16x16x32_bf16 v[124:127], a[20:23], a[124:127], 0
    buffer_load_dwordx4 v11, s[24:27], s46 offen offset:2048 lds
    v_mfma_f32_16x16x32_bf16 v[140:143], a[24:27], a[124:127], 0
    v_mfma_f32_16x16x32_bf16 v[156:159], a[28:31], a[124:127], 0
    v_mfma_f32_16x16x32_bf16 v[172:175], a[32:35], a[124:127], 0
    v_mfma_f32_16x16x32_bf16 v[188:191], a[36:39], a[124:127], 0
    buffer_load_dwordx4 v12, s[24:27], s46 offen offset:3072 lds
    v_mfma_f32_16x16x32_bf16 v[204:207], a[40:43], a[124:127], 0
    v_mfma_f32_16x16x32_bf16 v[220:223], a[44:47], a[124:127], 0
    v_mfma_f32_16x16x32_bf16 v[236:239], a[48:51], a[124:127], 0
    v_mfma_f32_16x16x32_bf16 v[252:255], a[52:55], a[124:127], 0
    buffer_load_dwordx4 a[168:171], v4, s[20:23], s41 offen offset:2048
    s_waitcnt vmcnt(14) lgkmcnt(0)
    v_mfma_f32_16x16x32_bf16 v[32:35], a[56:59], a[128:131], v[32:35]
    v_mfma_f32_16x16x32_bf16 v[48:51], a[60:63], a[128:131], v[48:51]
    s_waitcnt vmcnt(9)
    s_barrier
    v_mfma_f32_16x16x32_bf16 v[64:67], a[64:67], a[128:131], v[64:67]
    ds_read_b64_tr_b16 a[0:1], v7 offset:28672
    v_mfma_f32_16x16x32_bf16 v[80:83], a[68:71], a[128:131], v[80:83]
    ds_read_b64_tr_b16 a[2:3], v7 offset:30464
    buffer_load_dwordx4 a[172:175], v4, s[20:23], s41 offen offset:2304
    v_mfma_f32_16x16x32_bf16 v[96:99], a[72:75], a[128:131], v[96:99]
    v_mfma_f32_16x16x32_bf16 v[112:115], a[76:79], a[128:131], v[112:115]
    ds_read_b64_tr_b16 a[4:5], v7 offset:28704
    v_mfma_f32_16x16x32_bf16 v[128:131], a[80:83], a[128:131], v[128:131]
    ds_read_b64_tr_b16 a[6:7], v7 offset:30496
    v_mfma_f32_16x16x32_bf16 v[144:147], a[84:87], a[128:131], v[144:147]
    s_add_u32 m0, m0, 4096
    s_nop 0
    buffer_load_dwordx4 v13, s[24:27], s46 offen offset:0 lds
    v_mfma_f32_16x16x32_bf16 v[160:163], a[88:91], a[128:131], v[160:163]
    ds_read_b64_tr_b16 a[8:9], v7 offset:28736
    v_mfma_f32_16x16x32_bf16 v[176:179], a[92:95], a[128:131], v[176:179]
    ds_read_b64_tr_b16 a[10:11], v7 offset:30528
    v_mfma_f32_16x16x32_bf16 v[192:195], a[96:99], a[128:131], v[192:195]
    v_mfma_f32_16x16x32_bf16 v[208:211], a[100:103], a[128:131], v[208:211]
    ds_read_b64_tr_b16 a[12:13], v7 offset:28768
    s_add_u32 s40, s40, 4096
    s_add_u32 s41, s41, 4096
    buffer_load_dwordx4 a[112:115], v4, s[20:23], s40 offen offset:0
    v_mfma_f32_16x16x32_bf16 v[224:227], a[104:107], a[128:131], v[224:227]
    ds_read_b64_tr_b16 a[14:15], v7 offset:30560
    v_mfma_f32_16x16x32_bf16 v[240:243], a[108:111], a[128:131], v[240:243]
    v_mfma_f32_16x16x32_bf16 v[36:39], a[56:59], a[132:135], v[36:39]
    ds_read_b64_tr_b16 a[16:17], v7 offset:28800
    v_mfma_f32_16x16x32_bf16 v[52:55], a[60:63], a[132:135], v[52:55]
    ds_read_b64_tr_b16 a[18:19], v7 offset:30592
    buffer_load_dwordx4 v14, s[24:27], s46 offen offset:1024 lds
    v_mfma_f32_16x16x32_bf16 v[68:71], a[64:67], a[132:135], v[68:71]
    v_mfma_f32_16x16x32_bf16 v[84:87], a[68:71], a[132:135], v[84:87]
    ds_read_b64_tr_b16 a[20:21], v7 offset:28832
    v_mfma_f32_16x16x32_bf16 v[100:103], a[72:75], a[132:135], v[100:103]
    ds_read_b64_tr_b16 a[22:23], v7 offset:30624
    v_mfma_f32_16x16x32_bf16 v[116:119], a[76:79], a[132:135], v[116:119]
    buffer_load_dwordx4 a[116:119], v4, s[20:23], s40 offen offset:256
    v_mfma_f32_16x16x32_bf16 v[132:135], a[80:83], a[132:135], v[132:135]
    ds_read_b64_tr_b16 a[24:25], v7 offset:28864
    v_mfma_f32_16x16x32_bf16 v[148:151], a[84:87], a[132:135], v[148:151]
    ds_read_b64_tr_b16 a[26:27], v7 offset:30656
    v_mfma_f32_16x16x32_bf16 v[164:167], a[88:91], a[132:135], v[164:167]
    v_mfma_f32_16x16x32_bf16 v[180:183], a[92:95], a[132:135], v[180:183]
    ds_read_b64_tr_b16 a[28:29], v7 offset:43008
    buffer_load_dwordx4 v15, s[24:27], s46 offen offset:2048 lds
    v_mfma_f32_16x16x32_bf16 v[196:199], a[96:99], a[132:135], v[196:199]
    ds_read_b64_tr_b16 a[30:31], v7 offset:44800
    v_mfma_f32_16x16x32_bf16 v[212:215], a[100:103], a[132:135], v[212:215]
    v_mfma_f32_16x16x32_bf16 v[228:231], a[104:107], a[132:135], v[228:231]
    ds_read_b64_tr_b16 a[32:33], v7 offset:43040
    v_mfma_f32_16x16x32_bf16 v[244:247], a[108:111], a[132:135], v[244:247]
    ds_read_b64_tr_b16 a[34:35], v7 offset:44832
    buffer_load_dwordx4 a[120:123], v4, s[20:23], s41 offen offset:0
    v_mfma_f32_16x16x32_bf16 v[40:43], a[56:59], a[136:139], v[40:43]
    v_mfma_f32_16x16x32_bf16 v[56:59], a[60:63], a[136:139], v[56:59]
    ds_read_b64_tr_b16 a[36:37], v7 offset:43072
    v_mfma_f32_16x16x32_bf16 v[72:75], a[64:67], a[136:139], v[72:75]
    ds_read_b64_tr_b16 a[38:39], v7 offset:44864
    v_mfma_f32_16x16x32_bf16 v[88:91], a[68:71], a[136:139], v[88:91]
    buffer_load_dwordx4 a[124:127], v4, s[20:23], s41 offen offset:256
    v_mfma_f32_16x16x32_bf16 v[104:107], a[72:75], a[136:139], v[104:107]
    ds_read_b64_tr_b16 a[40:41], v7 offset:43104
    v_mfma_f32_16x16x32_bf16 v[120:123], a[76:79], a[136:139], v[120:123]
    ds_read_b64_tr_b16 a[42:43], v7 offset:44896
    v_mfma_f32_16x16x32_bf16 v[136:139], a[80:83], a[136:139], v[136:139]
    v_mfma_f32_16x16x32_bf16 v[152:155], a[84:87], a[136:139], v[152:155]
    ds_read_b64_tr_b16 a[44:45], v7 offset:43136
    s_add_u32 m0, s42, 86016
    s_add_u32 s46, s46, 458752
    buffer_load_dwordx4 v9, s[24:27], s46 offen offset:0 lds
    v_mfma_f32_16x16x32_bf16 v[168:171], a[88:91], a[136:139], v[168:171]
    ds_read_b64_tr_b16 a[46:47], v7 offset:44928
    v_mfma_f32_16x16x32_bf16 v[184:187], a[92:95], a[136:139], v[184:187]
    v_mfma_f32_16x16x32_bf16 v[200:203], a[96:99], a[136:139], v[200:203]
    ds_read_b64_tr_b16 a[48:49], v7 offset:43168
    v_mfma_f32_16x16x32_bf16 v[216:219], a[100:103], a[136:139], v[216:219]
    ds_read_b64_tr_b16 a[50:51], v7 offset:44960
    buffer_load_dwordx4 a[128:131], v4, s[20:23], s40 offen offset:2048
    v_mfma_f32_16x16x32_bf16 v[232:235], a[104:107], a[136:139], v[232:235]
    v_mfma_f32_16x16x32_bf16 v[248:251], a[108:111], a[136:139], v[248:251]
    ds_read_b64_tr_b16 a[52:53], v7 offset:43200
    v_mfma_f32_16x16x32_bf16 v[44:47], a[56:59], a[140:143], v[44:47]
    ds_read_b64_tr_b16 a[54:55], v7 offset:44992
    v_mfma_f32_16x16x32_bf16 v[60:63], a[60:63], a[140:143], v[60:63]
    buffer_load_dwordx4 v10, s[24:27], s46 offen offset:1024 lds
    v_mfma_f32_16x16x32_bf16 v[76:79], a[64:67], a[140:143], v[76:79]
    v_mfma_f32_16x16x32_bf16 v[92:95], a[68:71], a[140:143], v[92:95]
    v_mfma_f32_16x16x32_bf16 v[108:111], a[72:75], a[140:143], v[108:111]
    v_mfma_f32_16x16x32_bf16 v[124:127], a[76:79], a[140:143], v[124:127]
    buffer_load_dwordx4 a[132:135], v4, s[20:23], s40 offen offset:2304
    v_mfma_f32_16x16x32_bf16 v[140:143], a[80:83], a[140:143], v[140:143]
    v_mfma_f32_16x16x32_bf16 v[156:159], a[84:87], a[140:143], v[156:159]
    v_mfma_f32_16x16x32_bf16 v[172:175], a[88:91], a[140:143], v[172:175]
    v_mfma_f32_16x16x32_bf16 v[188:191], a[92:95], a[140:143], v[188:191]
    buffer_load_dwordx4 v11, s[24:27], s46 offen offset:2048 lds
    v_mfma_f32_16x16x32_bf16 v[204:207], a[96:99], a[140:143], v[204:207]
    v_mfma_f32_16x16x32_bf16 v[220:223], a[100:103], a[140:143], v[220:223]
    v_mfma_f32_16x16x32_bf16 v[236:239], a[104:107], a[140:143], v[236:239]
    v_mfma_f32_16x16x32_bf16 v[252:255], a[108:111], a[140:143], v[252:255]
    buffer_load_dwordx4 v12, s[24:27], s46 offen offset:3072 lds
    s_waitcnt vmcnt(21) lgkmcnt(0)
    v_mfma_f32_16x16x32_bf16 v[32:35], a[0:3], a[144:147], v[32:35]
    v_mfma_f32_16x16x32_bf16 v[48:51], a[4:7], a[144:147], v[48:51]
    v_mfma_f32_16x16x32_bf16 v[64:67], a[8:11], a[144:147], v[64:67]
    ds_read_b64_tr_b16 a[56:57], v7 offset:35840
    v_mfma_f32_16x16x32_bf16 v[80:83], a[12:15], a[144:147], v[80:83]
    ds_read_b64_tr_b16 a[58:59], v7 offset:37632
    buffer_load_dwordx4 a[136:139], v4, s[20:23], s41 offen offset:2048
    v_mfma_f32_16x16x32_bf16 v[96:99], a[16:19], a[144:147], v[96:99]
    v_mfma_f32_16x16x32_bf16 v[112:115], a[20:23], a[144:147], v[112:115]
    ds_read_b64_tr_b16 a[60:61], v7 offset:35872
    v_mfma_f32_16x16x32_bf16 v[128:131], a[24:27], a[144:147], v[128:131]
    ds_read_b64_tr_b16 a[62:63], v7 offset:37664
    v_mfma_f32_16x16x32_bf16 v[144:147], a[28:31], a[144:147], v[144:147]
    buffer_load_dwordx4 a[140:143], v4, s[20:23], s41 offen offset:2304
    v_mfma_f32_16x16x32_bf16 v[160:163], a[32:35], a[144:147], v[160:163]
    ds_read_b64_tr_b16 a[64:65], v7 offset:35904
    v_mfma_f32_16x16x32_bf16 v[176:179], a[36:39], a[144:147], v[176:179]
    ds_read_b64_tr_b16 a[66:67], v7 offset:37696
    v_mfma_f32_16x16x32_bf16 v[192:195], a[40:43], a[144:147], v[192:195]
    v_mfma_f32_16x16x32_bf16 v[208:211], a[44:47], a[144:147], v[208:211]
    ds_read_b64_tr_b16 a[68:69], v7 offset:35936
    s_add_u32 m0, m0, 4096
    s_nop 0
    buffer_load_dwordx4 v13, s[24:27], s46 offen offset:0 lds
    v_mfma_f32_16x16x32_bf16 v[224:227], a[48:51], a[144:147], v[224:227]
    ds_read_b64_tr_b16 a[70:71], v7 offset:37728
    v_mfma_f32_16x16x32_bf16 v[240:243], a[52:55], a[144:147], v[240:243]
    v_mfma_f32_16x16x32_bf16 v[36:39], a[0:3], a[148:151], v[36:39]
    ds_read_b64_tr_b16 a[72:73], v7 offset:35968
    v_mfma_f32_16x16x32_bf16 v[52:55], a[4:7], a[148:151], v[52:55]
    ds_read_b64_tr_b16 a[74:75], v7 offset:37760
    v_mfma_f32_16x16x32_bf16 v[68:71], a[8:11], a[148:151], v[68:71]
    v_mfma_f32_16x16x32_bf16 v[84:87], a[12:15], a[148:151], v[84:87]
    ds_read_b64_tr_b16 a[76:77], v7 offset:36000
    v_mfma_f32_16x16x32_bf16 v[100:103], a[16:19], a[148:151], v[100:103]
    ds_read_b64_tr_b16 a[78:79], v7 offset:37792
    v_mfma_f32_16x16x32_bf16 v[116:119], a[20:23], a[148:151], v[116:119]
    s_add_u32 s40, s40, 4096
    s_add_u32 s41, s41, 4096
    buffer_load_dwordx4 a[144:147], v4, s[20:23], s40 offen offset:0
    v_mfma_f32_16x16x32_bf16 v[132:135], a[24:27], a[148:151], v[132:135]
    ds_read_b64_tr_b16 a[80:81], v7 offset:36032
    v_mfma_f32_16x16x32_bf16 v[148:151], a[28:31], a[148:151], v[148:151]
    ds_read_b64_tr_b16 a[82:83], v7 offset:37824
    v_mfma_f32_16x16x32_bf16 v[164:167], a[32:35], a[148:151], v[164:167]
    v_mfma_f32_16x16x32_bf16 v[180:183], a[36:39], a[148:151], v[180:183]
    ds_read_b64_tr_b16 a[84:85], v7 offset:50176
    buffer_load_dwordx4 v14, s[24:27], s46 offen offset:1024 lds
    v_mfma_f32_16x16x32_bf16 v[196:199], a[40:43], a[148:151], v[196:199]
    ds_read_b64_tr_b16 a[86:87], v7 offset:51968
    v_mfma_f32_16x16x32_bf16 v[212:215], a[44:47], a[148:151], v[212:215]
    v_mfma_f32_16x16x32_bf16 v[228:231], a[48:51], a[148:151], v[228:231]
    ds_read_b64_tr_b16 a[88:89], v7 offset:50208
    v_mfma_f32_16x16x32_bf16 v[244:247], a[52:55], a[148:151], v[244:247]
    ds_read_b64_tr_b16 a[90:91], v7 offset:52000
    v_mfma_f32_16x16x32_bf16 v[40:43], a[0:3], a[152:155], v[40:43]
    v_mfma_f32_16x16x32_bf16 v[56:59], a[4:7], a[152:155], v[56:59]
    ds_read_b64_tr_b16 a[92:93], v7 offset:50240
    v_mfma_f32_16x16x32_bf16 v[72:75], a[8:11], a[152:155], v[72:75]
    ds_read_b64_tr_b16 a[94:95], v7 offset:52032
    v_mfma_f32_16x16x32_bf16 v[88:91], a[12:15], a[152:155], v[88:91]
    buffer_load_dwordx4 a[148:151], v4, s[20:23], s40 offen offset:256
    v_mfma_f32_16x16x32_bf16 v[104:107], a[16:19], a[152:155], v[104:107]
    ds_read_b64_tr_b16 a[96:97], v7 offset:50272
    v_mfma_f32_16x16x32_bf16 v[120:123], a[20:23], a[152:155], v[120:123]
    ds_read_b64_tr_b16 a[98:99], v7 offset:52064
    v_mfma_f32_16x16x32_bf16 v[136:139], a[24:27], a[152:155], v[136:139]
    v_mfma_f32_16x16x32_bf16 v[152:155], a[28:31], a[152:155], v[152:155]
    ds_read_b64_tr_b16 a[100:101], v7 offset:50304
    buffer_load_dwordx4 v15, s[24:27], s46 offen offset:2048 lds
    v_mfma_f32_16x16x32_bf16 v[168:171], a[32:35], a[152:155], v[168:171]
    ds_read_b64_tr_b16 a[102:103], v7 offset:52096
    v_mfma_f32_16x16x32_bf16 v[184:187], a[36:39], a[152:155], v[184:187]
    v_mfma_f32_16x16x32_bf16 v[200:203], a[40:43], a[152:155], v[200:203]
    ds_read_b64_tr_b16 a[104:105], v7 offset:50336
    v_mfma_f32_16x16x32_bf16 v[216:219], a[44:47], a[152:155], v[216:219]
    ds_read_b64_tr_b16 a[106:107], v7 offset:52128
    v_mfma_f32_16x16x32_bf16 v[232:235], a[48:51], a[152:155], v[232:235]
    v_mfma_f32_16x16x32_bf16 v[248:251], a[52:55], a[152:155], v[248:251]
    ds_read_b64_tr_b16 a[108:109], v7 offset:50368
    v_mfma_f32_16x16x32_bf16 v[44:47], a[0:3], a[156:159], v[44:47]
    ds_read_b64_tr_b16 a[110:111], v7 offset:52160
    v_mfma_f32_16x16x32_bf16 v[60:63], a[4:7], a[156:159], v[60:63]
    v_mfma_f32_16x16x32_bf16 v[76:79], a[8:11], a[156:159], v[76:79]
    v_mfma_f32_16x16x32_bf16 v[92:95], a[12:15], a[156:159], v[92:95]
    v_mfma_f32_16x16x32_bf16 v[108:111], a[16:19], a[156:159], v[108:111]
    v_mfma_f32_16x16x32_bf16 v[124:127], a[20:23], a[156:159], v[124:127]
    buffer_load_dwordx4 a[152:155], v4, s[20:23], s41 offen offset:0
    v_mfma_f32_16x16x32_bf16 v[140:143], a[24:27], a[156:159], v[140:143]
    v_mfma_f32_16x16x32_bf16 v[156:159], a[28:31], a[156:159], v[156:159]
    v_mfma_f32_16x16x32_bf16 v[172:175], a[32:35], a[156:159], v[172:175]
    v_mfma_f32_16x16x32_bf16 v[188:191], a[36:39], a[156:159], v[188:191]
    v_mfma_f32_16x16x32_bf16 v[204:207], a[40:43], a[156:159], v[204:207]
    v_mfma_f32_16x16x32_bf16 v[220:223], a[44:47], a[156:159], v[220:223]
    v_mfma_f32_16x16x32_bf16 v[236:239], a[48:51], a[156:159], v[236:239]
    v_mfma_f32_16x16x32_bf16 v[252:255], a[52:55], a[156:159], v[252:255]
    buffer_load_dwordx4 a[156:159], v4, s[20:23], s41 offen offset:256
    s_mov_b32 s44, 3
.p2align 6
L_k4_glu_kernel_main_1:
    s_waitcnt vmcnt(22) lgkmcnt(0)
    v_mfma_f32_16x16x32_bf16 v[32:35], a[56:59], a[160:163], v[32:35]
    v_mfma_f32_16x16x32_bf16 v[48:51], a[60:63], a[160:163], v[48:51]
    s_waitcnt vmcnt(17)
    s_barrier
    v_mfma_f32_16x16x32_bf16 v[64:67], a[64:67], a[160:163], v[64:67]
    ds_read_b64_tr_b16 a[0:1], v8 offset:0
    v_mfma_f32_16x16x32_bf16 v[80:83], a[68:71], a[160:163], v[80:83]
    ds_read_b64_tr_b16 a[2:3], v8 offset:1792
    v_mfma_f32_16x16x32_bf16 v[96:99], a[72:75], a[160:163], v[96:99]
    v_mfma_f32_16x16x32_bf16 v[112:115], a[76:79], a[160:163], v[112:115]
    ds_read_b64_tr_b16 a[4:5], v8 offset:32
    v_mfma_f32_16x16x32_bf16 v[128:131], a[80:83], a[160:163], v[128:131]
    ds_read_b64_tr_b16 a[6:7], v8 offset:1824
    v_mfma_f32_16x16x32_bf16 v[144:147], a[84:87], a[160:163], v[144:147]
    s_add_u32 m0, s42, 0
    s_add_u32 s46, s46, 458752
    buffer_load_dwordx4 v9, s[24:27], s46 offen offset:0 lds
    v_mfma_f32_16x16x32_bf16 v[160:163], a[88:91], a[160:163], v[160:163]
    ds_read_b64_tr_b16 a[8:9], v8 offset:64
    v_mfma_f32_16x16x32_bf16 v[176:179], a[92:95], a[160:163], v[176:179]
    ds_read_b64_tr_b16 a[10:11], v8 offset:1856
    v_mfma_f32_16x16x32_bf16 v[192:195], a[96:99], a[160:163], v[192:195]
    v_mfma_f32_16x16x32_bf16 v[208:211], a[100:103], a[160:163], v[208:211]
    ds_read_b64_tr_b16 a[12:13], v8 offset:96
    v_mfma_f32_16x16x32_bf16 v[224:227], a[104:107], a[160:163], v[224:227]
    ds_read_b64_tr_b16 a[14:15], v8 offset:1888
    v_mfma_f32_16x16x32_bf16 v[240:243], a[108:111], a[160:163], v[240:243]
    v_mfma_f32_16x16x32_bf16 v[36:39], a[56:59], a[164:167], v[36:39]
    ds_read_b64_tr_b16 a[16:17], v8 offset:128
    v_mfma_f32_16x16x32_bf16 v[52:55], a[60:63], a[164:167], v[52:55]
    ds_read_b64_tr_b16 a[18:19], v8 offset:1920
    v_mfma_f32_16x16x32_bf16 v[68:71], a[64:67], a[164:167], v[68:71]
    buffer_load_dwordx4 a[160:163], v4, s[20:23], s40 offen offset:2048
    v_mfma_f32_16x16x32_bf16 v[84:87], a[68:71], a[164:167], v[84:87]
    ds_read_b64_tr_b16 a[20:21], v8 offset:160
    v_mfma_f32_16x16x32_bf16 v[100:103], a[72:75], a[164:167], v[100:103]
    ds_read_b64_tr_b16 a[22:23], v8 offset:1952
    v_mfma_f32_16x16x32_bf16 v[116:119], a[76:79], a[164:167], v[116:119]
    buffer_load_dwordx4 v10, s[24:27], s46 offen offset:1024 lds
    v_mfma_f32_16x16x32_bf16 v[132:135], a[80:83], a[164:167], v[132:135]
    ds_read_b64_tr_b16 a[24:25], v8 offset:192
    v_mfma_f32_16x16x32_bf16 v[148:151], a[84:87], a[164:167], v[148:151]
    ds_read_b64_tr_b16 a[26:27], v8 offset:1984
    v_mfma_f32_16x16x32_bf16 v[164:167], a[88:91], a[164:167], v[164:167]
    v_mfma_f32_16x16x32_bf16 v[180:183], a[92:95], a[164:167], v[180:183]
    ds_read_b64_tr_b16 a[28:29], v8 offset:14336
    v_mfma_f32_16x16x32_bf16 v[196:199], a[96:99], a[164:167], v[196:199]
    ds_read_b64_tr_b16 a[30:31], v8 offset:16128
    v_mfma_f32_16x16x32_bf16 v[212:215], a[100:103], a[164:167], v[212:215]
    v_mfma_f32_16x16x32_bf16 v[228:231], a[104:107], a[164:167], v[228:231]
    ds_read_b64_tr_b16 a[32:33], v8 offset:14368
    v_mfma_f32_16x16x32_bf16 v[244:247], a[108:111], a[164:167], v[244:247]
    ds_read_b64_tr_b16 a[34:35], v8 offset:16160
    v_mfma_f32_16x16x32_bf16 v[40:43], a[56:59], a[168:171], v[40:43]
    v_mfma_f32_16x16x32_bf16 v[56:59], a[60:63], a[168:171], v[56:59]
    ds_read_b64_tr_b16 a[36:37], v8 offset:14400
    v_mfma_f32_16x16x32_bf16 v[72:75], a[64:67], a[168:171], v[72:75]
    ds_read_b64_tr_b16 a[38:39], v8 offset:16192
    buffer_load_dwordx4 a[164:167], v4, s[20:23], s40 offen offset:2304
    v_mfma_f32_16x16x32_bf16 v[88:91], a[68:71], a[168:171], v[88:91]
    buffer_load_dwordx4 v11, s[24:27], s46 offen offset:2048 lds
    v_mfma_f32_16x16x32_bf16 v[104:107], a[72:75], a[168:171], v[104:107]
    ds_read_b64_tr_b16 a[40:41], v8 offset:14432
    v_mfma_f32_16x16x32_bf16 v[120:123], a[76:79], a[168:171], v[120:123]
    ds_read_b64_tr_b16 a[42:43], v8 offset:16224
    v_mfma_f32_16x16x32_bf16 v[136:139], a[80:83], a[168:171], v[136:139]
    v_mfma_f32_16x16x32_bf16 v[152:155], a[84:87], a[168:171], v[152:155]
    ds_read_b64_tr_b16 a[44:45], v8 offset:14464
    v_mfma_f32_16x16x32_bf16 v[168:171], a[88:91], a[168:171], v[168:171]
    ds_read_b64_tr_b16 a[46:47], v8 offset:16256
    v_mfma_f32_16x16x32_bf16 v[184:187], a[92:95], a[168:171], v[184:187]
    v_mfma_f32_16x16x32_bf16 v[200:203], a[96:99], a[168:171], v[200:203]
    ds_read_b64_tr_b16 a[48:49], v8 offset:14496
    v_mfma_f32_16x16x32_bf16 v[216:219], a[100:103], a[168:171], v[216:219]
    ds_read_b64_tr_b16 a[50:51], v8 offset:16288
    v_mfma_f32_16x16x32_bf16 v[232:235], a[104:107], a[168:171], v[232:235]
    v_mfma_f32_16x16x32_bf16 v[248:251], a[108:111], a[168:171], v[248:251]
    ds_read_b64_tr_b16 a[52:53], v8 offset:14528
    v_mfma_f32_16x16x32_bf16 v[44:47], a[56:59], a[172:175], v[44:47]
    ds_read_b64_tr_b16 a[54:55], v8 offset:16320
    v_mfma_f32_16x16x32_bf16 v[60:63], a[60:63], a[172:175], v[60:63]
    buffer_load_dwordx4 v12, s[24:27], s46 offen offset:3072 lds
    v_mfma_f32_16x16x32_bf16 v[76:79], a[64:67], a[172:175], v[76:79]
    buffer_load_dwordx4 a[168:171], v4, s[20:23], s41 offen offset:2048
    v_mfma_f32_16x16x32_bf16 v[92:95], a[68:71], a[172:175], v[92:95]
    v_mfma_f32_16x16x32_bf16 v[108:111], a[72:75], a[172:175], v[108:111]
    v_mfma_f32_16x16x32_bf16 v[124:127], a[76:79], a[172:175], v[124:127]
    v_mfma_f32_16x16x32_bf16 v[140:143], a[80:83], a[172:175], v[140:143]
    v_mfma_f32_16x16x32_bf16 v[156:159], a[84:87], a[172:175], v[156:159]
    v_mfma_f32_16x16x32_bf16 v[172:175], a[88:91], a[172:175], v[172:175]
    v_mfma_f32_16x16x32_bf16 v[188:191], a[92:95], a[172:175], v[188:191]
    v_mfma_f32_16x16x32_bf16 v[204:207], a[96:99], a[172:175], v[204:207]
    v_mfma_f32_16x16x32_bf16 v[220:223], a[100:103], a[172:175], v[220:223]
    v_mfma_f32_16x16x32_bf16 v[236:239], a[104:107], a[172:175], v[236:239]
    v_mfma_f32_16x16x32_bf16 v[252:255], a[108:111], a[172:175], v[252:255]
    buffer_load_dwordx4 a[172:175], v4, s[20:23], s41 offen offset:2304
    s_waitcnt vmcnt(23) lgkmcnt(0)
    v_mfma_f32_16x16x32_bf16 v[32:35], a[0:3], a[112:115], v[32:35]
    v_mfma_f32_16x16x32_bf16 v[48:51], a[4:7], a[112:115], v[48:51]
    v_mfma_f32_16x16x32_bf16 v[64:67], a[8:11], a[112:115], v[64:67]
    ds_read_b64_tr_b16 a[56:57], v8 offset:7168
    v_mfma_f32_16x16x32_bf16 v[80:83], a[12:15], a[112:115], v[80:83]
    ds_read_b64_tr_b16 a[58:59], v8 offset:8960
    v_mfma_f32_16x16x32_bf16 v[96:99], a[16:19], a[112:115], v[96:99]
    v_mfma_f32_16x16x32_bf16 v[112:115], a[20:23], a[112:115], v[112:115]
    ds_read_b64_tr_b16 a[60:61], v8 offset:7200
    v_mfma_f32_16x16x32_bf16 v[128:131], a[24:27], a[112:115], v[128:131]
    ds_read_b64_tr_b16 a[62:63], v8 offset:8992
    v_mfma_f32_16x16x32_bf16 v[144:147], a[28:31], a[112:115], v[144:147]
    s_add_u32 m0, m0, 4096
    s_nop 0
    buffer_load_dwordx4 v13, s[24:27], s46 offen offset:0 lds
    v_mfma_f32_16x16x32_bf16 v[160:163], a[32:35], a[112:115], v[160:163]
    ds_read_b64_tr_b16 a[64:65], v8 offset:7232
    v_mfma_f32_16x16x32_bf16 v[176:179], a[36:39], a[112:115], v[176:179]
    ds_read_b64_tr_b16 a[66:67], v8 offset:9024
    v_mfma_f32_16x16x32_bf16 v[192:195], a[40:43], a[112:115], v[192:195]
    v_mfma_f32_16x16x32_bf16 v[208:211], a[44:47], a[112:115], v[208:211]
    ds_read_b64_tr_b16 a[68:69], v8 offset:7264
    v_mfma_f32_16x16x32_bf16 v[224:227], a[48:51], a[112:115], v[224:227]
    ds_read_b64_tr_b16 a[70:71], v8 offset:9056
    v_mfma_f32_16x16x32_bf16 v[240:243], a[52:55], a[112:115], v[240:243]
    v_mfma_f32_16x16x32_bf16 v[36:39], a[0:3], a[116:119], v[36:39]
    ds_read_b64_tr_b16 a[72:73], v8 offset:7296
    v_mfma_f32_16x16x32_bf16 v[52:55], a[4:7], a[116:119], v[52:55]
    ds_read_b64_tr_b16 a[74:75], v8 offset:9088
    v_mfma_f32_16x16x32_bf16 v[68:71], a[8:11], a[116:119], v[68:71]
    s_add_u32 s40, s40, 4096
    s_add_u32 s41, s41, 4096
    buffer_load_dwordx4 a[112:115], v4, s[20:23], s40 offen offset:0
    v_mfma_f32_16x16x32_bf16 v[84:87], a[12:15], a[116:119], v[84:87]
    ds_read_b64_tr_b16 a[76:77], v8 offset:7328
    v_mfma_f32_16x16x32_bf16 v[100:103], a[16:19], a[116:119], v[100:103]
    ds_read_b64_tr_b16 a[78:79], v8 offset:9120
    v_mfma_f32_16x16x32_bf16 v[116:119], a[20:23], a[116:119], v[116:119]
    buffer_load_dwordx4 v14, s[24:27], s46 offen offset:1024 lds
    v_mfma_f32_16x16x32_bf16 v[132:135], a[24:27], a[116:119], v[132:135]
    ds_read_b64_tr_b16 a[80:81], v8 offset:7360
    v_mfma_f32_16x16x32_bf16 v[148:151], a[28:31], a[116:119], v[148:151]
    ds_read_b64_tr_b16 a[82:83], v8 offset:9152
    v_mfma_f32_16x16x32_bf16 v[164:167], a[32:35], a[116:119], v[164:167]
    v_mfma_f32_16x16x32_bf16 v[180:183], a[36:39], a[116:119], v[180:183]
    ds_read_b64_tr_b16 a[84:85], v8 offset:21504
    v_mfma_f32_16x16x32_bf16 v[196:199], a[40:43], a[116:119], v[196:199]
    ds_read_b64_tr_b16 a[86:87], v8 offset:23296
    v_mfma_f32_16x16x32_bf16 v[212:215], a[44:47], a[116:119], v[212:215]
    v_mfma_f32_16x16x32_bf16 v[228:231], a[48:51], a[116:119], v[228:231]
    ds_read_b64_tr_b16 a[88:89], v8 offset:21536
    v_mfma_f32_16x16x32_bf16 v[244:247], a[52:55], a[116:119], v[244:247]
    ds_read_b64_tr_b16 a[90:91], v8 offset:23328
    v_mfma_f32_16x16x32_bf16 v[40:43], a[0:3], a[120:123], v[40:43]
    v_mfma_f32_16x16x32_bf16 v[56:59], a[4:7], a[120:123], v[56:59]
    ds_read_b64_tr_b16 a[92:93], v8 offset:21568
    v_mfma_f32_16x16x32_bf16 v[72:75], a[8:11], a[120:123], v[72:75]
    ds_read_b64_tr_b16 a[94:95], v8 offset:23360
    buffer_load_dwordx4 a[116:119], v4, s[20:23], s40 offen offset:256
    v_mfma_f32_16x16x32_bf16 v[88:91], a[12:15], a[120:123], v[88:91]
    buffer_load_dwordx4 v15, s[24:27], s46 offen offset:2048 lds
    v_mfma_f32_16x16x32_bf16 v[104:107], a[16:19], a[120:123], v[104:107]
    ds_read_b64_tr_b16 a[96:97], v8 offset:21600
    v_mfma_f32_16x16x32_bf16 v[120:123], a[20:23], a[120:123], v[120:123]
    ds_read_b64_tr_b16 a[98:99], v8 offset:23392
    v_mfma_f32_16x16x32_bf16 v[136:139], a[24:27], a[120:123], v[136:139]
    v_mfma_f32_16x16x32_bf16 v[152:155], a[28:31], a[120:123], v[152:155]
    ds_read_b64_tr_b16 a[100:101], v8 offset:21632
    v_mfma_f32_16x16x32_bf16 v[168:171], a[32:35], a[120:123], v[168:171]
    ds_read_b64_tr_b16 a[102:103], v8 offset:23424
    v_mfma_f32_16x16x32_bf16 v[184:187], a[36:39], a[120:123], v[184:187]
    v_mfma_f32_16x16x32_bf16 v[200:203], a[40:43], a[120:123], v[200:203]
    ds_read_b64_tr_b16 a[104:105], v8 offset:21664
    v_mfma_f32_16x16x32_bf16 v[216:219], a[44:47], a[120:123], v[216:219]
    ds_read_b64_tr_b16 a[106:107], v8 offset:23456
    v_mfma_f32_16x16x32_bf16 v[232:235], a[48:51], a[120:123], v[232:235]
    v_mfma_f32_16x16x32_bf16 v[248:251], a[52:55], a[120:123], v[248:251]
    ds_read_b64_tr_b16 a[108:109], v8 offset:21696
    v_mfma_f32_16x16x32_bf16 v[44:47], a[0:3], a[124:127], v[44:47]
    ds_read_b64_tr_b16 a[110:111], v8 offset:23488
    v_mfma_f32_16x16x32_bf16 v[60:63], a[4:7], a[124:127], v[60:63]
    v_mfma_f32_16x16x32_bf16 v[76:79], a[8:11], a[124:127], v[76:79]
    buffer_load_dwordx4 a[120:123], v4, s[20:23], s41 offen offset:0
    v_mfma_f32_16x16x32_bf16 v[92:95], a[12:15], a[124:127], v[92:95]
    v_mfma_f32_16x16x32_bf16 v[108:111], a[16:19], a[124:127], v[108:111]
    v_mfma_f32_16x16x32_bf16 v[124:127], a[20:23], a[124:127], v[124:127]
    v_mfma_f32_16x16x32_bf16 v[140:143], a[24:27], a[124:127], v[140:143]
    v_mfma_f32_16x16x32_bf16 v[156:159], a[28:31], a[124:127], v[156:159]
    v_mfma_f32_16x16x32_bf16 v[172:175], a[32:35], a[124:127], v[172:175]
    v_mfma_f32_16x16x32_bf16 v[188:191], a[36:39], a[124:127], v[188:191]
    v_mfma_f32_16x16x32_bf16 v[204:207], a[40:43], a[124:127], v[204:207]
    v_mfma_f32_16x16x32_bf16 v[220:223], a[44:47], a[124:127], v[220:223]
    v_mfma_f32_16x16x32_bf16 v[236:239], a[48:51], a[124:127], v[236:239]
    v_mfma_f32_16x16x32_bf16 v[252:255], a[52:55], a[124:127], v[252:255]
    buffer_load_dwordx4 a[124:127], v4, s[20:23], s41 offen offset:256
    s_waitcnt vmcnt(22) lgkmcnt(0)
    v_mfma_f32_16x16x32_bf16 v[32:35], a[56:59], a[128:131], v[32:35]
    v_mfma_f32_16x16x32_bf16 v[48:51], a[60:63], a[128:131], v[48:51]
    s_waitcnt vmcnt(17)
    s_barrier
    v_mfma_f32_16x16x32_bf16 v[64:67], a[64:67], a[128:131], v[64:67]
    ds_read_b64_tr_b16 a[0:1], v8 offset:28672
    v_mfma_f32_16x16x32_bf16 v[80:83], a[68:71], a[128:131], v[80:83]
    ds_read_b64_tr_b16 a[2:3], v8 offset:30464
    v_mfma_f32_16x16x32_bf16 v[96:99], a[72:75], a[128:131], v[96:99]
    v_mfma_f32_16x16x32_bf16 v[112:115], a[76:79], a[128:131], v[112:115]
    ds_read_b64_tr_b16 a[4:5], v8 offset:28704
    v_mfma_f32_16x16x32_bf16 v[128:131], a[80:83], a[128:131], v[128:131]
    ds_read_b64_tr_b16 a[6:7], v8 offset:30496
    v_mfma_f32_16x16x32_bf16 v[144:147], a[84:87], a[128:131], v[144:147]
    s_add_u32 m0, s42, 28672
    s_add_u32 s46, s46, 458752
    buffer_load_dwordx4 v9, s[24:27], s46 offen offset:0 lds
    v_mfma_f32_16x16x32_bf16 v[160:163], a[88:91], a[128:131], v[160:163]
    ds_read_b64_tr_b16 a[8:9], v8 offset:28736
    v_mfma_f32_16x16x32_bf16 v[176:179], a[92:95], a[128:131], v[176:179]
    ds_read_b64_tr_b16 a[10:11], v8 offset:30528
    v_mfma_f32_16x16x32_bf16 v[192:195], a[96:99], a[128:131], v[192:195]
    v_mfma_f32_16x16x32_bf16 v[208:211], a[100:103], a[128:131], v[208:211]
    ds_read_b64_tr_b16 a[12:13], v8 offset:28768
    v_mfma_f32_16x16x32_bf16 v[224:227], a[104:107], a[128:131], v[224:227]
    ds_read_b64_tr_b16 a[14:15], v8 offset:30560
    v_mfma_f32_16x16x32_bf16 v[240:243], a[108:111], a[128:131], v[240:243]
    v_mfma_f32_16x16x32_bf16 v[36:39], a[56:59], a[132:135], v[36:39]
    ds_read_b64_tr_b16 a[16:17], v8 offset:28800
    v_mfma_f32_16x16x32_bf16 v[52:55], a[60:63], a[132:135], v[52:55]
    ds_read_b64_tr_b16 a[18:19], v8 offset:30592
    v_mfma_f32_16x16x32_bf16 v[68:71], a[64:67], a[132:135], v[68:71]
    buffer_load_dwordx4 a[128:131], v4, s[20:23], s40 offen offset:2048
    v_mfma_f32_16x16x32_bf16 v[84:87], a[68:71], a[132:135], v[84:87]
    ds_read_b64_tr_b16 a[20:21], v8 offset:28832
    v_mfma_f32_16x16x32_bf16 v[100:103], a[72:75], a[132:135], v[100:103]
    ds_read_b64_tr_b16 a[22:23], v8 offset:30624
    v_mfma_f32_16x16x32_bf16 v[116:119], a[76:79], a[132:135], v[116:119]
    buffer_load_dwordx4 v10, s[24:27], s46 offen offset:1024 lds
    v_mfma_f32_16x16x32_bf16 v[132:135], a[80:83], a[132:135], v[132:135]
    ds_read_b64_tr_b16 a[24:25], v8 offset:28864
    v_mfma_f32_16x16x32_bf16 v[148:151], a[84:87], a[132:135], v[148:151]
    ds_read_b64_tr_b16 a[26:27], v8 offset:30656
    v_mfma_f32_16x16x32_bf16 v[164:167], a[88:91], a[132:135], v[164:167]
    v_mfma_f32_16x16x32_bf16 v[180:183], a[92:95], a[132:135], v[180:183]
    ds_read_b64_tr_b16 a[28:29], v8 offset:43008
    v_mfma_f32_16x16x32_bf16 v[196:199], a[96:99], a[132:135], v[196:199]
    ds_read_b64_tr_b16 a[30:31], v8 offset:44800
    v_mfma_f32_16x16x32_bf16 v[212:215], a[100:103], a[132:135], v[212:215]
    v_mfma_f32_16x16x32_bf16 v[228:231], a[104:107], a[132:135], v[228:231]
    ds_read_b64_tr_b16 a[32:33], v8 offset:43040
    v_mfma_f32_16x16x32_bf16 v[244:247], a[108:111], a[132:135], v[244:247]
    ds_read_b64_tr_b16 a[34:35], v8 offset:44832
    v_mfma_f32_16x16x32_bf16 v[40:43], a[56:59], a[136:139], v[40:43]
    v_mfma_f32_16x16x32_bf16 v[56:59], a[60:63], a[136:139], v[56:59]
    ds_read_b64_tr_b16 a[36:37], v8 offset:43072
    v_mfma_f32_16x16x32_bf16 v[72:75], a[64:67], a[136:139], v[72:75]
    ds_read_b64_tr_b16 a[38:39], v8 offset:44864
    buffer_load_dwordx4 a[132:135], v4, s[20:23], s40 offen offset:2304
    v_mfma_f32_16x16x32_bf16 v[88:91], a[68:71], a[136:139], v[88:91]
    buffer_load_dwordx4 v11, s[24:27], s46 offen offset:2048 lds
    v_mfma_f32_16x16x32_bf16 v[104:107], a[72:75], a[136:139], v[104:107]
    ds_read_b64_tr_b16 a[40:41], v8 offset:43104
    v_mfma_f32_16x16x32_bf16 v[120:123], a[76:79], a[136:139], v[120:123]
    ds_read_b64_tr_b16 a[42:43], v8 offset:44896
    v_mfma_f32_16x16x32_bf16 v[136:139], a[80:83], a[136:139], v[136:139]
    v_mfma_f32_16x16x32_bf16 v[152:155], a[84:87], a[136:139], v[152:155]
    ds_read_b64_tr_b16 a[44:45], v8 offset:43136
    v_mfma_f32_16x16x32_bf16 v[168:171], a[88:91], a[136:139], v[168:171]
    ds_read_b64_tr_b16 a[46:47], v8 offset:44928
    v_mfma_f32_16x16x32_bf16 v[184:187], a[92:95], a[136:139], v[184:187]
    v_mfma_f32_16x16x32_bf16 v[200:203], a[96:99], a[136:139], v[200:203]
    ds_read_b64_tr_b16 a[48:49], v8 offset:43168
    v_mfma_f32_16x16x32_bf16 v[216:219], a[100:103], a[136:139], v[216:219]
    ds_read_b64_tr_b16 a[50:51], v8 offset:44960
    v_mfma_f32_16x16x32_bf16 v[232:235], a[104:107], a[136:139], v[232:235]
    v_mfma_f32_16x16x32_bf16 v[248:251], a[108:111], a[136:139], v[248:251]
    ds_read_b64_tr_b16 a[52:53], v8 offset:43200
    v_mfma_f32_16x16x32_bf16 v[44:47], a[56:59], a[140:143], v[44:47]
    ds_read_b64_tr_b16 a[54:55], v8 offset:44992
    v_mfma_f32_16x16x32_bf16 v[60:63], a[60:63], a[140:143], v[60:63]
    buffer_load_dwordx4 v12, s[24:27], s46 offen offset:3072 lds
    v_mfma_f32_16x16x32_bf16 v[76:79], a[64:67], a[140:143], v[76:79]
    buffer_load_dwordx4 a[136:139], v4, s[20:23], s41 offen offset:2048
    v_mfma_f32_16x16x32_bf16 v[92:95], a[68:71], a[140:143], v[92:95]
    v_mfma_f32_16x16x32_bf16 v[108:111], a[72:75], a[140:143], v[108:111]
    v_mfma_f32_16x16x32_bf16 v[124:127], a[76:79], a[140:143], v[124:127]
    v_mfma_f32_16x16x32_bf16 v[140:143], a[80:83], a[140:143], v[140:143]
    v_mfma_f32_16x16x32_bf16 v[156:159], a[84:87], a[140:143], v[156:159]
    v_mfma_f32_16x16x32_bf16 v[172:175], a[88:91], a[140:143], v[172:175]
    buffer_load_dword v27, v26, s[56:59], 0 offen offset:0
    v_mfma_f32_16x16x32_bf16 v[188:191], a[92:95], a[140:143], v[188:191]
    v_mfma_f32_16x16x32_bf16 v[204:207], a[96:99], a[140:143], v[204:207]
    v_mfma_f32_16x16x32_bf16 v[220:223], a[100:103], a[140:143], v[220:223]
    v_mfma_f32_16x16x32_bf16 v[236:239], a[104:107], a[140:143], v[236:239]
    v_mfma_f32_16x16x32_bf16 v[252:255], a[108:111], a[140:143], v[252:255]
    buffer_load_dwordx4 a[140:143], v4, s[20:23], s41 offen offset:2304
    s_waitcnt vmcnt(24) lgkmcnt(0)
    v_mfma_f32_16x16x32_bf16 v[32:35], a[0:3], a[144:147], v[32:35]
    v_mfma_f32_16x16x32_bf16 v[48:51], a[4:7], a[144:147], v[48:51]
    v_mfma_f32_16x16x32_bf16 v[64:67], a[8:11], a[144:147], v[64:67]
    ds_read_b64_tr_b16 a[56:57], v8 offset:35840
    v_mfma_f32_16x16x32_bf16 v[80:83], a[12:15], a[144:147], v[80:83]
    ds_read_b64_tr_b16 a[58:59], v8 offset:37632
    v_mfma_f32_16x16x32_bf16 v[96:99], a[16:19], a[144:147], v[96:99]
    v_mfma_f32_16x16x32_bf16 v[112:115], a[20:23], a[144:147], v[112:115]
    ds_read_b64_tr_b16 a[60:61], v8 offset:35872
    v_mfma_f32_16x16x32_bf16 v[128:131], a[24:27], a[144:147], v[128:131]
    ds_read_b64_tr_b16 a[62:63], v8 offset:37664
    v_mfma_f32_16x16x32_bf16 v[144:147], a[28:31], a[144:147], v[144:147]
    s_add_u32 m0, m0, 4096
    s_nop 0
    buffer_load_dwordx4 v13, s[24:27], s46 offen offset:0 lds
    v_mfma_f32_16x16x32_bf16 v[160:163], a[32:35], a[144:147], v[160:163]
    ds_read_b64_tr_b16 a[64:65], v8 offset:35904
    v_mfma_f32_16x16x32_bf16 v[176:179], a[36:39], a[144:147], v[176:179]
    ds_read_b64_tr_b16 a[66:67], v8 offset:37696
    v_mfma_f32_16x16x32_bf16 v[192:195], a[40:43], a[144:147], v[192:195]
    v_mfma_f32_16x16x32_bf16 v[208:211], a[44:47], a[144:147], v[208:211]
    ds_read_b64_tr_b16 a[68:69], v8 offset:35936
    v_mfma_f32_16x16x32_bf16 v[224:227], a[48:51], a[144:147], v[224:227]
    ds_read_b64_tr_b16 a[70:71], v8 offset:37728
    v_mfma_f32_16x16x32_bf16 v[240:243], a[52:55], a[144:147], v[240:243]
    v_mfma_f32_16x16x32_bf16 v[36:39], a[0:3], a[148:151], v[36:39]
    ds_read_b64_tr_b16 a[72:73], v8 offset:35968
    v_mfma_f32_16x16x32_bf16 v[52:55], a[4:7], a[148:151], v[52:55]
    ds_read_b64_tr_b16 a[74:75], v8 offset:37760
    v_mfma_f32_16x16x32_bf16 v[68:71], a[8:11], a[148:151], v[68:71]
    s_add_u32 s40, s40, 4096
    s_add_u32 s41, s41, 4096
    buffer_load_dwordx4 a[144:147], v4, s[20:23], s40 offen offset:0
    v_mfma_f32_16x16x32_bf16 v[84:87], a[12:15], a[148:151], v[84:87]
    ds_read_b64_tr_b16 a[76:77], v8 offset:36000
    v_mfma_f32_16x16x32_bf16 v[100:103], a[16:19], a[148:151], v[100:103]
    ds_read_b64_tr_b16 a[78:79], v8 offset:37792
    v_mfma_f32_16x16x32_bf16 v[116:119], a[20:23], a[148:151], v[116:119]
    buffer_load_dwordx4 v14, s[24:27], s46 offen offset:1024 lds
    v_mfma_f32_16x16x32_bf16 v[132:135], a[24:27], a[148:151], v[132:135]
    ds_read_b64_tr_b16 a[80:81], v8 offset:36032
    v_mfma_f32_16x16x32_bf16 v[148:151], a[28:31], a[148:151], v[148:151]
    ds_read_b64_tr_b16 a[82:83], v8 offset:37824
    v_mfma_f32_16x16x32_bf16 v[164:167], a[32:35], a[148:151], v[164:167]
    v_mfma_f32_16x16x32_bf16 v[180:183], a[36:39], a[148:151], v[180:183]
    ds_read_b64_tr_b16 a[84:85], v8 offset:50176
    v_mfma_f32_16x16x32_bf16 v[196:199], a[40:43], a[148:151], v[196:199]
    ds_read_b64_tr_b16 a[86:87], v8 offset:51968
    v_mfma_f32_16x16x32_bf16 v[212:215], a[44:47], a[148:151], v[212:215]
    v_mfma_f32_16x16x32_bf16 v[228:231], a[48:51], a[148:151], v[228:231]
    ds_read_b64_tr_b16 a[88:89], v8 offset:50208
    v_mfma_f32_16x16x32_bf16 v[244:247], a[52:55], a[148:151], v[244:247]
    ds_read_b64_tr_b16 a[90:91], v8 offset:52000
    v_mfma_f32_16x16x32_bf16 v[40:43], a[0:3], a[152:155], v[40:43]
    v_mfma_f32_16x16x32_bf16 v[56:59], a[4:7], a[152:155], v[56:59]
    ds_read_b64_tr_b16 a[92:93], v8 offset:50240
    v_mfma_f32_16x16x32_bf16 v[72:75], a[8:11], a[152:155], v[72:75]
    ds_read_b64_tr_b16 a[94:95], v8 offset:52032
    buffer_load_dwordx4 a[148:151], v4, s[20:23], s40 offen offset:256
    v_mfma_f32_16x16x32_bf16 v[88:91], a[12:15], a[152:155], v[88:91]
    buffer_load_dwordx4 v15, s[24:27], s46 offen offset:2048 lds
    v_mfma_f32_16x16x32_bf16 v[104:107], a[16:19], a[152:155], v[104:107]
    ds_read_b64_tr_b16 a[96:97], v8 offset:50272
    v_mfma_f32_16x16x32_bf16 v[120:123], a[20:23], a[152:155], v[120:123]
    ds_read_b64_tr_b16 a[98:99], v8 offset:52064
    v_mfma_f32_16x16x32_bf16 v[136:139], a[24:27], a[152:155], v[136:139]
    v_mfma_f32_16x16x32_bf16 v[152:155], a[28:31], a[152:155], v[152:155]
    ds_read_b64_tr_b16 a[100:101], v8 offset:50304
    v_mfma_f32_16x16x32_bf16 v[168:171], a[32:35], a[152:155], v[168:171]
    ds_read_b64_tr_b16 a[102:103], v8 offset:52096
    v_mfma_f32_16x16x32_bf16 v[184:187], a[36:39], a[152:155], v[184:187]
    v_mfma_f32_16x16x32_bf16 v[200:203], a[40:43], a[152:155], v[200:203]
    ds_read_b64_tr_b16 a[104:105], v8 offset:50336
    v_mfma_f32_16x16x32_bf16 v[216:219], a[44:47], a[152:155], v[216:219]
    ds_read_b64_tr_b16 a[106:107], v8 offset:52128
    v_mfma_f32_16x16x32_bf16 v[232:235], a[48:51], a[152:155], v[232:235]
    v_mfma_f32_16x16x32_bf16 v[248:251], a[52:55], a[152:155], v[248:251]
    ds_read_b64_tr_b16 a[108:109], v8 offset:50368
    v_mfma_f32_16x16x32_bf16 v[44:47], a[0:3], a[156:159], v[44:47]
    ds_read_b64_tr_b16 a[110:111], v8 offset:52160
    v_mfma_f32_16x16x32_bf16 v[60:63], a[4:7], a[156:159], v[60:63]
    v_mfma_f32_16x16x32_bf16 v[76:79], a[8:11], a[156:159], v[76:79]
    buffer_load_dwordx4 a[152:155], v4, s[20:23], s41 offen offset:0
    v_mfma_f32_16x16x32_bf16 v[92:95], a[12:15], a[156:159], v[92:95]
    v_mfma_f32_16x16x32_bf16 v[108:111], a[16:19], a[156:159], v[108:111]
    v_mfma_f32_16x16x32_bf16 v[124:127], a[20:23], a[156:159], v[124:127]
    v_mfma_f32_16x16x32_bf16 v[140:143], a[24:27], a[156:159], v[140:143]
    v_mfma_f32_16x16x32_bf16 v[156:159], a[28:31], a[156:159], v[156:159]
    v_mfma_f32_16x16x32_bf16 v[172:175], a[32:35], a[156:159], v[172:175]
    v_mfma_f32_16x16x32_bf16 v[188:191], a[36:39], a[156:159], v[188:191]
    v_mfma_f32_16x16x32_bf16 v[204:207], a[40:43], a[156:159], v[204:207]
    v_mfma_f32_16x16x32_bf16 v[220:223], a[44:47], a[156:159], v[220:223]
    v_mfma_f32_16x16x32_bf16 v[236:239], a[48:51], a[156:159], v[236:239]
    v_mfma_f32_16x16x32_bf16 v[252:255], a[52:55], a[156:159], v[252:255]
    buffer_load_dwordx4 a[156:159], v4, s[20:23], s41 offen offset:256
    s_waitcnt vmcnt(23) lgkmcnt(0)
    v_mfma_f32_16x16x32_bf16 v[32:35], a[56:59], a[160:163], v[32:35]
    v_mfma_f32_16x16x32_bf16 v[48:51], a[60:63], a[160:163], v[48:51]
    s_waitcnt vmcnt(18)
    s_barrier
    v_mfma_f32_16x16x32_bf16 v[64:67], a[64:67], a[160:163], v[64:67]
    ds_read_b64_tr_b16 a[0:1], v7 offset:0
    v_mfma_f32_16x16x32_bf16 v[80:83], a[68:71], a[160:163], v[80:83]
    ds_read_b64_tr_b16 a[2:3], v7 offset:1792
    v_mfma_f32_16x16x32_bf16 v[96:99], a[72:75], a[160:163], v[96:99]
    v_mfma_f32_16x16x32_bf16 v[112:115], a[76:79], a[160:163], v[112:115]
    ds_read_b64_tr_b16 a[4:5], v7 offset:32
    v_mfma_f32_16x16x32_bf16 v[128:131], a[80:83], a[160:163], v[128:131]
    ds_read_b64_tr_b16 a[6:7], v7 offset:1824
    v_mfma_f32_16x16x32_bf16 v[144:147], a[84:87], a[160:163], v[144:147]
    s_add_u32 m0, s42, 57344
    s_add_u32 s46, s46, 458752
    buffer_load_dwordx4 v9, s[24:27], s46 offen offset:0 lds
    v_mfma_f32_16x16x32_bf16 v[160:163], a[88:91], a[160:163], v[160:163]
    ds_read_b64_tr_b16 a[8:9], v7 offset:64
    v_mfma_f32_16x16x32_bf16 v[176:179], a[92:95], a[160:163], v[176:179]
    ds_read_b64_tr_b16 a[10:11], v7 offset:1856
    v_mfma_f32_16x16x32_bf16 v[192:195], a[96:99], a[160:163], v[192:195]
    v_mfma_f32_16x16x32_bf16 v[208:211], a[100:103], a[160:163], v[208:211]
    ds_read_b64_tr_b16 a[12:13], v7 offset:96
    v_mfma_f32_16x16x32_bf16 v[224:227], a[104:107], a[160:163], v[224:227]
    ds_read_b64_tr_b16 a[14:15], v7 offset:1888
    v_mfma_f32_16x16x32_bf16 v[240:243], a[108:111], a[160:163], v[240:243]
    v_mfma_f32_16x16x32_bf16 v[36:39], a[56:59], a[164:167], v[36:39]
    ds_read_b64_tr_b16 a[16:17], v7 offset:128
    v_mfma_f32_16x16x32_bf16 v[52:55], a[60:63], a[164:167], v[52:55]
    ds_read_b64_tr_b16 a[18:19], v7 offset:1920
    v_mfma_f32_16x16x32_bf16 v[68:71], a[64:67], a[164:167], v[68:71]
    buffer_load_dwordx4 a[160:163], v4, s[20:23], s40 offen offset:2048
    v_mfma_f32_16x16x32_bf16 v[84:87], a[68:71], a[164:167], v[84:87]
    ds_read_b64_tr_b16 a[20:21], v7 offset:160
    v_mfma_f32_16x16x32_bf16 v[100:103], a[72:75], a[164:167], v[100:103]
    ds_read_b64_tr_b16 a[22:23], v7 offset:1952
    v_mfma_f32_16x16x32_bf16 v[116:119], a[76:79], a[164:167], v[116:119]
    buffer_load_dwordx4 v10, s[24:27], s46 offen offset:1024 lds
    v_mfma_f32_16x16x32_bf16 v[132:135], a[80:83], a[164:167], v[132:135]
    ds_read_b64_tr_b16 a[24:25], v7 offset:192
    v_mfma_f32_16x16x32_bf16 v[148:151], a[84:87], a[164:167], v[148:151]
    ds_read_b64_tr_b16 a[26:27], v7 offset:1984
    v_mfma_f32_16x16x32_bf16 v[164:167], a[88:91], a[164:167], v[164:167]
    v_mfma_f32_16x16x32_bf16 v[180:183], a[92:95], a[164:167], v[180:183]
    ds_read_b64_tr_b16 a[28:29], v7 offset:14336
    v_mfma_f32_16x16x32_bf16 v[196:199], a[96:99], a[164:167], v[196:199]
    ds_read_b64_tr_b16 a[30:31], v7 offset:16128
    v_mfma_f32_16x16x32_bf16 v[212:215], a[100:103], a[164:167], v[212:215]
    v_mfma_f32_16x16x32_bf16 v[228:231], a[104:107], a[164:167], v[228:231]
    ds_read_b64_tr_b16 a[32:33], v7 offset:14368
    v_mfma_f32_16x16x32_bf16 v[244:247], a[108:111], a[164:167], v[244:247]
    ds_read_b64_tr_b16 a[34:35], v7 offset:16160
    v_mfma_f32_16x16x32_bf16 v[40:43], a[56:59], a[168:171], v[40:43]
    v_mfma_f32_16x16x32_bf16 v[56:59], a[60:63], a[168:171], v[56:59]
    ds_read_b64_tr_b16 a[36:37], v7 offset:14400
    v_mfma_f32_16x16x32_bf16 v[72:75], a[64:67], a[168:171], v[72:75]
    ds_read_b64_tr_b16 a[38:39], v7 offset:16192
    buffer_load_dwordx4 a[164:167], v4, s[20:23], s40 offen offset:2304
    v_mfma_f32_16x16x32_bf16 v[88:91], a[68:71], a[168:171], v[88:91]
    buffer_load_dwordx4 v11, s[24:27], s46 offen offset:2048 lds
    v_mfma_f32_16x16x32_bf16 v[104:107], a[72:75], a[168:171], v[104:107]
    ds_read_b64_tr_b16 a[40:41], v7 offset:14432
    v_mfma_f32_16x16x32_bf16 v[120:123], a[76:79], a[168:171], v[120:123]
    ds_read_b64_tr_b16 a[42:43], v7 offset:16224
    v_mfma_f32_16x16x32_bf16 v[136:139], a[80:83], a[168:171], v[136:139]
    v_mfma_f32_16x16x32_bf16 v[152:155], a[84:87], a[168:171], v[152:155]
    ds_read_b64_tr_b16 a[44:45], v7 offset:14464
    v_mfma_f32_16x16x32_bf16 v[168:171], a[88:91], a[168:171], v[168:171]
    ds_read_b64_tr_b16 a[46:47], v7 offset:16256
    v_mfma_f32_16x16x32_bf16 v[184:187], a[92:95], a[168:171], v[184:187]
    v_mfma_f32_16x16x32_bf16 v[200:203], a[96:99], a[168:171], v[200:203]
    ds_read_b64_tr_b16 a[48:49], v7 offset:14496
    v_mfma_f32_16x16x32_bf16 v[216:219], a[100:103], a[168:171], v[216:219]
    ds_read_b64_tr_b16 a[50:51], v7 offset:16288
    v_mfma_f32_16x16x32_bf16 v[232:235], a[104:107], a[168:171], v[232:235]
    v_mfma_f32_16x16x32_bf16 v[248:251], a[108:111], a[168:171], v[248:251]
    ds_read_b64_tr_b16 a[52:53], v7 offset:14528
    v_mfma_f32_16x16x32_bf16 v[44:47], a[56:59], a[172:175], v[44:47]
    ds_read_b64_tr_b16 a[54:55], v7 offset:16320
    v_mfma_f32_16x16x32_bf16 v[60:63], a[60:63], a[172:175], v[60:63]
    buffer_load_dwordx4 v12, s[24:27], s46 offen offset:3072 lds
    v_mfma_f32_16x16x32_bf16 v[76:79], a[64:67], a[172:175], v[76:79]
    buffer_load_dwordx4 a[168:171], v4, s[20:23], s41 offen offset:2048
    v_mfma_f32_16x16x32_bf16 v[92:95], a[68:71], a[172:175], v[92:95]
    v_mfma_f32_16x16x32_bf16 v[108:111], a[72:75], a[172:175], v[108:111]
    v_mfma_f32_16x16x32_bf16 v[124:127], a[76:79], a[172:175], v[124:127]
    v_mfma_f32_16x16x32_bf16 v[140:143], a[80:83], a[172:175], v[140:143]
    v_mfma_f32_16x16x32_bf16 v[156:159], a[84:87], a[172:175], v[156:159]
    v_mfma_f32_16x16x32_bf16 v[172:175], a[88:91], a[172:175], v[172:175]
    v_mfma_f32_16x16x32_bf16 v[188:191], a[92:95], a[172:175], v[188:191]
    v_mfma_f32_16x16x32_bf16 v[204:207], a[96:99], a[172:175], v[204:207]
    v_mfma_f32_16x16x32_bf16 v[220:223], a[100:103], a[172:175], v[220:223]
    v_mfma_f32_16x16x32_bf16 v[236:239], a[104:107], a[172:175], v[236:239]
    v_mfma_f32_16x16x32_bf16 v[252:255], a[108:111], a[172:175], v[252:255]
    buffer_load_dwordx4 a[172:175], v4, s[20:23], s41 offen offset:2304
    s_waitcnt vmcnt(24) lgkmcnt(0)
    v_mfma_f32_16x16x32_bf16 v[32:35], a[0:3], a[112:115], v[32:35]
    v_mfma_f32_16x16x32_bf16 v[48:51], a[4:7], a[112:115], v[48:51]
    v_mfma_f32_16x16x32_bf16 v[64:67], a[8:11], a[112:115], v[64:67]
    ds_read_b64_tr_b16 a[56:57], v7 offset:7168
    v_mfma_f32_16x16x32_bf16 v[80:83], a[12:15], a[112:115], v[80:83]
    ds_read_b64_tr_b16 a[58:59], v7 offset:8960
    v_mfma_f32_16x16x32_bf16 v[96:99], a[16:19], a[112:115], v[96:99]
    v_mfma_f32_16x16x32_bf16 v[112:115], a[20:23], a[112:115], v[112:115]
    ds_read_b64_tr_b16 a[60:61], v7 offset:7200
    v_mfma_f32_16x16x32_bf16 v[128:131], a[24:27], a[112:115], v[128:131]
    ds_read_b64_tr_b16 a[62:63], v7 offset:8992
    v_mfma_f32_16x16x32_bf16 v[144:147], a[28:31], a[112:115], v[144:147]
    s_add_u32 m0, m0, 4096
    s_nop 0
    buffer_load_dwordx4 v13, s[24:27], s46 offen offset:0 lds
    v_mfma_f32_16x16x32_bf16 v[160:163], a[32:35], a[112:115], v[160:163]
    ds_read_b64_tr_b16 a[64:65], v7 offset:7232
    v_mfma_f32_16x16x32_bf16 v[176:179], a[36:39], a[112:115], v[176:179]
    ds_read_b64_tr_b16 a[66:67], v7 offset:9024
    v_mfma_f32_16x16x32_bf16 v[192:195], a[40:43], a[112:115], v[192:195]
    v_mfma_f32_16x16x32_bf16 v[208:211], a[44:47], a[112:115], v[208:211]
    ds_read_b64_tr_b16 a[68:69], v7 offset:7264
    v_mfma_f32_16x16x32_bf16 v[224:227], a[48:51], a[112:115], v[224:227]
    ds_read_b64_tr_b16 a[70:71], v7 offset:9056
    v_mfma_f32_16x16x32_bf16 v[240:243], a[52:55], a[112:115], v[240:243]
    v_mfma_f32_16x16x32_bf16 v[36:39], a[0:3], a[116:119], v[36:39]
    ds_read_b64_tr_b16 a[72:73], v7 offset:7296
    v_mfma_f32_16x16x32_bf16 v[52:55], a[4:7], a[116:119], v[52:55]
    ds_read_b64_tr_b16 a[74:75], v7 offset:9088
    v_mfma_f32_16x16x32_bf16 v[68:71], a[8:11], a[116:119], v[68:71]
    s_add_u32 s40, s40, 4096
    s_add_u32 s41, s41, 4096
    buffer_load_dwordx4 a[112:115], v4, s[20:23], s40 offen offset:0
    v_mfma_f32_16x16x32_bf16 v[84:87], a[12:15], a[116:119], v[84:87]
    ds_read_b64_tr_b16 a[76:77], v7 offset:7328
    v_mfma_f32_16x16x32_bf16 v[100:103], a[16:19], a[116:119], v[100:103]
    ds_read_b64_tr_b16 a[78:79], v7 offset:9120
    v_mfma_f32_16x16x32_bf16 v[116:119], a[20:23], a[116:119], v[116:119]
    buffer_load_dwordx4 v14, s[24:27], s46 offen offset:1024 lds
    v_mfma_f32_16x16x32_bf16 v[132:135], a[24:27], a[116:119], v[132:135]
    ds_read_b64_tr_b16 a[80:81], v7 offset:7360
    v_mfma_f32_16x16x32_bf16 v[148:151], a[28:31], a[116:119], v[148:151]
    ds_read_b64_tr_b16 a[82:83], v7 offset:9152
    v_mfma_f32_16x16x32_bf16 v[164:167], a[32:35], a[116:119], v[164:167]
    v_mfma_f32_16x16x32_bf16 v[180:183], a[36:39], a[116:119], v[180:183]
    ds_read_b64_tr_b16 a[84:85], v7 offset:21504
    v_mfma_f32_16x16x32_bf16 v[196:199], a[40:43], a[116:119], v[196:199]
    ds_read_b64_tr_b16 a[86:87], v7 offset:23296
    v_mfma_f32_16x16x32_bf16 v[212:215], a[44:47], a[116:119], v[212:215]
    v_mfma_f32_16x16x32_bf16 v[228:231], a[48:51], a[116:119], v[228:231]
    ds_read_b64_tr_b16 a[88:89], v7 offset:21536
    v_mfma_f32_16x16x32_bf16 v[244:247], a[52:55], a[116:119], v[244:247]
    ds_read_b64_tr_b16 a[90:91], v7 offset:23328
    v_mfma_f32_16x16x32_bf16 v[40:43], a[0:3], a[120:123], v[40:43]
    v_mfma_f32_16x16x32_bf16 v[56:59], a[4:7], a[120:123], v[56:59]
    ds_read_b64_tr_b16 a[92:93], v7 offset:21568
    v_mfma_f32_16x16x32_bf16 v[72:75], a[8:11], a[120:123], v[72:75]
    ds_read_b64_tr_b16 a[94:95], v7 offset:23360
    buffer_load_dwordx4 a[116:119], v4, s[20:23], s40 offen offset:256
    v_mfma_f32_16x16x32_bf16 v[88:91], a[12:15], a[120:123], v[88:91]
    buffer_load_dwordx4 v15, s[24:27], s46 offen offset:2048 lds
    v_mfma_f32_16x16x32_bf16 v[104:107], a[16:19], a[120:123], v[104:107]
    ds_read_b64_tr_b16 a[96:97], v7 offset:21600
    v_mfma_f32_16x16x32_bf16 v[120:123], a[20:23], a[120:123], v[120:123]
    ds_read_b64_tr_b16 a[98:99], v7 offset:23392
    v_mfma_f32_16x16x32_bf16 v[136:139], a[24:27], a[120:123], v[136:139]
    v_mfma_f32_16x16x32_bf16 v[152:155], a[28:31], a[120:123], v[152:155]
    ds_read_b64_tr_b16 a[100:101], v7 offset:21632
    v_mfma_f32_16x16x32_bf16 v[168:171], a[32:35], a[120:123], v[168:171]
    ds_read_b64_tr_b16 a[102:103], v7 offset:23424
    v_mfma_f32_16x16x32_bf16 v[184:187], a[36:39], a[120:123], v[184:187]
    v_mfma_f32_16x16x32_bf16 v[200:203], a[40:43], a[120:123], v[200:203]
    ds_read_b64_tr_b16 a[104:105], v7 offset:21664
    v_mfma_f32_16x16x32_bf16 v[216:219], a[44:47], a[120:123], v[216:219]
    ds_read_b64_tr_b16 a[106:107], v7 offset:23456
    v_mfma_f32_16x16x32_bf16 v[232:235], a[48:51], a[120:123], v[232:235]
    v_mfma_f32_16x16x32_bf16 v[248:251], a[52:55], a[120:123], v[248:251]
    ds_read_b64_tr_b16 a[108:109], v7 offset:21696
    v_mfma_f32_16x16x32_bf16 v[44:47], a[0:3], a[124:127], v[44:47]
    ds_read_b64_tr_b16 a[110:111], v7 offset:23488
    v_mfma_f32_16x16x32_bf16 v[60:63], a[4:7], a[124:127], v[60:63]
    v_mfma_f32_16x16x32_bf16 v[76:79], a[8:11], a[124:127], v[76:79]
    buffer_load_dwordx4 a[120:123], v4, s[20:23], s41 offen offset:0
    v_mfma_f32_16x16x32_bf16 v[92:95], a[12:15], a[124:127], v[92:95]
    v_mfma_f32_16x16x32_bf16 v[108:111], a[16:19], a[124:127], v[108:111]
    v_mfma_f32_16x16x32_bf16 v[124:127], a[20:23], a[124:127], v[124:127]
    v_mfma_f32_16x16x32_bf16 v[140:143], a[24:27], a[124:127], v[140:143]
    v_mfma_f32_16x16x32_bf16 v[156:159], a[28:31], a[124:127], v[156:159]
    v_mfma_f32_16x16x32_bf16 v[172:175], a[32:35], a[124:127], v[172:175]
    v_mfma_f32_16x16x32_bf16 v[188:191], a[36:39], a[124:127], v[188:191]
    v_mfma_f32_16x16x32_bf16 v[204:207], a[40:43], a[124:127], v[204:207]
    v_mfma_f32_16x16x32_bf16 v[220:223], a[44:47], a[124:127], v[220:223]
    v_mfma_f32_16x16x32_bf16 v[236:239], a[48:51], a[124:127], v[236:239]
    v_mfma_f32_16x16x32_bf16 v[252:255], a[52:55], a[124:127], v[252:255]
    buffer_load_dwordx4 a[124:127], v4, s[20:23], s41 offen offset:256
    s_waitcnt vmcnt(22) lgkmcnt(0)
    v_mfma_f32_16x16x32_bf16 v[32:35], a[56:59], a[128:131], v[32:35]
    v_mfma_f32_16x16x32_bf16 v[48:51], a[60:63], a[128:131], v[48:51]
    s_waitcnt vmcnt(17)
    s_barrier
    v_mfma_f32_16x16x32_bf16 v[64:67], a[64:67], a[128:131], v[64:67]
    ds_read_b64_tr_b16 a[0:1], v7 offset:28672
    v_mfma_f32_16x16x32_bf16 v[80:83], a[68:71], a[128:131], v[80:83]
    ds_read_b64_tr_b16 a[2:3], v7 offset:30464
    v_mfma_f32_16x16x32_bf16 v[96:99], a[72:75], a[128:131], v[96:99]
    v_mfma_f32_16x16x32_bf16 v[112:115], a[76:79], a[128:131], v[112:115]
    ds_read_b64_tr_b16 a[4:5], v7 offset:28704
    v_mfma_f32_16x16x32_bf16 v[128:131], a[80:83], a[128:131], v[128:131]
    ds_read_b64_tr_b16 a[6:7], v7 offset:30496
    v_mfma_f32_16x16x32_bf16 v[144:147], a[84:87], a[128:131], v[144:147]
    s_add_u32 m0, s42, 86016
    s_add_u32 s46, s46, 458752
    buffer_load_dwordx4 v9, s[24:27], s46 offen offset:0 lds
    v_mfma_f32_16x16x32_bf16 v[160:163], a[88:91], a[128:131], v[160:163]
    ds_read_b64_tr_b16 a[8:9], v7 offset:28736
    v_mfma_f32_16x16x32_bf16 v[176:179], a[92:95], a[128:131], v[176:179]
    ds_read_b64_tr_b16 a[10:11], v7 offset:30528
    v_mfma_f32_16x16x32_bf16 v[192:195], a[96:99], a[128:131], v[192:195]
    v_mfma_f32_16x16x32_bf16 v[208:211], a[100:103], a[128:131], v[208:211]
    ds_read_b64_tr_b16 a[12:13], v7 offset:28768
    v_mfma_f32_16x16x32_bf16 v[224:227], a[104:107], a[128:131], v[224:227]
    ds_read_b64_tr_b16 a[14:15], v7 offset:30560
    v_mfma_f32_16x16x32_bf16 v[240:243], a[108:111], a[128:131], v[240:243]
    v_mfma_f32_16x16x32_bf16 v[36:39], a[56:59], a[132:135], v[36:39]
    ds_read_b64_tr_b16 a[16:17], v7 offset:28800
    v_mfma_f32_16x16x32_bf16 v[52:55], a[60:63], a[132:135], v[52:55]
    ds_read_b64_tr_b16 a[18:19], v7 offset:30592
    v_mfma_f32_16x16x32_bf16 v[68:71], a[64:67], a[132:135], v[68:71]
    buffer_load_dwordx4 a[128:131], v4, s[20:23], s40 offen offset:2048
    v_mfma_f32_16x16x32_bf16 v[84:87], a[68:71], a[132:135], v[84:87]
    ds_read_b64_tr_b16 a[20:21], v7 offset:28832
    v_mfma_f32_16x16x32_bf16 v[100:103], a[72:75], a[132:135], v[100:103]
    ds_read_b64_tr_b16 a[22:23], v7 offset:30624
    v_mfma_f32_16x16x32_bf16 v[116:119], a[76:79], a[132:135], v[116:119]
    buffer_load_dwordx4 v10, s[24:27], s46 offen offset:1024 lds
    v_mfma_f32_16x16x32_bf16 v[132:135], a[80:83], a[132:135], v[132:135]
    ds_read_b64_tr_b16 a[24:25], v7 offset:28864
    v_mfma_f32_16x16x32_bf16 v[148:151], a[84:87], a[132:135], v[148:151]
    ds_read_b64_tr_b16 a[26:27], v7 offset:30656
    v_mfma_f32_16x16x32_bf16 v[164:167], a[88:91], a[132:135], v[164:167]
    v_mfma_f32_16x16x32_bf16 v[180:183], a[92:95], a[132:135], v[180:183]
    ds_read_b64_tr_b16 a[28:29], v7 offset:43008
    v_mfma_f32_16x16x32_bf16 v[196:199], a[96:99], a[132:135], v[196:199]
    ds_read_b64_tr_b16 a[30:31], v7 offset:44800
    v_mfma_f32_16x16x32_bf16 v[212:215], a[100:103], a[132:135], v[212:215]
    v_mfma_f32_16x16x32_bf16 v[228:231], a[104:107], a[132:135], v[228:231]
    ds_read_b64_tr_b16 a[32:33], v7 offset:43040
    v_mfma_f32_16x16x32_bf16 v[244:247], a[108:111], a[132:135], v[244:247]
    ds_read_b64_tr_b16 a[34:35], v7 offset:44832
    v_mfma_f32_16x16x32_bf16 v[40:43], a[56:59], a[136:139], v[40:43]
    v_mfma_f32_16x16x32_bf16 v[56:59], a[60:63], a[136:139], v[56:59]
    ds_read_b64_tr_b16 a[36:37], v7 offset:43072
    v_mfma_f32_16x16x32_bf16 v[72:75], a[64:67], a[136:139], v[72:75]
    ds_read_b64_tr_b16 a[38:39], v7 offset:44864
    buffer_load_dwordx4 a[132:135], v4, s[20:23], s40 offen offset:2304
    v_mfma_f32_16x16x32_bf16 v[88:91], a[68:71], a[136:139], v[88:91]
    buffer_load_dwordx4 v11, s[24:27], s46 offen offset:2048 lds
    v_mfma_f32_16x16x32_bf16 v[104:107], a[72:75], a[136:139], v[104:107]
    ds_read_b64_tr_b16 a[40:41], v7 offset:43104
    v_mfma_f32_16x16x32_bf16 v[120:123], a[76:79], a[136:139], v[120:123]
    ds_read_b64_tr_b16 a[42:43], v7 offset:44896
    v_mfma_f32_16x16x32_bf16 v[136:139], a[80:83], a[136:139], v[136:139]
    v_mfma_f32_16x16x32_bf16 v[152:155], a[84:87], a[136:139], v[152:155]
    ds_read_b64_tr_b16 a[44:45], v7 offset:43136
    v_mfma_f32_16x16x32_bf16 v[168:171], a[88:91], a[136:139], v[168:171]
    ds_read_b64_tr_b16 a[46:47], v7 offset:44928
    v_mfma_f32_16x16x32_bf16 v[184:187], a[92:95], a[136:139], v[184:187]
    v_mfma_f32_16x16x32_bf16 v[200:203], a[96:99], a[136:139], v[200:203]
    ds_read_b64_tr_b16 a[48:49], v7 offset:43168
    v_mfma_f32_16x16x32_bf16 v[216:219], a[100:103], a[136:139], v[216:219]
    ds_read_b64_tr_b16 a[50:51], v7 offset:44960
    v_mfma_f32_16x16x32_bf16 v[232:235], a[104:107], a[136:139], v[232:235]
    v_mfma_f32_16x16x32_bf16 v[248:251], a[108:111], a[136:139], v[248:251]
    ds_read_b64_tr_b16 a[52:53], v7 offset:43200
    v_mfma_f32_16x16x32_bf16 v[44:47], a[56:59], a[140:143], v[44:47]
    ds_read_b64_tr_b16 a[54:55], v7 offset:44992
    v_mfma_f32_16x16x32_bf16 v[60:63], a[60:63], a[140:143], v[60:63]
    buffer_load_dwordx4 v12, s[24:27], s46 offen offset:3072 lds
    v_mfma_f32_16x16x32_bf16 v[76:79], a[64:67], a[140:143], v[76:79]
    buffer_load_dwordx4 a[136:139], v4, s[20:23], s41 offen offset:2048
    v_mfma_f32_16x16x32_bf16 v[92:95], a[68:71], a[140:143], v[92:95]
    v_mfma_f32_16x16x32_bf16 v[108:111], a[72:75], a[140:143], v[108:111]
    v_mfma_f32_16x16x32_bf16 v[124:127], a[76:79], a[140:143], v[124:127]
    v_mfma_f32_16x16x32_bf16 v[140:143], a[80:83], a[140:143], v[140:143]
    v_mfma_f32_16x16x32_bf16 v[156:159], a[84:87], a[140:143], v[156:159]
    v_mfma_f32_16x16x32_bf16 v[172:175], a[88:91], a[140:143], v[172:175]
    buffer_load_dword v27, v26, s[56:59], 0 offen offset:2048
    v_mfma_f32_16x16x32_bf16 v[188:191], a[92:95], a[140:143], v[188:191]
    v_mfma_f32_16x16x32_bf16 v[204:207], a[96:99], a[140:143], v[204:207]
    v_add_u32 v26, 0x40000000, v26
    v_mfma_f32_16x16x32_bf16 v[220:223], a[100:103], a[140:143], v[220:223]
    v_mfma_f32_16x16x32_bf16 v[236:239], a[104:107], a[140:143], v[236:239]
    v_mfma_f32_16x16x32_bf16 v[252:255], a[108:111], a[140:143], v[252:255]
    buffer_load_dwordx4 a[140:143], v4, s[20:23], s41 offen offset:2304
    s_waitcnt vmcnt(24) lgkmcnt(0)
    v_mfma_f32_16x16x32_bf16 v[32:35], a[0:3], a[144:147], v[32:35]
    v_mfma_f32_16x16x32_bf16 v[48:51], a[4:7], a[144:147], v[48:51]
    v_mfma_f32_16x16x32_bf16 v[64:67], a[8:11], a[144:147], v[64:67]
    ds_read_b64_tr_b16 a[56:57], v7 offset:35840
    v_mfma_f32_16x16x32_bf16 v[80:83], a[12:15], a[144:147], v[80:83]
    ds_read_b64_tr_b16 a[58:59], v7 offset:37632
    v_mfma_f32_16x16x32_bf16 v[96:99], a[16:19], a[144:147], v[96:99]
    v_mfma_f32_16x16x32_bf16 v[112:115], a[20:23], a[144:147], v[112:115]
    ds_read_b64_tr_b16 a[60:61], v7 offset:35872
    v_mfma_f32_16x16x32_bf16 v[128:131], a[24:27], a[144:147], v[128:131]
    ds_read_b64_tr_b16 a[62:63], v7 offset:37664
    v_mfma_f32_16x16x32_bf16 v[144:147], a[28:31], a[144:147], v[144:147]
    s_add_u32 m0, m0, 4096
    s_nop 0
    buffer_load_dwordx4 v13, s[24:27], s46 offen offset:0 lds
    v_mfma_f32_16x16x32_bf16 v[160:163], a[32:35], a[144:147], v[160:163]
    ds_read_b64_tr_b16 a[64:65], v7 offset:35904
    v_mfma_f32_16x16x32_bf16 v[176:179], a[36:39], a[144:147], v[176:179]
    ds_read_b64_tr_b16 a[66:67], v7 offset:37696
    v_mfma_f32_16x16x32_bf16 v[192:195], a[40:43], a[144:147], v[192:195]
    v_mfma_f32_16x16x32_bf16 v[208:211], a[44:47], a[144:147], v[208:211]
    ds_read_b64_tr_b16 a[68:69], v7 offset:35936
    v_mfma_f32_16x16x32_bf16 v[224:227], a[48:51], a[144:147], v[224:227]
    ds_read_b64_tr_b16 a[70:71], v7 offset:37728
    v_mfma_f32_16x16x32_bf16 v[240:243], a[52:55], a[144:147], v[240:243]
    v_mfma_f32_16x16x32_bf16 v[36:39], a[0:3], a[148:151], v[36:39]
    ds_read_b64_tr_b16 a[72:73], v7 offset:35968
    v_mfma_f32_16x16x32_bf16 v[52:55], a[4:7], a[148:151], v[52:55]
    ds_read_b64_tr_b16 a[74:75], v7 offset:37760
    v_mfma_f32_16x16x32_bf16 v[68:71], a[8:11], a[148:151], v[68:71]
    s_add_u32 s40, s40, 4096
    s_add_u32 s41, s41, 4096
    buffer_load_dwordx4 a[144:147], v4, s[20:23], s40 offen offset:0
    v_mfma_f32_16x16x32_bf16 v[84:87], a[12:15], a[148:151], v[84:87]
    ds_read_b64_tr_b16 a[76:77], v7 offset:36000
    v_mfma_f32_16x16x32_bf16 v[100:103], a[16:19], a[148:151], v[100:103]
    ds_read_b64_tr_b16 a[78:79], v7 offset:37792
    v_mfma_f32_16x16x32_bf16 v[116:119], a[20:23], a[148:151], v[116:119]
    buffer_load_dwordx4 v14, s[24:27], s46 offen offset:1024 lds
    v_mfma_f32_16x16x32_bf16 v[132:135], a[24:27], a[148:151], v[132:135]
    ds_read_b64_tr_b16 a[80:81], v7 offset:36032
    v_mfma_f32_16x16x32_bf16 v[148:151], a[28:31], a[148:151], v[148:151]
    ds_read_b64_tr_b16 a[82:83], v7 offset:37824
    v_mfma_f32_16x16x32_bf16 v[164:167], a[32:35], a[148:151], v[164:167]
    v_mfma_f32_16x16x32_bf16 v[180:183], a[36:39], a[148:151], v[180:183]
    ds_read_b64_tr_b16 a[84:85], v7 offset:50176
    v_mfma_f32_16x16x32_bf16 v[196:199], a[40:43], a[148:151], v[196:199]
    ds_read_b64_tr_b16 a[86:87], v7 offset:51968
    v_mfma_f32_16x16x32_bf16 v[212:215], a[44:47], a[148:151], v[212:215]
    v_mfma_f32_16x16x32_bf16 v[228:231], a[48:51], a[148:151], v[228:231]
    ds_read_b64_tr_b16 a[88:89], v7 offset:50208
    v_mfma_f32_16x16x32_bf16 v[244:247], a[52:55], a[148:151], v[244:247]
    ds_read_b64_tr_b16 a[90:91], v7 offset:52000
    v_mfma_f32_16x16x32_bf16 v[40:43], a[0:3], a[152:155], v[40:43]
    v_mfma_f32_16x16x32_bf16 v[56:59], a[4:7], a[152:155], v[56:59]
    ds_read_b64_tr_b16 a[92:93], v7 offset:50240
    v_mfma_f32_16x16x32_bf16 v[72:75], a[8:11], a[152:155], v[72:75]
    ds_read_b64_tr_b16 a[94:95], v7 offset:52032
    buffer_load_dwordx4 a[148:151], v4, s[20:23], s40 offen offset:256
    v_mfma_f32_16x16x32_bf16 v[88:91], a[12:15], a[152:155], v[88:91]
    buffer_load_dwordx4 v15, s[24:27], s46 offen offset:2048 lds
    v_mfma_f32_16x16x32_bf16 v[104:107], a[16:19], a[152:155], v[104:107]
    ds_read_b64_tr_b16 a[96:97], v7 offset:50272
    v_mfma_f32_16x16x32_bf16 v[120:123], a[20:23], a[152:155], v[120:123]
    ds_read_b64_tr_b16 a[98:99], v7 offset:52064
    v_mfma_f32_16x16x32_bf16 v[136:139], a[24:27], a[152:155], v[136:139]
    v_mfma_f32_16x16x32_bf16 v[152:155], a[28:31], a[152:155], v[152:155]
    ds_read_b64_tr_b16 a[100:101], v7 offset:50304
    v_mfma_f32_16x16x32_bf16 v[168:171], a[32:35], a[152:155], v[168:171]
    ds_read_b64_tr_b16 a[102:103], v7 offset:52096
    v_mfma_f32_16x16x32_bf16 v[184:187], a[36:39], a[152:155], v[184:187]
    v_mfma_f32_16x16x32_bf16 v[200:203], a[40:43], a[152:155], v[200:203]
    ds_read_b64_tr_b16 a[104:105], v7 offset:50336
    v_mfma_f32_16x16x32_bf16 v[216:219], a[44:47], a[152:155], v[216:219]
    ds_read_b64_tr_b16 a[106:107], v7 offset:52128
    v_mfma_f32_16x16x32_bf16 v[232:235], a[48:51], a[152:155], v[232:235]
    v_mfma_f32_16x16x32_bf16 v[248:251], a[52:55], a[152:155], v[248:251]
    ds_read_b64_tr_b16 a[108:109], v7 offset:50368
    v_mfma_f32_16x16x32_bf16 v[44:47], a[0:3], a[156:159], v[44:47]
    ds_read_b64_tr_b16 a[110:111], v7 offset:52160
    v_mfma_f32_16x16x32_bf16 v[60:63], a[4:7], a[156:159], v[60:63]
    v_mfma_f32_16x16x32_bf16 v[76:79], a[8:11], a[156:159], v[76:79]
    buffer_load_dwordx4 a[152:155], v4, s[20:23], s41 offen offset:0
    v_mfma_f32_16x16x32_bf16 v[92:95], a[12:15], a[156:159], v[92:95]
    v_mfma_f32_16x16x32_bf16 v[108:111], a[16:19], a[156:159], v[108:111]
    v_mfma_f32_16x16x32_bf16 v[124:127], a[20:23], a[156:159], v[124:127]
    v_mfma_f32_16x16x32_bf16 v[140:143], a[24:27], a[156:159], v[140:143]
    v_mfma_f32_16x16x32_bf16 v[156:159], a[28:31], a[156:159], v[156:159]
    v_mfma_f32_16x16x32_bf16 v[172:175], a[32:35], a[156:159], v[172:175]
    v_mfma_f32_16x16x32_bf16 v[188:191], a[36:39], a[156:159], v[188:191]
    v_mfma_f32_16x16x32_bf16 v[204:207], a[40:43], a[156:159], v[204:207]
    v_mfma_f32_16x16x32_bf16 v[220:223], a[44:47], a[156:159], v[220:223]
    v_mfma_f32_16x16x32_bf16 v[236:239], a[48:51], a[156:159], v[236:239]
    v_mfma_f32_16x16x32_bf16 v[252:255], a[52:55], a[156:159], v[252:255]
    buffer_load_dwordx4 a[156:159], v4, s[20:23], s41 offen offset:256
    s_sub_u32 s44, s44, 1
    s_cmp_lg_u32 s44, 0
    s_cbranch_scc1 L_k4_glu_kernel_main_1
    s_waitcnt vmcnt(23) lgkmcnt(0)
    v_mfma_f32_16x16x32_bf16 v[32:35], a[56:59], a[160:163], v[32:35]
    v_mfma_f32_16x16x32_bf16 v[48:51], a[60:63], a[160:163], v[48:51]
    s_waitcnt vmcnt(18)
    s_barrier
    v_mfma_f32_16x16x32_bf16 v[64:67], a[64:67], a[160:163], v[64:67]
    ds_read_b64_tr_b16 a[0:1], v8 offset:0
    v_mfma_f32_16x16x32_bf16 v[80:83], a[68:71], a[160:163], v[80:83]
    ds_read_b64_tr_b16 a[2:3], v8 offset:1792
    v_mfma_f32_16x16x32_bf16 v[96:99], a[72:75], a[160:163], v[96:99]
    s_add_u32 m0, s61, 0
    s_nop 0
    buffer_load_dwordx4 v21, s[56:59], s60 offen offset:0 lds
    v_mfma_f32_16x16x32_bf16 v[112:115], a[76:79], a[160:163], v[112:115]
    ds_read_b64_tr_b16 a[4:5], v8 offset:32
    v_mfma_f32_16x16x32_bf16 v[128:131], a[80:83], a[160:163], v[128:131]
    ds_read_b64_tr_b16 a[6:7], v8 offset:1824
    v_mfma_f32_16x16x32_bf16 v[144:147], a[84:87], a[160:163], v[144:147]
    v_mfma_f32_16x16x32_bf16 v[160:163], a[88:91], a[160:163], v[160:163]
    ds_read_b64_tr_b16 a[8:9], v8 offset:64
    v_mfma_f32_16x16x32_bf16 v[176:179], a[92:95], a[160:163], v[176:179]
    ds_read_b64_tr_b16 a[10:11], v8 offset:1856
    v_mfma_f32_16x16x32_bf16 v[192:195], a[96:99], a[160:163], v[192:195]
    buffer_load_dwordx4 v22, s[56:59], s60 offen offset:1024 lds
    v_mfma_f32_16x16x32_bf16 v[208:211], a[100:103], a[160:163], v[208:211]
    ds_read_b64_tr_b16 a[12:13], v8 offset:96
    v_mfma_f32_16x16x32_bf16 v[224:227], a[104:107], a[160:163], v[224:227]
    ds_read_b64_tr_b16 a[14:15], v8 offset:1888
    v_mfma_f32_16x16x32_bf16 v[240:243], a[108:111], a[160:163], v[240:243]
    v_mfma_f32_16x16x32_bf16 v[36:39], a[56:59], a[164:167], v[36:39]
    ds_read_b64_tr_b16 a[16:17], v8 offset:128
    v_mfma_f32_16x16x32_bf16 v[52:55], a[60:63], a[164:167], v[52:55]
    ds_read_b64_tr_b16 a[18:19], v8 offset:1920
    v_mfma_f32_16x16x32_bf16 v[68:71], a[64:67], a[164:167], v[68:71]
    buffer_load_dwordx4 a[160:163], v4, s[20:23], s40 offen offset:2048
    buffer_load_dwordx4 v23, s[56:59], s60 offen offset:2048 lds
    v_mfma_f32_16x16x32_bf16 v[84:87], a[68:71], a[164:167], v[84:87]
    ds_read_b64_tr_b16 a[20:21], v8 offset:160
    v_mfma_f32_16x16x32_bf16 v[100:103], a[72:75], a[164:167], v[100:103]
    ds_read_b64_tr_b16 a[22:23], v8 offset:1952
    v_mfma_f32_16x16x32_bf16 v[116:119], a[76:79], a[164:167], v[116:119]
    v_mfma_f32_16x16x32_bf16 v[132:135], a[80:83], a[164:167], v[132:135]
    ds_read_b64_tr_b16 a[24:25], v8 offset:192
    v_mfma_f32_16x16x32_bf16 v[148:151], a[84:87], a[164:167], v[148:151]
    ds_read_b64_tr_b16 a[26:27], v8 offset:1984
    v_mfma_f32_16x16x32_bf16 v[164:167], a[88:91], a[164:167], v[164:167]
    v_mfma_f32_16x16x32_bf16 v[180:183], a[92:95], a[164:167], v[180:183]
    ds_read_b64_tr_b16 a[28:29], v8 offset:14336
    v_mfma_f32_16x16x32_bf16 v[196:199], a[96:99], a[164:167], v[196:199]
    ds_read_b64_tr_b16 a[30:31], v8 offset:16128
    v_mfma_f32_16x16x32_bf16 v[212:215], a[100:103], a[164:167], v[212:215]
    buffer_load_dwordx4 v24, s[56:59], s60 offen offset:3072 lds
    v_mfma_f32_16x16x32_bf16 v[228:231], a[104:107], a[164:167], v[228:231]
    ds_read_b64_tr_b16 a[32:33], v8 offset:14368
    v_mfma_f32_16x16x32_bf16 v[244:247], a[108:111], a[164:167], v[244:247]
    ds_read_b64_tr_b16 a[34:35], v8 offset:16160
    v_mfma_f32_16x16x32_bf16 v[40:43], a[56:59], a[168:171], v[40:43]
    v_mfma_f32_16x16x32_bf16 v[56:59], a[60:63], a[168:171], v[56:59]
    ds_read_b64_tr_b16 a[36:37], v8 offset:14400
    v_mfma_f32_16x16x32_bf16 v[72:75], a[64:67], a[168:171], v[72:75]
    ds_read_b64_tr_b16 a[38:39], v8 offset:16192
    buffer_load_dwordx4 a[164:167], v4, s[20:23], s40 offen offset:2304
    v_mfma_f32_16x16x32_bf16 v[88:91], a[68:71], a[168:171], v[88:91]
    s_add_u32 m0, s61, 4096
    s_add_u32 s60, s60, 32768
    buffer_load_dwordx4 v21, s[56:59], s60 offen offset:0 lds
    v_mfma_f32_16x16x32_bf16 v[104:107], a[72:75], a[168:171], v[104:107]
    ds_read_b64_tr_b16 a[40:41], v8 offset:14432
    v_mfma_f32_16x16x32_bf16 v[120:123], a[76:79], a[168:171], v[120:123]
    ds_read_b64_tr_b16 a[42:43], v8 offset:16224
    v_mfma_f32_16x16x32_bf16 v[136:139], a[80:83], a[168:171], v[136:139]
    v_mfma_f32_16x16x32_bf16 v[152:155], a[84:87], a[168:171], v[152:155]
    ds_read_b64_tr_b16 a[44:45], v8 offset:14464
    v_mfma_f32_16x16x32_bf16 v[168:171], a[88:91], a[168:171], v[168:171]
    ds_read_b64_tr_b16 a[46:47], v8 offset:16256
    v_mfma_f32_16x16x32_bf16 v[184:187], a[92:95], a[168:171], v[184:187]
    v_mfma_f32_16x16x32_bf16 v[200:203], a[96:99], a[168:171], v[200:203]
    ds_read_b64_tr_b16 a[48:49], v8 offset:14496
    v_mfma_f32_16x16x32_bf16 v[216:219], a[100:103], a[168:171], v[216:219]
    ds_read_b64_tr_b16 a[50:51], v8 offset:16288
    v_mfma_f32_16x16x32_bf16 v[232:235], a[104:107], a[168:171], v[232:235]
    buffer_load_dwordx4 v22, s[56:59], s60 offen offset:1024 lds
    v_mfma_f32_16x16x32_bf16 v[248:251], a[108:111], a[168:171], v[248:251]
    ds_read_b64_tr_b16 a[52:53], v8 offset:14528
    v_mfma_f32_16x16x32_bf16 v[44:47], a[56:59], a[172:175], v[44:47]
    ds_read_b64_tr_b16 a[54:55], v8 offset:16320
    v_mfma_f32_16x16x32_bf16 v[60:63], a[60:63], a[172:175], v[60:63]
    v_mfma_f32_16x16x32_bf16 v[76:79], a[64:67], a[172:175], v[76:79]
    buffer_load_dwordx4 a[168:171], v4, s[20:23], s41 offen offset:2048
    v_mfma_f32_16x16x32_bf16 v[92:95], a[68:71], a[172:175], v[92:95]
    v_mfma_f32_16x16x32_bf16 v[108:111], a[72:75], a[172:175], v[108:111]
    buffer_load_dwordx4 v23, s[56:59], s60 offen offset:2048 lds
    v_mfma_f32_16x16x32_bf16 v[124:127], a[76:79], a[172:175], v[124:127]
    v_mfma_f32_16x16x32_bf16 v[140:143], a[80:83], a[172:175], v[140:143]
    v_mfma_f32_16x16x32_bf16 v[156:159], a[84:87], a[172:175], v[156:159]
    v_mfma_f32_16x16x32_bf16 v[172:175], a[88:91], a[172:175], v[172:175]
    v_mfma_f32_16x16x32_bf16 v[188:191], a[92:95], a[172:175], v[188:191]
    v_mfma_f32_16x16x32_bf16 v[204:207], a[96:99], a[172:175], v[204:207]
    v_mfma_f32_16x16x32_bf16 v[220:223], a[100:103], a[172:175], v[220:223]
    v_mfma_f32_16x16x32_bf16 v[236:239], a[104:107], a[172:175], v[236:239]
    v_mfma_f32_16x16x32_bf16 v[252:255], a[108:111], a[172:175], v[252:255]
    buffer_load_dwordx4 a[172:175], v4, s[20:23], s41 offen offset:2304
    s_waitcnt vmcnt(27) lgkmcnt(0)
    v_mfma_f32_16x16x32_bf16 v[32:35], a[0:3], a[112:115], v[32:35]
    v_mfma_f32_16x16x32_bf16 v[48:51], a[4:7], a[112:115], v[48:51]
    s_add_u32 s32, s8, 0x2c00000
    s_addc_u32 s33, s9, 0
    s_mov_b32 s34, 0x400000
    s_mov_b32 s35, 0x20000
    s_lshl_b32 s47, s2, 14
    s_lshl_b32 s16, s3, 12
    s_add_u32 s47, s47, s16
    v_lshlrev_b32 v20, 4, v1
    v_mov_b32 v16, -1
    v_mov_b32 v17, -1
    v_mov_b32 v18, -1
    v_mov_b32 v19, -1
    v_mfma_f32_16x16x32_bf16 v[64:67], a[8:11], a[112:115], v[64:67]
    ds_read_b64_tr_b16 a[56:57], v8 offset:7168
    v_mfma_f32_16x16x32_bf16 v[80:83], a[12:15], a[112:115], v[80:83]
    ds_read_b64_tr_b16 a[58:59], v8 offset:8960
    v_mfma_f32_16x16x32_bf16 v[96:99], a[16:19], a[112:115], v[96:99]
    ds_read_b64_tr_b16 a[60:61], v8 offset:7200
    buffer_load_dwordx4 v24, s[56:59], s60 offen offset:3072 lds
    v_mfma_f32_16x16x32_bf16 v[112:115], a[20:23], a[112:115], v[112:115]
    ds_read_b64_tr_b16 a[62:63], v8 offset:8992
    s_mul_i32 s16, s43, 229376
    s_mul_i32 s17, s13, 7168
    s_add_u32 s16, s16, s17
    s_add_u32 s17, s16, 229376
    s_add_u32 s18, s16, 4096
    s_add_u32 s19, s17, 4096
    s_mov_b32 s48, 0xbfb8aa3b
    s_mov_b32 s50, 1.0
    v_lshlrev_b32 v9, 4, v3
    v_lshl_add_u32 v9, v5, 9, v9
    v_mul_u32_u24 v10, 229376, v6
    v_add_u32 v9, v9, v10
    v_mfma_f32_16x16x32_bf16 v[128:131], a[24:27], a[112:115], v[128:131]
    v_mfma_f32_16x16x32_bf16 v[144:147], a[28:31], a[112:115], v[144:147]
    ds_read_b64_tr_b16 a[64:65], v8 offset:7232
    v_mfma_f32_16x16x32_bf16 v[160:163], a[32:35], a[112:115], v[160:163]
    ds_read_b64_tr_b16 a[66:67], v8 offset:9024
    v_mfma_f32_16x16x32_bf16 v[176:179], a[36:39], a[112:115], v[176:179]
    ds_read_b64_tr_b16 a[68:69], v8 offset:7264
    v_mfma_f32_16x16x32_bf16 v[192:195], a[40:43], a[112:115], v[192:195]
    ds_read_b64_tr_b16 a[70:71], v8 offset:9056
    s_add_u32 m0, s61, 32768
    s_add_u32 s60, s60, 229376
    buffer_load_dwordx4 v21, s[56:59], s60 offen offset:0 lds
    v_mfma_f32_16x16x32_bf16 v[208:211], a[44:47], a[112:115], v[208:211]
    v_mfma_f32_16x16x32_bf16 v[224:227], a[48:51], a[112:115], v[224:227]
    ds_read_b64_tr_b16 a[72:73], v8 offset:7296
    buffer_store_dwordx4 v[16:19], v20, s[32:35], s47 offen offset:0 sc1
    v_mfma_f32_16x16x32_bf16 v[240:243], a[52:55], a[112:115], v[240:243]
    ds_read_b64_tr_b16 a[74:75], v8 offset:9088
    v_mfma_f32_16x16x32_bf16 v[36:39], a[0:3], a[116:119], v[36:39]
    ds_read_b64_tr_b16 a[76:77], v8 offset:7328
    v_mfma_f32_16x16x32_bf16 v[52:55], a[4:7], a[116:119], v[52:55]
    ds_read_b64_tr_b16 a[78:79], v8 offset:9120
    v_mfma_f32_16x16x32_bf16 v[68:71], a[8:11], a[116:119], v[68:71]
    buffer_load_dwordx4 v22, s[56:59], s60 offen offset:1024 lds
    v_mfma_f32_16x16x32_bf16 v[84:87], a[12:15], a[116:119], v[84:87]
    ds_read_b64_tr_b16 a[80:81], v8 offset:7360
    v_mfma_f32_16x16x32_bf16 v[100:103], a[16:19], a[116:119], v[100:103]
    ds_read_b64_tr_b16 a[82:83], v8 offset:9152
    v_mfma_f32_16x16x32_bf16 v[116:119], a[20:23], a[116:119], v[116:119]
    ds_read_b64_tr_b16 a[84:85], v8 offset:21504
    v_mfma_f32_16x16x32_bf16 v[132:135], a[24:27], a[116:119], v[132:135]
    ds_read_b64_tr_b16 a[86:87], v8 offset:23296
    v_mfma_f32_16x16x32_bf16 v[148:151], a[28:31], a[116:119], v[148:151]
    v_mfma_f32_16x16x32_bf16 v[164:167], a[32:35], a[116:119], v[164:167]
    ds_read_b64_tr_b16 a[88:89], v8 offset:21536
    buffer_store_dwordx4 v[16:19], v20, s[32:35], s47 offen offset:1024 sc1
    buffer_load_dwordx4 v23, s[56:59], s60 offen offset:2048 lds
    v_mfma_f32_16x16x32_bf16 v[180:183], a[36:39], a[116:119], v[180:183]
    ds_read_b64_tr_b16 a[90:91], v8 offset:23328
    v_mfma_f32_16x16x32_bf16 v[196:199], a[40:43], a[116:119], v[196:199]
    ds_read_b64_tr_b16 a[92:93], v8 offset:21568
    v_mfma_f32_16x16x32_bf16 v[212:215], a[44:47], a[116:119], v[212:215]
    ds_read_b64_tr_b16 a[94:95], v8 offset:23360
    v_mfma_f32_16x16x32_bf16 v[228:231], a[48:51], a[116:119], v[228:231]
    v_mfma_f32_16x16x32_bf16 v[244:247], a[52:55], a[116:119], v[244:247]
    ds_read_b64_tr_b16 a[96:97], v8 offset:21600
    v_mfma_f32_16x16x32_bf16 v[40:43], a[0:3], a[120:123], v[40:43]
    ds_read_b64_tr_b16 a[98:99], v8 offset:23392
    buffer_load_dwordx4 v24, s[56:59], s60 offen offset:3072 lds
    v_mfma_f32_16x16x32_bf16 v[56:59], a[4:7], a[120:123], v[56:59]
    ds_read_b64_tr_b16 a[100:101], v8 offset:21632
    v_mfma_f32_16x16x32_bf16 v[72:75], a[8:11], a[120:123], v[72:75]
    ds_read_b64_tr_b16 a[102:103], v8 offset:23424
    v_mfma_f32_16x16x32_bf16 v[88:91], a[12:15], a[120:123], v[88:91]
    v_mfma_f32_16x16x32_bf16 v[104:107], a[16:19], a[120:123], v[104:107]
    ds_read_b64_tr_b16 a[104:105], v8 offset:21664
    buffer_store_dwordx4 v[16:19], v20, s[32:35], s47 offen offset:2048 sc1
    v_mfma_f32_16x16x32_bf16 v[120:123], a[20:23], a[120:123], v[120:123]
    ds_read_b64_tr_b16 a[106:107], v8 offset:23456
    v_mfma_f32_16x16x32_bf16 v[136:139], a[24:27], a[120:123], v[136:139]
    ds_read_b64_tr_b16 a[108:109], v8 offset:21696
    s_add_u32 m0, s61, 36864
    s_add_u32 s60, s60, 32768
    buffer_load_dwordx4 v21, s[56:59], s60 offen offset:0 lds
    v_mfma_f32_16x16x32_bf16 v[152:155], a[28:31], a[120:123], v[152:155]
    ds_read_b64_tr_b16 a[110:111], v8 offset:23488
    v_mfma_f32_16x16x32_bf16 v[168:171], a[32:35], a[120:123], v[168:171]
    v_mfma_f32_16x16x32_bf16 v[184:187], a[36:39], a[120:123], v[184:187]
    s_waitcnt vmcnt(22)
    s_barrier
    v_mfma_f32_16x16x32_bf16 v[200:203], a[40:43], a[120:123], v[200:203]
    ds_read_b64_tr_b16 a[176:177], v8 offset:35840
    v_mfma_f32_16x16x32_bf16 v[216:219], a[44:47], a[120:123], v[216:219]
    ds_read_b64_tr_b16 a[178:179], v8 offset:37632
    v_mfma_f32_16x16x32_bf16 v[232:235], a[48:51], a[120:123], v[232:235]
    ds_read_b64_tr_b16 a[180:181], v8 offset:35872
    buffer_load_dwordx4 v22, s[56:59], s60 offen offset:1024 lds
    v_mfma_f32_16x16x32_bf16 v[248:251], a[52:55], a[120:123], v[248:251]
    ds_read_b64_tr_b16 a[182:183], v8 offset:37664
    v_mfma_f32_16x16x32_bf16 v[44:47], a[0:3], a[124:127], v[44:47]
    buffer_store_dwordx4 v[16:19], v20, s[32:35], s47 offen offset:3072 sc1
    v_mfma_f32_16x16x32_bf16 v[60:63], a[4:7], a[124:127], v[60:63]
    ds_read_b64_tr_b16 a[184:185], v8 offset:35904
    v_mfma_f32_16x16x32_bf16 v[76:79], a[8:11], a[124:127], v[76:79]
    ds_read_b64_tr_b16 a[186:187], v8 offset:37696
    v_mfma_f32_16x16x32_bf16 v[92:95], a[12:15], a[124:127], v[92:95]
    ds_read_b64_tr_b16 a[188:189], v8 offset:35936
    v_mfma_f32_16x16x32_bf16 v[108:111], a[16:19], a[124:127], v[108:111]
    ds_read_b64_tr_b16 a[190:191], v8 offset:37728
    buffer_load_dwordx4 v23, s[56:59], s60 offen offset:2048 lds
    v_mfma_f32_16x16x32_bf16 v[124:127], a[20:23], a[124:127], v[124:127]
    v_mfma_f32_16x16x32_bf16 v[140:143], a[24:27], a[124:127], v[140:143]
    ds_read_b64_tr_b16 a[192:193], v8 offset:35968
    v_mfma_f32_16x16x32_bf16 v[156:159], a[28:31], a[124:127], v[156:159]
    ds_read_b64_tr_b16 a[194:195], v8 offset:37760
    v_mfma_f32_16x16x32_bf16 v[172:175], a[32:35], a[124:127], v[172:175]
    ds_read_b64_tr_b16 a[196:197], v8 offset:36000
    v_mfma_f32_16x16x32_bf16 v[188:191], a[36:39], a[124:127], v[188:191]
    ds_read_b64_tr_b16 a[198:199], v8 offset:37792
    v_mfma_f32_16x16x32_bf16 v[204:207], a[40:43], a[124:127], v[204:207]
    v_mfma_f32_16x16x32_bf16 v[220:223], a[44:47], a[124:127], v[220:223]
    ds_read_b64_tr_b16 a[200:201], v8 offset:36032
    v_mfma_f32_16x16x32_bf16 v[236:239], a[48:51], a[124:127], v[236:239]
    ds_read_b64_tr_b16 a[202:203], v8 offset:37824
    v_mfma_f32_16x16x32_bf16 v[252:255], a[52:55], a[124:127], v[252:255]
    s_waitcnt vmcnt(12)
    s_waitcnt lgkmcnt(15)
    v_mfma_f32_16x16x32_bf16 v[32:35], a[56:59], a[128:131], v[32:35]
    ds_read_b64_tr_b16 a[0:1], v8 offset:28672
    v_mfma_f32_16x16x32_bf16 v[48:51], a[60:63], a[128:131], v[48:51]
    ds_read_b64_tr_b16 a[2:3], v8 offset:30464
    v_mfma_f32_16x16x32_bf16 v[64:67], a[64:67], a[128:131], v[64:67]
    ds_read_b64_tr_b16 a[4:5], v8 offset:28704
    v_mfma_f32_16x16x32_bf16 v[80:83], a[68:71], a[128:131], v[80:83]
    ds_read_b64_tr_b16 a[6:7], v8 offset:30496
    buffer_load_dwordx4 v24, s[56:59], s60 offen offset:3072 lds
    v_mfma_f32_16x16x32_bf16 v[96:99], a[72:75], a[128:131], v[96:99]
    ds_read_b64_tr_b16 a[8:9], v8 offset:28736
    v_mfma_f32_16x16x32_bf16 v[112:115], a[76:79], a[128:131], v[112:115]
    ds_read_b64_tr_b16 a[10:11], v8 offset:30528
    v_mfma_f32_16x16x32_bf16 v[128:131], a[80:83], a[128:131], v[128:131]
    ds_read_b64_tr_b16 a[12:13], v8 offset:28768
    v_mfma_f32_16x16x32_bf16 v[144:147], a[84:87], a[128:131], v[144:147]
    ds_read_b64_tr_b16 a[14:15], v8 offset:30560
    v_mfma_f32_16x16x32_bf16 v[160:163], a[88:91], a[128:131], v[160:163]
    ds_read_b64_tr_b16 a[16:17], v8 offset:28800
    s_add_u32 m0, s61, 65536
    s_add_u32 s60, s60, 229376
    buffer_load_dwordx4 v21, s[56:59], s60 offen offset:0 lds
    v_mfma_f32_16x16x32_bf16 v[176:179], a[92:95], a[128:131], v[176:179]
    ds_read_b64_tr_b16 a[18:19], v8 offset:30592
    v_mfma_f32_16x16x32_bf16 v[192:195], a[96:99], a[128:131], v[192:195]
    ds_read_b64_tr_b16 a[20:21], v8 offset:28832
    v_mfma_f32_16x16x32_bf16 v[208:211], a[100:103], a[128:131], v[208:211]
    ds_read_b64_tr_b16 a[22:23], v8 offset:30624
    v_mfma_f32_16x16x32_bf16 v[224:227], a[104:107], a[128:131], v[224:227]
    ds_read_b64_tr_b16 a[24:25], v8 offset:28864
    s_waitcnt lgkmcnt(15)
    v_mfma_f32_16x16x32_bf16 v[240:243], a[108:111], a[128:131], v[240:243]
    ds_read_b64_tr_b16 a[26:27], v8 offset:30656
    v_mfma_f32_16x16x32_bf16 v[36:39], a[56:59], a[132:135], v[36:39]
    ds_read_b64_tr_b16 a[28:29], v8 offset:43008
    buffer_load_dwordx4 v22, s[56:59], s60 offen offset:1024 lds
    v_mfma_f32_16x16x32_bf16 v[52:55], a[60:63], a[132:135], v[52:55]
    ds_read_b64_tr_b16 a[30:31], v8 offset:44800
    v_mfma_f32_16x16x32_bf16 v[68:71], a[64:67], a[132:135], v[68:71]
    ds_read_b64_tr_b16 a[32:33], v8 offset:43040
    v_mfma_f32_16x16x32_bf16 v[84:87], a[68:71], a[132:135], v[84:87]
    ds_read_b64_tr_b16 a[34:35], v8 offset:44832
    v_mfma_f32_16x16x32_bf16 v[100:103], a[72:75], a[132:135], v[100:103]
    ds_read_b64_tr_b16 a[36:37], v8 offset:43072
    v_mfma_f32_16x16x32_bf16 v[116:119], a[76:79], a[132:135], v[116:119]
    ds_read_b64_tr_b16 a[38:39], v8 offset:44864
    v_mfma_f32_16x16x32_bf16 v[132:135], a[80:83], a[132:135], v[132:135]
    ds_read_b64_tr_b16 a[40:41], v8 offset:43104
    buffer_load_dwordx4 v23, s[56:59], s60 offen offset:2048 lds
    v_mfma_f32_16x16x32_bf16 v[148:151], a[84:87], a[132:135], v[148:151]
    ds_read_b64_tr_b16 a[42:43], v8 offset:44896
    v_mfma_f32_16x16x32_bf16 v[164:167], a[88:91], a[132:135], v[164:167]
    ds_read_b64_tr_b16 a[44:45], v8 offset:43136
    v_mfma_f32_16x16x32_bf16 v[180:183], a[92:95], a[132:135], v[180:183]
    ds_read_b64_tr_b16 a[46:47], v8 offset:44928
    v_mfma_f32_16x16x32_bf16 v[196:199], a[96:99], a[132:135], v[196:199]
    ds_read_b64_tr_b16 a[48:49], v8 offset:43168
    v_mfma_f32_16x16x32_bf16 v[212:215], a[100:103], a[132:135], v[212:215]
    ds_read_b64_tr_b16 a[50:51], v8 offset:44960
    v_mfma_f32_16x16x32_bf16 v[228:231], a[104:107], a[132:135], v[228:231]
    ds_read_b64_tr_b16 a[52:53], v8 offset:43200
    buffer_load_dwordx4 v24, s[56:59], s60 offen offset:3072 lds
    v_mfma_f32_16x16x32_bf16 v[244:247], a[108:111], a[132:135], v[244:247]
    ds_read_b64_tr_b16 a[54:55], v8 offset:44992
    s_waitcnt lgkmcnt(15)
    v_mfma_f32_16x16x32_bf16 v[32:35], a[0:3], a[144:147], v[32:35]
    ds_read_b64_tr_b16 a[204:205], v8 offset:50176
    v_mfma_f32_16x16x32_bf16 v[48:51], a[4:7], a[144:147], v[48:51]
    ds_read_b64_tr_b16 a[206:207], v8 offset:51968
    v_mfma_f32_16x16x32_bf16 v[64:67], a[8:11], a[144:147], v[64:67]
    ds_read_b64_tr_b16 a[208:209], v8 offset:50208
    v_mfma_f32_16x16x32_bf16 v[80:83], a[12:15], a[144:147], v[80:83]
    ds_read_b64_tr_b16 a[210:211], v8 offset:52000
    s_add_u32 m0, s61, 69632
    s_add_u32 s60, s60, 32768
    buffer_load_dwordx4 v21, s[56:59], s60 offen offset:0 lds
    v_mfma_f32_16x16x32_bf16 v[96:99], a[16:19], a[144:147], v[96:99]
    ds_read_b64_tr_b16 a[212:213], v8 offset:50240
    v_mfma_f32_16x16x32_bf16 v[112:115], a[20:23], a[144:147], v[112:115]
    ds_read_b64_tr_b16 a[214:215], v8 offset:52032
    s_waitcnt lgkmcnt(15)
    v_mfma_f32_16x16x32_bf16 v[128:131], a[24:27], a[144:147], v[128:131]
    ds_read_b64_tr_b16 a[216:217], v8 offset:50272
    v_mfma_f32_16x16x32_bf16 v[144:147], a[28:31], a[144:147], v[144:147]
    ds_read_b64_tr_b16 a[218:219], v8 offset:52064
    v_mfma_f32_16x16x32_bf16 v[160:163], a[32:35], a[144:147], v[160:163]
    ds_read_b64_tr_b16 a[220:221], v8 offset:50304
    s_waitcnt lgkmcnt(15)
    v_mfma_f32_16x16x32_bf16 v[176:179], a[36:39], a[144:147], v[176:179]
    ds_read_b64_tr_b16 a[222:223], v8 offset:52096
    buffer_load_dwordx4 v22, s[56:59], s60 offen offset:1024 lds
    v_mfma_f32_16x16x32_bf16 v[192:195], a[40:43], a[144:147], v[192:195]
    ds_read_b64_tr_b16 a[224:225], v8 offset:50336
    s_waitcnt lgkmcnt(15)
    v_mfma_f32_16x16x32_bf16 v[208:211], a[44:47], a[144:147], v[208:211]
    ds_read_b64_tr_b16 a[226:227], v8 offset:52128
    s_waitcnt lgkmcnt(14)
    v_mfma_f32_16x16x32_bf16 v[224:227], a[48:51], a[144:147], v[224:227]
    ds_read_b64_tr_b16 a[228:229], v8 offset:50368
    s_waitcnt lgkmcnt(13)
    v_mfma_f32_16x16x32_bf16 v[240:243], a[52:55], a[144:147], v[240:243]
    ds_read_b64_tr_b16 a[230:231], v8 offset:52160
    v_mfma_f32_16x16x32_bf16 v[32:35], a[176:179], a[160:163], v[32:35]
    v_mfma_f32_16x16x32_bf16 v[48:51], a[180:183], a[160:163], v[48:51]
    buffer_load_dwordx4 v23, s[56:59], s60 offen offset:2048 lds
    v_mfma_f32_16x16x32_bf16 v[64:67], a[184:187], a[160:163], v[64:67]
    v_mfma_f32_16x16x32_bf16 v[80:83], a[188:191], a[160:163], v[80:83]
    v_mfma_f32_16x16x32_bf16 v[96:99], a[192:195], a[160:163], v[96:99]
    v_mfma_f32_16x16x32_bf16 v[112:115], a[196:199], a[160:163], v[112:115]
    v_mfma_f32_16x16x32_bf16 v[128:131], a[200:203], a[160:163], v[128:131]
    s_waitcnt lgkmcnt(12)
    v_mfma_f32_16x16x32_bf16 v[144:147], a[204:207], a[160:163], v[144:147]
    buffer_load_dwordx4 v24, s[56:59], s60 offen offset:3072 lds
    s_waitcnt lgkmcnt(10)
    v_mfma_f32_16x16x32_bf16 v[160:163], a[208:211], a[160:163], v[160:163]
    s_waitcnt lgkmcnt(8)
    v_mfma_f32_16x16x32_bf16 v[176:179], a[212:215], a[160:163], v[176:179]
    s_waitcnt lgkmcnt(6)
    v_mfma_f32_16x16x32_bf16 v[192:195], a[216:219], a[160:163], v[192:195]
    s_waitcnt lgkmcnt(4)
    v_mfma_f32_16x16x32_bf16 v[208:211], a[220:223], a[160:163], v[208:211]
    s_waitcnt lgkmcnt(2)
    v_mfma_f32_16x16x32_bf16 v[224:227], a[224:227], a[160:163], v[224:227]
    s_waitcnt lgkmcnt(0)
    v_mfma_f32_16x16x32_bf16 v[240:243], a[228:231], a[160:163], v[240:243]
    v_mfma_f32_16x16x32_bf16 v[36:39], a[0:3], a[148:151], v[36:39]
    s_waitcnt lgkmcnt(0)
    s_barrier
    v_mfma_f32_16x16x32_bf16 v[52:55], a[4:7], a[148:151], v[52:55]
    v_pk_mul_f32 v[32:33], v[32:33], s[48:49] op_sel_hi:[1,0]
    v_pk_mul_f32 v[34:35], v[34:35], s[48:49] op_sel_hi:[1,0]
    v_pk_mul_f32 v[48:49], v[48:49], s[48:49] op_sel_hi:[1,0]
    v_pk_mul_f32 v[50:51], v[50:51], s[48:49] op_sel_hi:[1,0]
    v_mfma_f32_16x16x32_bf16 v[68:71], a[8:11], a[148:151], v[68:71]
    v_exp_f32 v32, v32
    v_exp_f32 v33, v33
    v_mfma_f32_16x16x32_bf16 v[84:87], a[12:15], a[148:151], v[84:87]
    v_exp_f32 v34, v34
    v_exp_f32 v35, v35
    v_mfma_f32_16x16x32_bf16 v[100:103], a[16:19], a[148:151], v[100:103]
    v_exp_f32 v48, v48
    v_exp_f32 v49, v49
    v_mfma_f32_16x16x32_bf16 v[116:119], a[20:23], a[148:151], v[116:119]
    v_exp_f32 v50, v50
    v_exp_f32 v51, v51
    v_mfma_f32_16x16x32_bf16 v[132:135], a[24:27], a[148:151], v[132:135]
    v_pk_add_f32 v[32:33], v[32:33], s[50:51] op_sel_hi:[1,0]
    v_pk_add_f32 v[34:35], v[34:35], s[50:51] op_sel_hi:[1,0]
    v_pk_add_f32 v[48:49], v[48:49], s[50:51] op_sel_hi:[1,0]
    v_pk_add_f32 v[50:51], v[50:51], s[50:51] op_sel_hi:[1,0]
    v_mfma_f32_16x16x32_bf16 v[148:151], a[28:31], a[148:151], v[148:151]
    s_add_u32 m0, s61, 98304
    s_add_u32 s60, s60, 229376
    buffer_load_dwordx4 v21, s[56:59], s60 offen offset:0 lds
    v_rcp_f32 v32, v32
    v_rcp_f32 v33, v33
    v_mfma_f32_16x16x32_bf16 v[164:167], a[32:35], a[148:151], v[164:167]
    v_rcp_f32 v34, v34
    v_rcp_f32 v35, v35
    v_mfma_f32_16x16x32_bf16 v[180:183], a[36:39], a[148:151], v[180:183]
    v_rcp_f32 v48, v48
    v_rcp_f32 v49, v49
    v_mfma_f32_16x16x32_bf16 v[196:199], a[40:43], a[148:151], v[196:199]
    v_rcp_f32 v50, v50
    v_rcp_f32 v51, v51
    v_mfma_f32_16x16x32_bf16 v[212:215], a[44:47], a[148:151], v[212:215]
    v_pk_mul_f32 v[32:33], v[32:33], v[144:145]
    v_pk_mul_f32 v[34:35], v[34:35], v[146:147]
    v_pk_mul_f32 v[48:49], v[48:49], v[160:161]
    v_pk_mul_f32 v[50:51], v[50:51], v[162:163]
    v_mfma_f32_16x16x32_bf16 v[228:231], a[48:51], a[148:151], v[228:231]
    v_cvt_pk_bf16_f32 v144, v32, v33
    v_cvt_pk_bf16_f32 v145, v34, v35
    v_cvt_pk_bf16_f32 v146, v48, v49
    v_cvt_pk_bf16_f32 v147, v50, v51
    v_mfma_f32_16x16x32_bf16 v[244:247], a[52:55], a[148:151], v[244:247]
    s_nop 1
    v_permlane32_swap_b32 v144, v146
    v_permlane32_swap_b32 v145, v147
    buffer_store_dwordx4 v[144:147], v4, s[28:31], s16 offen offset:0 sc1
    v_mfma_f32_16x16x32_bf16 v[36:39], a[176:179], a[164:167], v[36:39]
    v_pk_mul_f32 v[64:65], v[64:65], s[48:49] op_sel_hi:[1,0]
    v_pk_mul_f32 v[66:67], v[66:67], s[48:49] op_sel_hi:[1,0]
    v_pk_mul_f32 v[80:81], v[80:81], s[48:49] op_sel_hi:[1,0]
    v_pk_mul_f32 v[82:83], v[82:83], s[48:49] op_sel_hi:[1,0]
    v_mfma_f32_16x16x32_bf16 v[52:55], a[180:183], a[164:167], v[52:55]
    v_exp_f32 v64, v64
    v_exp_f32 v65, v65
    v_mfma_f32_16x16x32_bf16 v[68:71], a[184:187], a[164:167], v[68:71]
    v_exp_f32 v66, v66
    v_exp_f32 v67, v67
    v_mfma_f32_16x16x32_bf16 v[84:87], a[188:191], a[164:167], v[84:87]
    v_exp_f32 v80, v80
    v_exp_f32 v81, v81
    v_mfma_f32_16x16x32_bf16 v[100:103], a[192:195], a[164:167], v[100:103]
    v_exp_f32 v82, v82
    v_exp_f32 v83, v83
    v_mfma_f32_16x16x32_bf16 v[116:119], a[196:199], a[164:167], v[116:119]
    v_pk_add_f32 v[64:65], v[64:65], s[50:51] op_sel_hi:[1,0]
    v_pk_add_f32 v[66:67], v[66:67], s[50:51] op_sel_hi:[1,0]
    v_pk_add_f32 v[80:81], v[80:81], s[50:51] op_sel_hi:[1,0]
    v_pk_add_f32 v[82:83], v[82:83], s[50:51] op_sel_hi:[1,0]
    v_mfma_f32_16x16x32_bf16 v[132:135], a[200:203], a[164:167], v[132:135]
    v_rcp_f32 v64, v64
    v_rcp_f32 v65, v65
    v_mfma_f32_16x16x32_bf16 v[148:151], a[204:207], a[164:167], v[148:151]
    buffer_load_dwordx4 v22, s[56:59], s60 offen offset:1024 lds
    v_rcp_f32 v66, v66
    v_rcp_f32 v67, v67
    v_mfma_f32_16x16x32_bf16 v[164:167], a[208:211], a[164:167], v[164:167]
    v_rcp_f32 v80, v80
    v_rcp_f32 v81, v81
    v_mfma_f32_16x16x32_bf16 v[180:183], a[212:215], a[164:167], v[180:183]
    v_rcp_f32 v82, v82
    v_rcp_f32 v83, v83
    v_mfma_f32_16x16x32_bf16 v[196:199], a[216:219], a[164:167], v[196:199]
    v_pk_mul_f32 v[64:65], v[64:65], v[176:177]
    v_pk_mul_f32 v[66:67], v[66:67], v[178:179]
    v_pk_mul_f32 v[80:81], v[80:81], v[192:193]
    v_pk_mul_f32 v[82:83], v[82:83], v[194:195]
    v_mfma_f32_16x16x32_bf16 v[212:215], a[220:223], a[164:167], v[212:215]
    v_cvt_pk_bf16_f32 v176, v64, v65
    v_cvt_pk_bf16_f32 v177, v66, v67
    v_cvt_pk_bf16_f32 v178, v80, v81
    v_cvt_pk_bf16_f32 v179, v82, v83
    v_mfma_f32_16x16x32_bf16 v[228:231], a[224:227], a[164:167], v[228:231]
    s_nop 1
    v_permlane32_swap_b32 v176, v178
    v_permlane32_swap_b32 v177, v179
    buffer_store_dwordx4 v[176:179], v4, s[28:31], s16 offen offset:2048 sc1
    v_mfma_f32_16x16x32_bf16 v[244:247], a[228:231], a[164:167], v[244:247]
    v_pk_mul_f32 v[96:97], v[96:97], s[48:49] op_sel_hi:[1,0]
    v_pk_mul_f32 v[98:99], v[98:99], s[48:49] op_sel_hi:[1,0]
    v_pk_mul_f32 v[112:113], v[112:113], s[48:49] op_sel_hi:[1,0]
    v_pk_mul_f32 v[114:115], v[114:115], s[48:49] op_sel_hi:[1,0]
    v_mfma_f32_16x16x32_bf16 v[40:43], a[56:59], a[136:139], v[40:43]
    v_exp_f32 v96, v96
    v_exp_f32 v97, v97
    v_mfma_f32_16x16x32_bf16 v[56:59], a[60:63], a[136:139], v[56:59]
    v_exp_f32 v98, v98
    v_exp_f32 v99, v99
    v_mfma_f32_16x16x32_bf16 v[72:75], a[64:67], a[136:139], v[72:75]
    v_exp_f32 v112, v112
    v_exp_f32 v113, v113
    v_mfma_f32_16x16x32_bf16 v[88:91], a[68:71], a[136:139], v[88:91]
    v_exp_f32 v114, v114
    v_exp_f32 v115, v115
    v_mfma_f32_16x16x32_bf16 v[104:107], a[72:75], a[136:139], v[104:107]
    v_pk_add_f32 v[96:97], v[96:97], s[50:51] op_sel_hi:[1,0]
    v_pk_add_f32 v[98:99], v[98:99], s[50:51] op_sel_hi:[1,0]
    v_pk_add_f32 v[112:113], v[112:113], s[50:51] op_sel_hi:[1,0]
    v_pk_add_f32 v[114:115], v[114:115], s[50:51] op_sel_hi:[1,0]
    v_mfma_f32_16x16x32_bf16 v[120:123], a[76:79], a[136:139], v[120:123]
    v_rcp_f32 v96, v96
    v_rcp_f32 v97, v97
    v_mfma_f32_16x16x32_bf16 v[136:139], a[80:83], a[136:139], v[136:139]
    v_rcp_f32 v98, v98
    v_rcp_f32 v99, v99
    v_mfma_f32_16x16x32_bf16 v[152:155], a[84:87], a[136:139], v[152:155]
    buffer_load_dwordx4 v23, s[56:59], s60 offen offset:2048 lds
    v_rcp_f32 v112, v112
    v_rcp_f32 v113, v113
    v_mfma_f32_16x16x32_bf16 v[168:171], a[88:91], a[136:139], v[168:171]
    v_rcp_f32 v114, v114
    v_rcp_f32 v115, v115
    v_mfma_f32_16x16x32_bf16 v[184:187], a[92:95], a[136:139], v[184:187]
    v_pk_mul_f32 v[96:97], v[96:97], v[208:209]
    v_pk_mul_f32 v[98:99], v[98:99], v[210:211]
    v_pk_mul_f32 v[112:113], v[112:113], v[224:225]
    v_pk_mul_f32 v[114:115], v[114:115], v[226:227]
    v_mfma_f32_16x16x32_bf16 v[200:203], a[96:99], a[136:139], v[200:203]
    v_cvt_pk_bf16_f32 v208, v96, v97
    v_cvt_pk_bf16_f32 v209, v98, v99
    v_cvt_pk_bf16_f32 v210, v112, v113
    v_cvt_pk_bf16_f32 v211, v114, v115
    v_mfma_f32_16x16x32_bf16 v[216:219], a[100:103], a[136:139], v[216:219]
    s_nop 1
    v_permlane32_swap_b32 v208, v210
    v_permlane32_swap_b32 v209, v211
    buffer_store_dwordx4 v[208:211], v4, s[28:31], s18 offen offset:0 sc1
    v_mfma_f32_16x16x32_bf16 v[232:235], a[104:107], a[136:139], v[232:235]
    v_pk_mul_f32 v[128:129], v[128:129], s[48:49] op_sel_hi:[1,0]
    v_pk_mul_f32 v[130:131], v[130:131], s[48:49] op_sel_hi:[1,0]
    v_exp_f32 v128, v128
    v_mfma_f32_16x16x32_bf16 v[248:251], a[108:111], a[136:139], v[248:251]
    v_exp_f32 v129, v129
    v_exp_f32 v130, v130
    v_mfma_f32_16x16x32_bf16 v[40:43], a[0:3], a[152:155], v[40:43]
    v_exp_f32 v131, v131
    v_pk_add_f32 v[128:129], v[128:129], s[50:51] op_sel_hi:[1,0]
    v_pk_add_f32 v[130:131], v[130:131], s[50:51] op_sel_hi:[1,0]
    v_mfma_f32_16x16x32_bf16 v[56:59], a[4:7], a[152:155], v[56:59]
    v_rcp_f32 v128, v128
    v_rcp_f32 v129, v129
    v_mfma_f32_16x16x32_bf16 v[72:75], a[8:11], a[152:155], v[72:75]
    v_rcp_f32 v130, v130
    v_rcp_f32 v131, v131
    v_mfma_f32_16x16x32_bf16 v[88:91], a[12:15], a[152:155], v[88:91]
    v_pk_mul_f32 v[128:129], v[128:129], v[240:241]
    v_pk_mul_f32 v[130:131], v[130:131], v[242:243]
    v_cvt_pk_bf16_f32 v240, v128, v129
    v_cvt_pk_bf16_f32 v241, v130, v131
    v_mfma_f32_16x16x32_bf16 v[104:107], a[16:19], a[152:155], v[104:107]
    v_pk_mul_f32 v[36:37], v[36:37], s[48:49] op_sel_hi:[1,0]
    v_pk_mul_f32 v[38:39], v[38:39], s[48:49] op_sel_hi:[1,0]
    v_pk_mul_f32 v[52:53], v[52:53], s[48:49] op_sel_hi:[1,0]
    v_pk_mul_f32 v[54:55], v[54:55], s[48:49] op_sel_hi:[1,0]
    v_mfma_f32_16x16x32_bf16 v[120:123], a[20:23], a[152:155], v[120:123]
    v_exp_f32 v36, v36
    v_exp_f32 v37, v37
    v_mfma_f32_16x16x32_bf16 v[136:139], a[24:27], a[152:155], v[136:139]
    v_exp_f32 v38, v38
    v_exp_f32 v39, v39
    v_mfma_f32_16x16x32_bf16 v[152:155], a[28:31], a[152:155], v[152:155]
    buffer_load_dwordx4 v24, s[56:59], s60 offen offset:3072 lds
    v_exp_f32 v52, v52
    v_exp_f32 v53, v53
    v_mfma_f32_16x16x32_bf16 v[168:171], a[32:35], a[152:155], v[168:171]
    v_exp_f32 v54, v54
    v_exp_f32 v55, v55
    v_mfma_f32_16x16x32_bf16 v[184:187], a[36:39], a[152:155], v[184:187]
    v_pk_add_f32 v[36:37], v[36:37], s[50:51] op_sel_hi:[1,0]
    v_pk_add_f32 v[38:39], v[38:39], s[50:51] op_sel_hi:[1,0]
    v_pk_add_f32 v[52:53], v[52:53], s[50:51] op_sel_hi:[1,0]
    v_pk_add_f32 v[54:55], v[54:55], s[50:51] op_sel_hi:[1,0]
    v_mfma_f32_16x16x32_bf16 v[200:203], a[40:43], a[152:155], v[200:203]
    v_rcp_f32 v36, v36
    v_rcp_f32 v37, v37
    v_mfma_f32_16x16x32_bf16 v[216:219], a[44:47], a[152:155], v[216:219]
    v_rcp_f32 v38, v38
    v_rcp_f32 v39, v39
    v_mfma_f32_16x16x32_bf16 v[232:235], a[48:51], a[152:155], v[232:235]
    v_rcp_f32 v52, v52
    v_rcp_f32 v53, v53
    v_mfma_f32_16x16x32_bf16 v[248:251], a[52:55], a[152:155], v[248:251]
    v_rcp_f32 v54, v54
    v_rcp_f32 v55, v55
    v_mfma_f32_16x16x32_bf16 v[40:43], a[176:179], a[168:171], v[40:43]
    v_pk_mul_f32 v[36:37], v[36:37], v[148:149]
    v_pk_mul_f32 v[38:39], v[38:39], v[150:151]
    v_pk_mul_f32 v[52:53], v[52:53], v[164:165]
    v_pk_mul_f32 v[54:55], v[54:55], v[166:167]
    v_mfma_f32_16x16x32_bf16 v[56:59], a[180:183], a[168:171], v[56:59]
    v_cvt_pk_bf16_f32 v148, v36, v37
    v_cvt_pk_bf16_f32 v149, v38, v39
    v_cvt_pk_bf16_f32 v150, v52, v53
    v_cvt_pk_bf16_f32 v151, v54, v55
    v_mfma_f32_16x16x32_bf16 v[72:75], a[184:187], a[168:171], v[72:75]
    s_nop 1
    v_permlane32_swap_b32 v148, v150
    v_permlane32_swap_b32 v149, v151
    buffer_store_dwordx4 v[148:151], v4, s[28:31], s16 offen offset:256 sc1
    v_mfma_f32_16x16x32_bf16 v[88:91], a[188:191], a[168:171], v[88:91]
    v_pk_mul_f32 v[68:69], v[68:69], s[48:49] op_sel_hi:[1,0]
    v_pk_mul_f32 v[70:71], v[70:71], s[48:49] op_sel_hi:[1,0]
    v_pk_mul_f32 v[84:85], v[84:85], s[48:49] op_sel_hi:[1,0]
    v_pk_mul_f32 v[86:87], v[86:87], s[48:49] op_sel_hi:[1,0]
    v_mfma_f32_16x16x32_bf16 v[104:107], a[192:195], a[168:171], v[104:107]
    v_exp_f32 v68, v68
    v_exp_f32 v69, v69
    v_mfma_f32_16x16x32_bf16 v[120:123], a[196:199], a[168:171], v[120:123]
    v_exp_f32 v70, v70
    v_exp_f32 v71, v71
    v_mfma_f32_16x16x32_bf16 v[136:139], a[200:203], a[168:171], v[136:139]
    v_exp_f32 v84, v84
    v_exp_f32 v85, v85
    v_mfma_f32_16x16x32_bf16 v[152:155], a[204:207], a[168:171], v[152:155]
    s_add_u32 m0, s61, 102400
    s_add_u32 s60, s60, 32768
    buffer_load_dwordx4 v21, s[56:59], s60 offen offset:0 lds
    v_exp_f32 v86, v86
    v_exp_f32 v87, v87
    v_mfma_f32_16x16x32_bf16 v[168:171], a[208:211], a[168:171], v[168:171]
    v_pk_add_f32 v[68:69], v[68:69], s[50:51] op_sel_hi:[1,0]
    v_pk_add_f32 v[70:71], v[70:71], s[50:51] op_sel_hi:[1,0]
    v_pk_add_f32 v[84:85], v[84:85], s[50:51] op_sel_hi:[1,0]
    v_pk_add_f32 v[86:87], v[86:87], s[50:51] op_sel_hi:[1,0]
    v_mfma_f32_16x16x32_bf16 v[184:187], a[212:215], a[168:171], v[184:187]
    v_rcp_f32 v68, v68
    v_rcp_f32 v69, v69
    v_mfma_f32_16x16x32_bf16 v[200:203], a[216:219], a[168:171], v[200:203]
    v_rcp_f32 v70, v70
    v_rcp_f32 v71, v71
    v_mfma_f32_16x16x32_bf16 v[216:219], a[220:223], a[168:171], v[216:219]
    v_rcp_f32 v84, v84
    v_rcp_f32 v85, v85
    v_mfma_f32_16x16x32_bf16 v[232:235], a[224:227], a[168:171], v[232:235]
    v_rcp_f32 v86, v86
    v_rcp_f32 v87, v87
    v_mfma_f32_16x16x32_bf16 v[248:251], a[228:231], a[168:171], v[248:251]
    v_pk_mul_f32 v[68:69], v[68:69], v[180:181]
    v_pk_mul_f32 v[70:71], v[70:71], v[182:183]
    v_pk_mul_f32 v[84:85], v[84:85], v[196:197]
    v_pk_mul_f32 v[86:87], v[86:87], v[198:199]
    v_mfma_f32_16x16x32_bf16 v[44:47], a[56:59], a[140:143], v[44:47]
    v_cvt_pk_bf16_f32 v180, v68, v69
    v_cvt_pk_bf16_f32 v181, v70, v71
    v_cvt_pk_bf16_f32 v182, v84, v85
    v_cvt_pk_bf16_f32 v183, v86, v87
    v_mfma_f32_16x16x32_bf16 v[60:63], a[60:63], a[140:143], v[60:63]
    s_nop 1
    v_permlane32_swap_b32 v180, v182
    v_permlane32_swap_b32 v181, v183
    buffer_store_dwordx4 v[180:183], v4, s[28:31], s16 offen offset:2304 sc1
    v_mfma_f32_16x16x32_bf16 v[76:79], a[64:67], a[140:143], v[76:79]
    v_pk_mul_f32 v[100:101], v[100:101], s[48:49] op_sel_hi:[1,0]
    v_pk_mul_f32 v[102:103], v[102:103], s[48:49] op_sel_hi:[1,0]
    v_pk_mul_f32 v[116:117], v[116:117], s[48:49] op_sel_hi:[1,0]
    v_pk_mul_f32 v[118:119], v[118:119], s[48:49] op_sel_hi:[1,0]
    v_mfma_f32_16x16x32_bf16 v[92:95], a[68:71], a[140:143], v[92:95]
    v_exp_f32 v100, v100
    v_exp_f32 v101, v101
    v_mfma_f32_16x16x32_bf16 v[108:111], a[72:75], a[140:143], v[108:111]
    v_exp_f32 v102, v102
    v_exp_f32 v103, v103
    v_mfma_f32_16x16x32_bf16 v[124:127], a[76:79], a[140:143], v[124:127]
    v_exp_f32 v116, v116
    v_exp_f32 v117, v117
    v_mfma_f32_16x16x32_bf16 v[140:143], a[80:83], a[140:143], v[140:143]
    v_exp_f32 v118, v118
    v_exp_f32 v119, v119
    v_mfma_f32_16x16x32_bf16 v[156:159], a[84:87], a[140:143], v[156:159]
    buffer_load_dwordx4 v22, s[56:59], s60 offen offset:1024 lds
    v_pk_add_f32 v[100:101], v[100:101], s[50:51] op_sel_hi:[1,0]
    v_pk_add_f32 v[102:103], v[102:103], s[50:51] op_sel_hi:[1,0]
    v_pk_add_f32 v[116:117], v[116:117], s[50:51] op_sel_hi:[1,0]
    v_pk_add_f32 v[118:119], v[118:119], s[50:51] op_sel_hi:[1,0]
    v_mfma_f32_16x16x32_bf16 v[172:175], a[88:91], a[140:143], v[172:175]
    v_rcp_f32 v100, v100
    v_rcp_f32 v101, v101
    v_mfma_f32_16x16x32_bf16 v[188:191], a[92:95], a[140:143], v[188:191]
    v_rcp_f32 v102, v102
    v_rcp_f32 v103, v103
    v_mfma_f32_16x16x32_bf16 v[204:207], a[96:99], a[140:143], v[204:207]
    v_rcp_f32 v116, v116
    v_rcp_f32 v117, v117
    v_mfma_f32_16x16x32_bf16 v[220:223], a[100:103], a[140:143], v[220:223]
    v_rcp_f32 v118, v118
    v_rcp_f32 v119, v119
    v_mfma_f32_16x16x32_bf16 v[236:239], a[104:107], a[140:143], v[236:239]
    v_pk_mul_f32 v[100:101], v[100:101], v[212:213]
    v_pk_mul_f32 v[102:103], v[102:103], v[214:215]
    v_pk_mul_f32 v[116:117], v[116:117], v[228:229]
    v_pk_mul_f32 v[118:119], v[118:119], v[230:231]
    v_mfma_f32_16x16x32_bf16 v[252:255], a[108:111], a[140:143], v[252:255]
    v_cvt_pk_bf16_f32 v212, v100, v101
    v_cvt_pk_bf16_f32 v213, v102, v103
    v_cvt_pk_bf16_f32 v214, v116, v117
    v_cvt_pk_bf16_f32 v215, v118, v119
    v_mfma_f32_16x16x32_bf16 v[44:47], a[0:3], a[156:159], v[44:47]
    s_nop 1
    v_permlane32_swap_b32 v212, v214
    v_permlane32_swap_b32 v213, v215
    buffer_store_dwordx4 v[212:215], v4, s[28:31], s18 offen offset:256 sc1
    v_mfma_f32_16x16x32_bf16 v[60:63], a[4:7], a[156:159], v[60:63]
    v_pk_mul_f32 v[132:133], v[132:133], s[48:49] op_sel_hi:[1,0]
    v_pk_mul_f32 v[134:135], v[134:135], s[48:49] op_sel_hi:[1,0]
    v_exp_f32 v132, v132
    v_mfma_f32_16x16x32_bf16 v[76:79], a[8:11], a[156:159], v[76:79]
    v_exp_f32 v133, v133
    v_exp_f32 v134, v134
    v_mfma_f32_16x16x32_bf16 v[92:95], a[12:15], a[156:159], v[92:95]
    v_exp_f32 v135, v135
    v_pk_add_f32 v[132:133], v[132:133], s[50:51] op_sel_hi:[1,0]
    v_pk_add_f32 v[134:135], v[134:135], s[50:51] op_sel_hi:[1,0]
    v_mfma_f32_16x16x32_bf16 v[108:111], a[16:19], a[156:159], v[108:111]
    v_rcp_f32 v132, v132
    v_rcp_f32 v133, v133
    v_mfma_f32_16x16x32_bf16 v[124:127], a[20:23], a[156:159], v[124:127]
    v_rcp_f32 v134, v134
    v_rcp_f32 v135, v135
    v_mfma_f32_16x16x32_bf16 v[140:143], a[24:27], a[156:159], v[140:143]
    v_pk_mul_f32 v[132:133], v[132:133], v[244:245]
    v_pk_mul_f32 v[134:135], v[134:135], v[246:247]
    v_cvt_pk_bf16_f32 v244, v132, v133
    v_cvt_pk_bf16_f32 v245, v134, v135
    v_mfma_f32_16x16x32_bf16 v[156:159], a[28:31], a[156:159], v[156:159]
    buffer_load_dwordx4 v23, s[56:59], s60 offen offset:2048 lds
    v_pk_mul_f32 v[40:41], v[40:41], s[48:49] op_sel_hi:[1,0]
    v_pk_mul_f32 v[42:43], v[42:43], s[48:49] op_sel_hi:[1,0]
    v_pk_mul_f32 v[56:57], v[56:57], s[48:49] op_sel_hi:[1,0]
    v_pk_mul_f32 v[58:59], v[58:59], s[48:49] op_sel_hi:[1,0]
    v_mfma_f32_16x16x32_bf16 v[172:175], a[32:35], a[156:159], v[172:175]
    v_exp_f32 v40, v40
    v_exp_f32 v41, v41
    v_mfma_f32_16x16x32_bf16 v[188:191], a[36:39], a[156:159], v[188:191]
    v_exp_f32 v42, v42
    v_exp_f32 v43, v43
    v_mfma_f32_16x16x32_bf16 v[204:207], a[40:43], a[156:159], v[204:207]
    v_exp_f32 v56, v56
    v_exp_f32 v57, v57
    v_mfma_f32_16x16x32_bf16 v[220:223], a[44:47], a[156:159], v[220:223]
    v_exp_f32 v58, v58
    v_exp_f32 v59, v59
    v_mfma_f32_16x16x32_bf16 v[236:239], a[48:51], a[156:159], v[236:239]
    v_pk_add_f32 v[40:41], v[40:41], s[50:51] op_sel_hi:[1,0]
    v_pk_add_f32 v[42:43], v[42:43], s[50:51] op_sel_hi:[1,0]
    v_pk_add_f32 v[56:57], v[56:57], s[50:51] op_sel_hi:[1,0]
    v_pk_add_f32 v[58:59], v[58:59], s[50:51] op_sel_hi:[1,0]
    v_mfma_f32_16x16x32_bf16 v[252:255], a[52:55], a[156:159], v[252:255]
    v_rcp_f32 v40, v40
    v_rcp_f32 v41, v41
    v_mfma_f32_16x16x32_bf16 v[44:47], a[176:179], a[172:175], v[44:47]
    v_rcp_f32 v42, v42
    v_rcp_f32 v43, v43
    v_mfma_f32_16x16x32_bf16 v[60:63], a[180:183], a[172:175], v[60:63]
    v_rcp_f32 v56, v56
    v_rcp_f32 v57, v57
    v_mfma_f32_16x16x32_bf16 v[76:79], a[184:187], a[172:175], v[76:79]
    v_rcp_f32 v58, v58
    v_rcp_f32 v59, v59
    v_mfma_f32_16x16x32_bf16 v[92:95], a[188:191], a[172:175], v[92:95]
    v_pk_mul_f32 v[40:41], v[40:41], v[152:153]
    v_pk_mul_f32 v[42:43], v[42:43], v[154:155]
    v_pk_mul_f32 v[56:57], v[56:57], v[168:169]
    v_pk_mul_f32 v[58:59], v[58:59], v[170:171]
    v_mfma_f32_16x16x32_bf16 v[108:111], a[192:195], a[172:175], v[108:111]
    v_cvt_pk_bf16_f32 v152, v40, v41
    v_cvt_pk_bf16_f32 v153, v42, v43
    v_cvt_pk_bf16_f32 v154, v56, v57
    v_cvt_pk_bf16_f32 v155, v58, v59
    v_mfma_f32_16x16x32_bf16 v[124:127], a[196:199], a[172:175], v[124:127]
    s_nop 1
    v_permlane32_swap_b32 v152, v154
    v_permlane32_swap_b32 v153, v155
    buffer_store_dwordx4 v[152:155], v4, s[28:31], s17 offen offset:0 sc1
    v_mfma_f32_16x16x32_bf16 v[140:143], a[200:203], a[172:175], v[140:143]
    v_pk_mul_f32 v[72:73], v[72:73], s[48:49] op_sel_hi:[1,0]
    v_pk_mul_f32 v[74:75], v[74:75], s[48:49] op_sel_hi:[1,0]
    v_pk_mul_f32 v[88:89], v[88:89], s[48:49] op_sel_hi:[1,0]
    v_pk_mul_f32 v[90:91], v[90:91], s[48:49] op_sel_hi:[1,0]
    v_mfma_f32_16x16x32_bf16 v[156:159], a[204:207], a[172:175], v[156:159]
    buffer_load_dwordx4 v24, s[56:59], s60 offen offset:3072 lds
    v_exp_f32 v72, v72
    v_exp_f32 v73, v73
    v_mfma_f32_16x16x32_bf16 v[172:175], a[208:211], a[172:175], v[172:175]
    v_exp_f32 v74, v74
    v_exp_f32 v75, v75
    v_mfma_f32_16x16x32_bf16 v[188:191], a[212:215], a[172:175], v[188:191]
    v_exp_f32 v88, v88
    v_exp_f32 v89, v89
    v_mfma_f32_16x16x32_bf16 v[204:207], a[216:219], a[172:175], v[204:207]
    v_exp_f32 v90, v90
    v_exp_f32 v91, v91
    v_mfma_f32_16x16x32_bf16 v[220:223], a[220:223], a[172:175], v[220:223]
    v_pk_add_f32 v[72:73], v[72:73], s[50:51] op_sel_hi:[1,0]
    v_pk_add_f32 v[74:75], v[74:75], s[50:51] op_sel_hi:[1,0]
    v_pk_add_f32 v[88:89], v[88:89], s[50:51] op_sel_hi:[1,0]
    v_pk_add_f32 v[90:91], v[90:91], s[50:51] op_sel_hi:[1,0]
    v_mfma_f32_16x16x32_bf16 v[236:239], a[224:227], a[172:175], v[236:239]
    v_rcp_f32 v72, v72
    v_rcp_f32 v73, v73
    v_mfma_f32_16x16x32_bf16 v[252:255], a[228:231], a[172:175], v[252:255]
    v_rcp_f32 v74, v74
    v_rcp_f32 v75, v75
    v_rcp_f32 v88, v88
    v_rcp_f32 v89, v89
    v_rcp_f32 v90, v90
    v_rcp_f32 v91, v91
    v_pk_mul_f32 v[72:73], v[72:73], v[184:185]
    v_pk_mul_f32 v[74:75], v[74:75], v[186:187]
    v_pk_mul_f32 v[88:89], v[88:89], v[200:201]
    v_pk_mul_f32 v[90:91], v[90:91], v[202:203]
    v_cvt_pk_bf16_f32 v184, v72, v73
    v_cvt_pk_bf16_f32 v185, v74, v75
    v_cvt_pk_bf16_f32 v186, v88, v89
    v_cvt_pk_bf16_f32 v187, v90, v91
    s_nop 1
    v_permlane32_swap_b32 v184, v186
    v_permlane32_swap_b32 v185, v187
    buffer_store_dwordx4 v[184:187], v4, s[28:31], s17 offen offset:2048 sc1
    v_pk_mul_f32 v[104:105], v[104:105], s[48:49] op_sel_hi:[1,0]
    v_pk_mul_f32 v[106:107], v[106:107], s[48:49] op_sel_hi:[1,0]
    v_pk_mul_f32 v[120:121], v[120:121], s[48:49] op_sel_hi:[1,0]
    v_pk_mul_f32 v[122:123], v[122:123], s[48:49] op_sel_hi:[1,0]
    v_exp_f32 v104, v104
    v_exp_f32 v105, v105
    v_exp_f32 v106, v106
    v_exp_f32 v107, v107
    v_exp_f32 v120, v120
    v_exp_f32 v121, v121
    v_exp_f32 v122, v122
    v_exp_f32 v123, v123
    v_pk_add_f32 v[104:105], v[104:105], s[50:51] op_sel_hi:[1,0]
    v_pk_add_f32 v[106:107], v[106:107], s[50:51] op_sel_hi:[1,0]
    v_pk_add_f32 v[120:121], v[120:121], s[50:51] op_sel_hi:[1,0]
    v_pk_add_f32 v[122:123], v[122:123], s[50:51] op_sel_hi:[1,0]
    v_rcp_f32 v104, v104
    v_rcp_f32 v105, v105
    v_rcp_f32 v106, v106
    v_rcp_f32 v107, v107
    v_rcp_f32 v120, v120
    v_rcp_f32 v121, v121
    v_rcp_f32 v122, v122
    v_rcp_f32 v123, v123
    v_pk_mul_f32 v[104:105], v[104:105], v[216:217]
    v_pk_mul_f32 v[106:107], v[106:107], v[218:219]
    v_pk_mul_f32 v[120:121], v[120:121], v[232:233]
    v_pk_mul_f32 v[122:123], v[122:123], v[234:235]
    v_cvt_pk_bf16_f32 v216, v104, v105
    v_cvt_pk_bf16_f32 v217, v106, v107
    v_cvt_pk_bf16_f32 v218, v120, v121
    v_cvt_pk_bf16_f32 v219, v122, v123
    s_nop 1
    v_permlane32_swap_b32 v216, v218
    v_permlane32_swap_b32 v217, v219
    buffer_store_dwordx4 v[216:219], v4, s[28:31], s19 offen offset:0 sc1
    v_pk_mul_f32 v[136:137], v[136:137], s[48:49] op_sel_hi:[1,0]
    v_pk_mul_f32 v[138:139], v[138:139], s[48:49] op_sel_hi:[1,0]
    v_exp_f32 v136, v136
    v_exp_f32 v137, v137
    v_exp_f32 v138, v138
    v_exp_f32 v139, v139
    v_pk_add_f32 v[136:137], v[136:137], s[50:51] op_sel_hi:[1,0]
    v_pk_add_f32 v[138:139], v[138:139], s[50:51] op_sel_hi:[1,0]
    v_rcp_f32 v136, v136
    v_rcp_f32 v137, v137
    v_rcp_f32 v138, v138
    v_rcp_f32 v139, v139
    v_pk_mul_f32 v[136:137], v[136:137], v[248:249]
    v_pk_mul_f32 v[138:139], v[138:139], v[250:251]
    v_cvt_pk_bf16_f32 v242, v136, v137
    v_cvt_pk_bf16_f32 v243, v138, v139
    s_nop 1
    v_permlane32_swap_b32 v240, v242
    v_permlane32_swap_b32 v241, v243
    buffer_store_dwordx4 v[240:243], v9, s[28:31], s18 offen offset:2048 sc1
    v_pk_mul_f32 v[44:45], v[44:45], s[48:49] op_sel_hi:[1,0]
    v_pk_mul_f32 v[46:47], v[46:47], s[48:49] op_sel_hi:[1,0]
    v_pk_mul_f32 v[60:61], v[60:61], s[48:49] op_sel_hi:[1,0]
    v_pk_mul_f32 v[62:63], v[62:63], s[48:49] op_sel_hi:[1,0]
    v_exp_f32 v44, v44
    v_exp_f32 v45, v45
    v_exp_f32 v46, v46
    v_exp_f32 v47, v47
    v_exp_f32 v60, v60
    v_exp_f32 v61, v61
    v_exp_f32 v62, v62
    v_exp_f32 v63, v63
    v_pk_add_f32 v[44:45], v[44:45], s[50:51] op_sel_hi:[1,0]
    v_pk_add_f32 v[46:47], v[46:47], s[50:51] op_sel_hi:[1,0]
    v_pk_add_f32 v[60:61], v[60:61], s[50:51] op_sel_hi:[1,0]
    v_pk_add_f32 v[62:63], v[62:63], s[50:51] op_sel_hi:[1,0]
    v_rcp_f32 v44, v44
    v_rcp_f32 v45, v45
    v_rcp_f32 v46, v46
    v_rcp_f32 v47, v47
    v_rcp_f32 v60, v60
    v_rcp_f32 v61, v61
    v_rcp_f32 v62, v62
    v_rcp_f32 v63, v63
    v_pk_mul_f32 v[44:45], v[44:45], v[156:157]
    v_pk_mul_f32 v[46:47], v[46:47], v[158:159]
    v_pk_mul_f32 v[60:61], v[60:61], v[172:173]
    v_pk_mul_f32 v[62:63], v[62:63], v[174:175]
    v_cvt_pk_bf16_f32 v156, v44, v45
    v_cvt_pk_bf16_f32 v157, v46, v47
    v_cvt_pk_bf16_f32 v158, v60, v61
    v_cvt_pk_bf16_f32 v159, v62, v63
    s_nop 1
    v_permlane32_swap_b32 v156, v158
    v_permlane32_swap_b32 v157, v159
    buffer_store_dwordx4 v[156:159], v4, s[28:31], s17 offen offset:256 sc1
    v_pk_mul_f32 v[76:77], v[76:77], s[48:49] op_sel_hi:[1,0]
    v_pk_mul_f32 v[78:79], v[78:79], s[48:49] op_sel_hi:[1,0]
    v_pk_mul_f32 v[92:93], v[92:93], s[48:49] op_sel_hi:[1,0]
    v_pk_mul_f32 v[94:95], v[94:95], s[48:49] op_sel_hi:[1,0]
    v_exp_f32 v76, v76
    v_exp_f32 v77, v77
    v_exp_f32 v78, v78
    v_exp_f32 v79, v79
    v_exp_f32 v92, v92
    v_exp_f32 v93, v93
    v_exp_f32 v94, v94
    v_exp_f32 v95, v95
    v_pk_add_f32 v[76:77], v[76:77], s[50:51] op_sel_hi:[1,0]
    v_pk_add_f32 v[78:79], v[78:79], s[50:51] op_sel_hi:[1,0]
    v_pk_add_f32 v[92:93], v[92:93], s[50:51] op_sel_hi:[1,0]
    v_pk_add_f32 v[94:95], v[94:95], s[50:51] op_sel_hi:[1,0]
    v_rcp_f32 v76, v76
    v_rcp_f32 v77, v77
    v_rcp_f32 v78, v78
    v_rcp_f32 v79, v79
    v_rcp_f32 v92, v92
    v_rcp_f32 v93, v93
    v_rcp_f32 v94, v94
    v_rcp_f32 v95, v95
    v_pk_mul_f32 v[76:77], v[76:77], v[188:189]
    v_pk_mul_f32 v[78:79], v[78:79], v[190:191]
    v_pk_mul_f32 v[92:93], v[92:93], v[204:205]
    v_pk_mul_f32 v[94:95], v[94:95], v[206:207]
    v_cvt_pk_bf16_f32 v188, v76, v77
    v_cvt_pk_bf16_f32 v189, v78, v79
    v_cvt_pk_bf16_f32 v190, v92, v93
    v_cvt_pk_bf16_f32 v191, v94, v95
    s_nop 1
    v_permlane32_swap_b32 v188, v190
    v_permlane32_swap_b32 v189, v191
    buffer_store_dwordx4 v[188:191], v4, s[28:31], s17 offen offset:2304 sc1
    v_pk_mul_f32 v[108:109], v[108:109], s[48:49] op_sel_hi:[1,0]
    v_pk_mul_f32 v[110:111], v[110:111], s[48:49] op_sel_hi:[1,0]
    v_pk_mul_f32 v[124:125], v[124:125], s[48:49] op_sel_hi:[1,0]
    v_pk_mul_f32 v[126:127], v[126:127], s[48:49] op_sel_hi:[1,0]
    v_exp_f32 v108, v108
    v_exp_f32 v109, v109
    v_exp_f32 v110, v110
    v_exp_f32 v111, v111
    v_exp_f32 v124, v124
    v_exp_f32 v125, v125
    v_exp_f32 v126, v126
    v_exp_f32 v127, v127
    v_pk_add_f32 v[108:109], v[108:109], s[50:51] op_sel_hi:[1,0]
    v_pk_add_f32 v[110:111], v[110:111], s[50:51] op_sel_hi:[1,0]
    v_pk_add_f32 v[124:125], v[124:125], s[50:51] op_sel_hi:[1,0]
    v_pk_add_f32 v[126:127], v[126:127], s[50:51] op_sel_hi:[1,0]
    v_rcp_f32 v108, v108
    v_rcp_f32 v109, v109
    v_rcp_f32 v110, v110
    v_rcp_f32 v111, v111
    v_rcp_f32 v124, v124
    v_rcp_f32 v125, v125
    v_rcp_f32 v126, v126
    v_rcp_f32 v127, v127
    v_pk_mul_f32 v[108:109], v[108:109], v[220:221]
    v_pk_mul_f32 v[110:111], v[110:111], v[222:223]
    v_pk_mul_f32 v[124:125], v[124:125], v[236:237]
    v_pk_mul_f32 v[126:127], v[126:127], v[238:239]
    v_cvt_pk_bf16_f32 v220, v108, v109
    v_cvt_pk_bf16_f32 v221, v110, v111
    v_cvt_pk_bf16_f32 v222, v124, v125
    v_cvt_pk_bf16_f32 v223, v126, v127
    s_nop 1
    v_permlane32_swap_b32 v220, v222
    v_permlane32_swap_b32 v221, v223
    buffer_store_dwordx4 v[220:223], v4, s[28:31], s19 offen offset:256 sc1
    v_pk_mul_f32 v[140:141], v[140:141], s[48:49] op_sel_hi:[1,0]
    v_pk_mul_f32 v[142:143], v[142:143], s[48:49] op_sel_hi:[1,0]
    v_exp_f32 v140, v140
    v_exp_f32 v141, v141
    v_exp_f32 v142, v142
    v_exp_f32 v143, v143
    v_pk_add_f32 v[140:141], v[140:141], s[50:51] op_sel_hi:[1,0]
    v_pk_add_f32 v[142:143], v[142:143], s[50:51] op_sel_hi:[1,0]
    v_rcp_f32 v140, v140
    v_rcp_f32 v141, v141
    v_rcp_f32 v142, v142
    v_rcp_f32 v143, v143
    v_pk_mul_f32 v[140:141], v[140:141], v[252:253]
    v_pk_mul_f32 v[142:143], v[142:143], v[254:255]
    v_cvt_pk_bf16_f32 v246, v140, v141
    v_cvt_pk_bf16_f32 v247, v142, v143
    s_nop 1
    v_permlane32_swap_b32 v244, v246
    v_permlane32_swap_b32 v245, v247
    buffer_store_dwordx4 v[244:247], v9, s[28:31], s18 offen offset:2304 sc1
    s_mov_b32 s14, s53
    s_mov_b32 s12, s54
    s_mov_b32 s13, s55
    s_lshl_b32 s15, s13, 1
    s_add_u32 s15, s15, s14
    s_lshl_b32 s43, s12, 2
    s_add_u32 s43, s43, s3
    s_mul_i32 s40, s43, 229376
    s_mul_i32 s16, s14, 114688
    s_add_u32 s40, s40, s16
    v_and_b32 v3, 15, v1
    v_bfe_u32 v6, v1, 4, 1
    v_lshrrev_b32 v7, 5, v1
    v_lshlrev_b32 v5, 4, v3
    v_lshl_add_u32 v5, v6, 9, v5
    v_lshl_add_u32 v2, v7, 3, v5
    v_mov_b32 v10, v25
    v_mov_b32 v11, 0
    v_mov_b32 v12, v21
    v_mov_b32 v13, v22
    v_mov_b32 v14, v23
    v_mov_b32 v15, v24
    v_lshrrev_b32 v8, 2, v3
    v_lshl_add_u32 v8, v6, 2, v8
    v_lshl_add_u32 v5, v7, 4, v8
    v_lshlrev_b32 v5, 8, v5
    v_lshl_add_u32 v5, v8, 5, v5
    v_and_b32 v8, 3, v3
    v_lshl_add_u32 v5, v8, 3, v5
    s_lshl_b32 s16, s14, 7
    v_xor_b32 v5, s16, v5
    v_xor_b32 v16, 0, v5
    v_add_u32 v24, 65536, v16
    v_xor_b32 v17, 32, v5
    v_add_u32 v25, 65536, v17
    v_xor_b32 v18, 64, v5
    v_add_u32 v26, 65536, v18
    v_xor_b32 v19, 96, v5
    v_add_u32 v27, 65536, v19
    v_xor_b32 v20, 128, v5
    v_add_u32 v28, 65536, v20
    v_xor_b32 v21, 160, v5
    v_add_u32 v29, 65536, v21
    v_xor_b32 v22, 192, v5
    v_add_u32 v30, 65536, v22
    v_xor_b32 v23, 224, v5
    v_add_u32 v31, 65536, v23
    s_add_u32 s20, s8, 0xe00000
    s_addc_u32 s21, s9, 0
    s_mov_b32 s22, 0x400000
    s_mov_b32 s23, 0x20000
    s_mov_b32 s24, s10
    s_mov_b32 s25, s11
    s_mov_b32 s26, 0x400000
    s_mov_b32 s27, 0x20000
    s_mov_b32 s45, 0
    s_mov_b32 s63, 237568
    s_waitcnt vmcnt(0)
    s_barrier
    s_cmp_lg_u32 s3, 0
    s_cbranch_scc1 L_k4_glu_kernel_w0_4
    s_mov_b64 exec, 1
    buffer_store_dword v11, off, s[36:39], s62 sc0 sc1
    s_mov_b64 exec, -1
    buffer_load_dword v8, v10, s[36:39], s63 offen sc0 sc1
L_k4_glu_kernel_w0_4:
    v_mov_b32 v240, v12
    v_mov_b32 v241, v13
    v_mov_b32 v242, v14
    v_mov_b32 v243, v15
    ds_read_b64_tr_b16 v[96:97], v16 offset:0
    ds_read_b64_tr_b16 v[98:99], v16 offset:2048
    ds_read_b64_tr_b16 v[100:101], v17 offset:0
    ds_read_b64_tr_b16 v[102:103], v17 offset:2048
    ds_read_b64_tr_b16 v[104:105], v18 offset:0
    ds_read_b64_tr_b16 v[106:107], v18 offset:2048
    ds_read_b64_tr_b16 v[108:109], v19 offset:0
    ds_read_b64_tr_b16 v[110:111], v19 offset:2048
    ds_read_b64_tr_b16 v[112:113], v20 offset:0
    ds_read_b64_tr_b16 v[114:115], v20 offset:2048
    ds_read_b64_tr_b16 v[116:117], v21 offset:0
    ds_read_b64_tr_b16 v[118:119], v21 offset:2048
    ds_read_b64_tr_b16 v[120:121], v22 offset:0
    ds_read_b64_tr_b16 v[122:123], v22 offset:2048
    ds_read_b64_tr_b16 v[124:125], v23 offset:0
    ds_read_b64_tr_b16 v[126:127], v23 offset:2048
    s_cmp_lg_u32 s3, 0
    s_cbranch_scc1 L_k4_glu_kernel_rdy_3
    s_waitcnt vmcnt(0)
    v_cmp_eq_u32 vcc, -1, v8
    s_cbranch_vccz L_k4_glu_kernel_rdy_3
L_k4_glu_kernel_wait_2:
    buffer_load_dword v8, v10, s[36:39], s63 offen sc0 sc1
    s_add_u32 s45, s45, 1
    s_cmp_gt_u32 s45, 4000
    s_waitcnt vmcnt(0)
    s_cbranch_scc1 L_k4_glu_kernel_rdy_3
    v_cmp_eq_u32 vcc, -1, v8
    s_cbranch_vccnz L_k4_glu_kernel_wait_2
L_k4_glu_kernel_rdy_3:
    s_barrier
    buffer_load_dwordx4 a[0:3], v4, s[28:31], s40 offen offset:0
    buffer_load_dwordx4 a[4:7], v4, s[28:31], s40 offen offset:256
    buffer_load_dwordx4 a[8:11], v4, s[28:31], s40 offen offset:2048
    buffer_load_dwordx4 a[12:15], v4, s[28:31], s40 offen offset:2304
    s_add_u32 s40, s40, 4096
    buffer_load_dwordx4 a[16:19], v4, s[28:31], s40 offen offset:0
    buffer_load_dwordx4 a[20:23], v4, s[28:31], s40 offen offset:256
    buffer_load_dwordx4 a[24:27], v4, s[28:31], s40 offen offset:2048
    buffer_load_dwordx4 a[28:31], v4, s[28:31], s40 offen offset:2304
    s_waitcnt vmcnt(6)
    s_waitcnt lgkmcnt(14)
    v_mfma_f32_16x16x32_bf16 v[32:35], v[96:99], a[0:3], 0
    ds_read_b64_tr_b16 v[128:129], v16 offset:8192
    v_mfma_f32_16x16x32_bf16 v[36:39], v[96:99], a[4:7], 0
    ds_read_b64_tr_b16 v[130:131], v16 offset:10240
    s_add_u32 s40, s40, 4096
    buffer_load_dwordx4 a[32:35], v4, s[28:31], s40 offen offset:0
    s_waitcnt lgkmcnt(14)
    v_mfma_f32_16x16x32_bf16 v[40:43], v[100:103], a[0:3], 0
    ds_read_b64_tr_b16 v[132:133], v17 offset:8192
    v_mfma_f32_16x16x32_bf16 v[44:47], v[100:103], a[4:7], 0
    ds_read_b64_tr_b16 v[134:135], v17 offset:10240
    buffer_load_dwordx4 a[36:39], v4, s[28:31], s40 offen offset:256
    s_waitcnt lgkmcnt(14)
    v_mfma_f32_16x16x32_bf16 v[48:51], v[104:107], a[0:3], 0
    ds_read_b64_tr_b16 v[136:137], v18 offset:8192
    v_mfma_f32_16x16x32_bf16 v[52:55], v[104:107], a[4:7], 0
    ds_read_b64_tr_b16 v[138:139], v18 offset:10240
    buffer_load_dwordx4 a[40:43], v4, s[28:31], s40 offen offset:2048
    s_waitcnt lgkmcnt(14)
    v_mfma_f32_16x16x32_bf16 v[56:59], v[108:111], a[0:3], 0
    ds_read_b64_tr_b16 v[140:141], v19 offset:8192
    v_mfma_f32_16x16x32_bf16 v[60:63], v[108:111], a[4:7], 0
    ds_read_b64_tr_b16 v[142:143], v19 offset:10240
    buffer_load_dwordx4 a[44:47], v4, s[28:31], s40 offen offset:2304
    s_waitcnt lgkmcnt(14)
    v_mfma_f32_16x16x32_bf16 v[64:67], v[112:115], a[0:3], 0
    ds_read_b64_tr_b16 v[144:145], v20 offset:8192
    v_mfma_f32_16x16x32_bf16 v[68:71], v[112:115], a[4:7], 0
    ds_read_b64_tr_b16 v[146:147], v20 offset:10240
    s_add_u32 s40, s40, 4096
    buffer_load_dwordx4 a[48:51], v4, s[28:31], s40 offen offset:0
    s_waitcnt lgkmcnt(14)
    v_mfma_f32_16x16x32_bf16 v[72:75], v[116:119], a[0:3], 0
    ds_read_b64_tr_b16 v[148:149], v21 offset:8192
    v_mfma_f32_16x16x32_bf16 v[76:79], v[116:119], a[4:7], 0
    ds_read_b64_tr_b16 v[150:151], v21 offset:10240
    buffer_load_dwordx4 a[52:55], v4, s[28:31], s40 offen offset:256
    s_waitcnt lgkmcnt(14)
    v_mfma_f32_16x16x32_bf16 v[80:83], v[120:123], a[0:3], 0
    ds_read_b64_tr_b16 v[152:153], v22 offset:8192
    v_mfma_f32_16x16x32_bf16 v[84:87], v[120:123], a[4:7], 0
    ds_read_b64_tr_b16 v[154:155], v22 offset:10240
    buffer_load_dwordx4 a[56:59], v4, s[28:31], s40 offen offset:2048
    s_waitcnt lgkmcnt(14)
    v_mfma_f32_16x16x32_bf16 v[88:91], v[124:127], a[0:3], 0
    ds_read_b64_tr_b16 v[156:157], v23 offset:8192
    v_mfma_f32_16x16x32_bf16 v[92:95], v[124:127], a[4:7], 0
    ds_read_b64_tr_b16 v[158:159], v23 offset:10240
    buffer_load_dwordx4 a[60:63], v4, s[28:31], s40 offen offset:2304
    s_waitcnt vmcnt(12)
    s_waitcnt lgkmcnt(12)
    v_mfma_f32_16x16x32_bf16 v[32:35], v[128:131], a[8:11], v[32:35]
    ds_read_b64_tr_b16 v[96:97], v16 offset:16384
    v_mfma_f32_16x16x32_bf16 v[36:39], v[128:131], a[12:15], v[36:39]
    ds_read_b64_tr_b16 v[98:99], v16 offset:18432
    s_add_u32 s40, s40, 4096
    buffer_load_dwordx4 a[64:67], v4, s[28:31], s40 offen offset:0
    v_mfma_f32_16x16x32_bf16 v[40:43], v[132:135], a[8:11], v[40:43]
    ds_read_b64_tr_b16 v[100:101], v17 offset:16384
    v_mfma_f32_16x16x32_bf16 v[44:47], v[132:135], a[12:15], v[44:47]
    ds_read_b64_tr_b16 v[102:103], v17 offset:18432
    buffer_load_dwordx4 a[68:71], v4, s[28:31], s40 offen offset:256
    s_waitcnt lgkmcnt(12)
    v_mfma_f32_16x16x32_bf16 v[48:51], v[136:139], a[8:11], v[48:51]
    ds_read_b64_tr_b16 v[104:105], v18 offset:16384
    v_mfma_f32_16x16x32_bf16 v[52:55], v[136:139], a[12:15], v[52:55]
    ds_read_b64_tr_b16 v[106:107], v18 offset:18432
    v_mfma_f32_16x16x32_bf16 v[56:59], v[140:143], a[8:11], v[56:59]
    ds_read_b64_tr_b16 v[108:109], v19 offset:16384
    v_mfma_f32_16x16x32_bf16 v[60:63], v[140:143], a[12:15], v[60:63]
    ds_read_b64_tr_b16 v[110:111], v19 offset:18432
    s_waitcnt lgkmcnt(12)
    v_mfma_f32_16x16x32_bf16 v[64:67], v[144:147], a[8:11], v[64:67]
    ds_read_b64_tr_b16 v[112:113], v20 offset:16384
    v_mfma_f32_16x16x32_bf16 v[68:71], v[144:147], a[12:15], v[68:71]
    ds_read_b64_tr_b16 v[114:115], v20 offset:18432
    v_mfma_f32_16x16x32_bf16 v[72:75], v[148:151], a[8:11], v[72:75]
    ds_read_b64_tr_b16 v[116:117], v21 offset:16384
    v_mfma_f32_16x16x32_bf16 v[76:79], v[148:151], a[12:15], v[76:79]
    ds_read_b64_tr_b16 v[118:119], v21 offset:18432
    s_waitcnt lgkmcnt(12)
    v_mfma_f32_16x16x32_bf16 v[80:83], v[152:155], a[8:11], v[80:83]
    ds_read_b64_tr_b16 v[120:121], v22 offset:16384
    v_mfma_f32_16x16x32_bf16 v[84:87], v[152:155], a[12:15], v[84:87]
    ds_read_b64_tr_b16 v[122:123], v22 offset:18432
    v_mfma_f32_16x16x32_bf16 v[88:91], v[156:159], a[8:11], v[88:91]
    ds_read_b64_tr_b16 v[124:125], v23 offset:16384
    v_mfma_f32_16x16x32_bf16 v[92:95], v[156:159], a[12:15], v[92:95]
    ds_read_b64_tr_b16 v[126:127], v23 offset:18432
    s_waitcnt vmcnt(12)
    s_waitcnt lgkmcnt(12)
    v_mfma_f32_16x16x32_bf16 v[32:35], v[96:99], a[16:19], v[32:35]
    ds_read_b64_tr_b16 v[128:129], v16 offset:24576
    v_mfma_f32_16x16x32_bf16 v[36:39], v[96:99], a[20:23], v[36:39]
    ds_read_b64_tr_b16 v[130:131], v16 offset:26624
    buffer_load_dwordx4 a[72:75], v4, s[28:31], s40 offen offset:2048
    v_mfma_f32_16x16x32_bf16 v[40:43], v[100:103], a[16:19], v[40:43]
    ds_read_b64_tr_b16 v[132:133], v17 offset:24576
    v_mfma_f32_16x16x32_bf16 v[44:47], v[100:103], a[20:23], v[44:47]
    ds_read_b64_tr_b16 v[134:135], v17 offset:26624
    buffer_load_dwordx4 a[76:79], v4, s[28:31], s40 offen offset:2304
    s_waitcnt lgkmcnt(12)
    v_mfma_f32_16x16x32_bf16 v[48:51], v[104:107], a[16:19], v[48:51]
    ds_read_b64_tr_b16 v[136:137], v18 offset:24576
    v_mfma_f32_16x16x32_bf16 v[52:55], v[104:107], a[20:23], v[52:55]
    ds_read_b64_tr_b16 v[138:139], v18 offset:26624
    v_mfma_f32_16x16x32_bf16 v[56:59], v[108:111], a[16:19], v[56:59]
    ds_read_b64_tr_b16 v[140:141], v19 offset:24576
    v_mfma_f32_16x16x32_bf16 v[60:63], v[108:111], a[20:23], v[60:63]
    ds_read_b64_tr_b16 v[142:143], v19 offset:26624
    s_waitcnt lgkmcnt(12)
    v_mfma_f32_16x16x32_bf16 v[64:67], v[112:115], a[16:19], v[64:67]
    ds_read_b64_tr_b16 v[144:145], v20 offset:24576
    v_mfma_f32_16x16x32_bf16 v[68:71], v[112:115], a[20:23], v[68:71]
    ds_read_b64_tr_b16 v[146:147], v20 offset:26624
    v_mfma_f32_16x16x32_bf16 v[72:75], v[116:119], a[16:19], v[72:75]
    ds_read_b64_tr_b16 v[148:149], v21 offset:24576
    v_mfma_f32_16x16x32_bf16 v[76:79], v[116:119], a[20:23], v[76:79]
    ds_read_b64_tr_b16 v[150:151], v21 offset:26624
    s_waitcnt lgkmcnt(12)
    v_mfma_f32_16x16x32_bf16 v[80:83], v[120:123], a[16:19], v[80:83]
    ds_read_b64_tr_b16 v[152:153], v22 offset:24576
    v_mfma_f32_16x16x32_bf16 v[84:87], v[120:123], a[20:23], v[84:87]
    ds_read_b64_tr_b16 v[154:155], v22 offset:26624
    v_mfma_f32_16x16x32_bf16 v[88:91], v[124:127], a[16:19], v[88:91]
    ds_read_b64_tr_b16 v[156:157], v23 offset:24576
    v_mfma_f32_16x16x32_bf16 v[92:95], v[124:127], a[20:23], v[92:95]
    ds_read_b64_tr_b16 v[158:159], v23 offset:26624
    s_waitcnt vmcnt(12)
    s_waitcnt lgkmcnt(12)
    v_mfma_f32_16x16x32_bf16 v[32:35], v[128:131], a[24:27], v[32:35]
    ds_read_b64_tr_b16 v[96:97], v16 offset:32768
    v_mfma_f32_16x16x32_bf16 v[36:39], v[128:131], a[28:31], v[36:39]
    ds_read_b64_tr_b16 v[98:99], v16 offset:34816
    s_add_u32 s40, s40, 4096
    buffer_load_dwordx4 a[80:83], v4, s[28:31], s40 offen offset:0
    v_mfma_f32_16x16x32_bf16 v[40:43], v[132:135], a[24:27], v[40:43]
    ds_read_b64_tr_b16 v[100:101], v17 offset:32768
    v_mfma_f32_16x16x32_bf16 v[44:47], v[132:135], a[28:31], v[44:47]
    ds_read_b64_tr_b16 v[102:103], v17 offset:34816
    buffer_load_dwordx4 a[84:87], v4, s[28:31], s40 offen offset:256
    s_waitcnt lgkmcnt(12)
    v_mfma_f32_16x16x32_bf16 v[48:51], v[136:139], a[24:27], v[48:51]
    ds_read_b64_tr_b16 v[104:105], v18 offset:32768
    v_mfma_f32_16x16x32_bf16 v[52:55], v[136:139], a[28:31], v[52:55]
    ds_read_b64_tr_b16 v[106:107], v18 offset:34816
    v_mfma_f32_16x16x32_bf16 v[56:59], v[140:143], a[24:27], v[56:59]
    ds_read_b64_tr_b16 v[108:109], v19 offset:32768
    v_mfma_f32_16x16x32_bf16 v[60:63], v[140:143], a[28:31], v[60:63]
    ds_read_b64_tr_b16 v[110:111], v19 offset:34816
    s_waitcnt lgkmcnt(12)
    v_mfma_f32_16x16x32_bf16 v[64:67], v[144:147], a[24:27], v[64:67]
    ds_read_b64_tr_b16 v[112:113], v20 offset:32768
    v_mfma_f32_16x16x32_bf16 v[68:71], v[144:147], a[28:31], v[68:71]
    ds_read_b64_tr_b16 v[114:115], v20 offset:34816
    v_mfma_f32_16x16x32_bf16 v[72:75], v[148:151], a[24:27], v[72:75]
    ds_read_b64_tr_b16 v[116:117], v21 offset:32768
    v_mfma_f32_16x16x32_bf16 v[76:79], v[148:151], a[28:31], v[76:79]
    ds_read_b64_tr_b16 v[118:119], v21 offset:34816
    s_waitcnt lgkmcnt(12)
    v_mfma_f32_16x16x32_bf16 v[80:83], v[152:155], a[24:27], v[80:83]
    ds_read_b64_tr_b16 v[120:121], v22 offset:32768
    v_mfma_f32_16x16x32_bf16 v[84:87], v[152:155], a[28:31], v[84:87]
    ds_read_b64_tr_b16 v[122:123], v22 offset:34816
    v_mfma_f32_16x16x32_bf16 v[88:91], v[156:159], a[24:27], v[88:91]
    ds_read_b64_tr_b16 v[124:125], v23 offset:32768
    v_mfma_f32_16x16x32_bf16 v[92:95], v[156:159], a[28:31], v[92:95]
    ds_read_b64_tr_b16 v[126:127], v23 offset:34816
    s_waitcnt vmcnt(12)
    s_waitcnt lgkmcnt(12)
    v_mfma_f32_16x16x32_bf16 v[32:35], v[96:99], a[32:35], v[32:35]
    ds_read_b64_tr_b16 v[128:129], v16 offset:40960
    v_mfma_f32_16x16x32_bf16 v[36:39], v[96:99], a[36:39], v[36:39]
    ds_read_b64_tr_b16 v[130:131], v16 offset:43008
    buffer_load_dwordx4 a[88:91], v4, s[28:31], s40 offen offset:2048
    v_mfma_f32_16x16x32_bf16 v[40:43], v[100:103], a[32:35], v[40:43]
    ds_read_b64_tr_b16 v[132:133], v17 offset:40960
    v_mfma_f32_16x16x32_bf16 v[44:47], v[100:103], a[36:39], v[44:47]
    ds_read_b64_tr_b16 v[134:135], v17 offset:43008
    buffer_load_dwordx4 a[92:95], v4, s[28:31], s40 offen offset:2304
    s_waitcnt lgkmcnt(12)
    v_mfma_f32_16x16x32_bf16 v[48:51], v[104:107], a[32:35], v[48:51]
    ds_read_b64_tr_b16 v[136:137], v18 offset:40960
    v_mfma_f32_16x16x32_bf16 v[52:55], v[104:107], a[36:39], v[52:55]
    ds_read_b64_tr_b16 v[138:139], v18 offset:43008
    v_mfma_f32_16x16x32_bf16 v[56:59], v[108:111], a[32:35], v[56:59]
    ds_read_b64_tr_b16 v[140:141], v19 offset:40960
    v_mfma_f32_16x16x32_bf16 v[60:63], v[108:111], a[36:39], v[60:63]
    ds_read_b64_tr_b16 v[142:143], v19 offset:43008
    s_waitcnt lgkmcnt(12)
    v_mfma_f32_16x16x32_bf16 v[64:67], v[112:115], a[32:35], v[64:67]
    ds_read_b64_tr_b16 v[144:145], v20 offset:40960
    v_mfma_f32_16x16x32_bf16 v[68:71], v[112:115], a[36:39], v[68:71]
    ds_read_b64_tr_b16 v[146:147], v20 offset:43008
    v_mfma_f32_16x16x32_bf16 v[72:75], v[116:119], a[32:35], v[72:75]
    ds_read_b64_tr_b16 v[148:149], v21 offset:40960
    v_mfma_f32_16x16x32_bf16 v[76:79], v[116:119], a[36:39], v[76:79]
    ds_read_b64_tr_b16 v[150:151], v21 offset:43008
    s_waitcnt lgkmcnt(12)
    v_mfma_f32_16x16x32_bf16 v[80:83], v[120:123], a[32:35], v[80:83]
    ds_read_b64_tr_b16 v[152:153], v22 offset:40960
    v_mfma_f32_16x16x32_bf16 v[84:87], v[120:123], a[36:39], v[84:87]
    ds_read_b64_tr_b16 v[154:155], v22 offset:43008
    v_mfma_f32_16x16x32_bf16 v[88:91], v[124:127], a[32:35], v[88:91]
    ds_read_b64_tr_b16 v[156:157], v23 offset:40960
    v_mfma_f32_16x16x32_bf16 v[92:95], v[124:127], a[36:39], v[92:95]
    ds_read_b64_tr_b16 v[158:159], v23 offset:43008
    s_waitcnt vmcnt(12)
    s_waitcnt lgkmcnt(12)
    v_mfma_f32_16x16x32_bf16 v[32:35], v[128:131], a[40:43], v[32:35]
    ds_read_b64_tr_b16 v[96:97], v16 offset:49152
    v_mfma_f32_16x16x32_bf16 v[36:39], v[128:131], a[44:47], v[36:39]
    ds_read_b64_tr_b16 v[98:99], v16 offset:51200
    s_add_u32 s40, s40, 4096
    buffer_load_dwordx4 a[96:99], v4, s[28:31], s40 offen offset:0
    v_mfma_f32_16x16x32_bf16 v[40:43], v[132:135], a[40:43], v[40:43]
    ds_read_b64_tr_b16 v[100:101], v17 offset:49152
    v_mfma_f32_16x16x32_bf16 v[44:47], v[132:135], a[44:47], v[44:47]
    ds_read_b64_tr_b16 v[102:103], v17 offset:51200
    buffer_load_dwordx4 a[100:103], v4, s[28:31], s40 offen offset:256
    s_waitcnt lgkmcnt(12)
    v_mfma_f32_16x16x32_bf16 v[48:51], v[136:139], a[40:43], v[48:51]
    ds_read_b64_tr_b16 v[104:105], v18 offset:49152
    v_mfma_f32_16x16x32_bf16 v[52:55], v[136:139], a[44:47], v[52:55]
    ds_read_b64_tr_b16 v[106:107], v18 offset:51200
    v_mfma_f32_16x16x32_bf16 v[56:59], v[140:143], a[40:43], v[56:59]
    ds_read_b64_tr_b16 v[108:109], v19 offset:49152
    v_mfma_f32_16x16x32_bf16 v[60:63], v[140:143], a[44:47], v[60:63]
    ds_read_b64_tr_b16 v[110:111], v19 offset:51200
    s_waitcnt lgkmcnt(12)
    v_mfma_f32_16x16x32_bf16 v[64:67], v[144:147], a[40:43], v[64:67]
    ds_read_b64_tr_b16 v[112:113], v20 offset:49152
    v_mfma_f32_16x16x32_bf16 v[68:71], v[144:147], a[44:47], v[68:71]
    ds_read_b64_tr_b16 v[114:115], v20 offset:51200
    v_mfma_f32_16x16x32_bf16 v[72:75], v[148:151], a[40:43], v[72:75]
    ds_read_b64_tr_b16 v[116:117], v21 offset:49152
    v_mfma_f32_16x16x32_bf16 v[76:79], v[148:151], a[44:47], v[76:79]
    ds_read_b64_tr_b16 v[118:119], v21 offset:51200
    s_waitcnt lgkmcnt(12)
    v_mfma_f32_16x16x32_bf16 v[80:83], v[152:155], a[40:43], v[80:83]
    ds_read_b64_tr_b16 v[120:121], v22 offset:49152
    v_mfma_f32_16x16x32_bf16 v[84:87], v[152:155], a[44:47], v[84:87]
    ds_read_b64_tr_b16 v[122:123], v22 offset:51200
    v_mfma_f32_16x16x32_bf16 v[88:91], v[156:159], a[40:43], v[88:91]
    ds_read_b64_tr_b16 v[124:125], v23 offset:49152
    v_mfma_f32_16x16x32_bf16 v[92:95], v[156:159], a[44:47], v[92:95]
    ds_read_b64_tr_b16 v[126:127], v23 offset:51200
    s_waitcnt vmcnt(12)
    s_waitcnt lgkmcnt(12)
    v_mfma_f32_16x16x32_bf16 v[32:35], v[96:99], a[48:51], v[32:35]
    ds_read_b64_tr_b16 v[128:129], v16 offset:57344
    v_mfma_f32_16x16x32_bf16 v[36:39], v[96:99], a[52:55], v[36:39]
    ds_read_b64_tr_b16 v[130:131], v16 offset:59392
    buffer_load_dwordx4 a[104:107], v4, s[28:31], s40 offen offset:2048
    v_mfma_f32_16x16x32_bf16 v[40:43], v[100:103], a[48:51], v[40:43]
    ds_read_b64_tr_b16 v[132:133], v17 offset:57344
    v_mfma_f32_16x16x32_bf16 v[44:47], v[100:103], a[52:55], v[44:47]
    ds_read_b64_tr_b16 v[134:135], v17 offset:59392
    buffer_load_dwordx4 a[108:111], v4, s[28:31], s40 offen offset:2304
    s_waitcnt lgkmcnt(12)
    v_mfma_f32_16x16x32_bf16 v[48:51], v[104:107], a[48:51], v[48:51]
    ds_read_b64_tr_b16 v[136:137], v18 offset:57344
    v_mfma_f32_16x16x32_bf16 v[52:55], v[104:107], a[52:55], v[52:55]
    ds_read_b64_tr_b16 v[138:139], v18 offset:59392
    v_mfma_f32_16x16x32_bf16 v[56:59], v[108:111], a[48:51], v[56:59]
    ds_read_b64_tr_b16 v[140:141], v19 offset:57344
    v_mfma_f32_16x16x32_bf16 v[60:63], v[108:111], a[52:55], v[60:63]
    ds_read_b64_tr_b16 v[142:143], v19 offset:59392
    s_waitcnt lgkmcnt(12)
    v_mfma_f32_16x16x32_bf16 v[64:67], v[112:115], a[48:51], v[64:67]
    ds_read_b64_tr_b16 v[144:145], v20 offset:57344
    v_mfma_f32_16x16x32_bf16 v[68:71], v[112:115], a[52:55], v[68:71]
    ds_read_b64_tr_b16 v[146:147], v20 offset:59392
    v_mfma_f32_16x16x32_bf16 v[72:75], v[116:119], a[48:51], v[72:75]
    ds_read_b64_tr_b16 v[148:149], v21 offset:57344
    v_mfma_f32_16x16x32_bf16 v[76:79], v[116:119], a[52:55], v[76:79]
    ds_read_b64_tr_b16 v[150:151], v21 offset:59392
    s_waitcnt lgkmcnt(12)
    v_mfma_f32_16x16x32_bf16 v[80:83], v[120:123], a[48:51], v[80:83]
    ds_read_b64_tr_b16 v[152:153], v22 offset:57344
    v_mfma_f32_16x16x32_bf16 v[84:87], v[120:123], a[52:55], v[84:87]
    ds_read_b64_tr_b16 v[154:155], v22 offset:59392
    v_mfma_f32_16x16x32_bf16 v[88:91], v[124:127], a[48:51], v[88:91]
    ds_read_b64_tr_b16 v[156:157], v23 offset:57344
    v_mfma_f32_16x16x32_bf16 v[92:95], v[124:127], a[52:55], v[92:95]
    ds_read_b64_tr_b16 v[158:159], v23 offset:59392
    s_waitcnt vmcnt(12)
    s_waitcnt lgkmcnt(12)
    v_mfma_f32_16x16x32_bf16 v[32:35], v[128:131], a[56:59], v[32:35]
    s_barrier
    ds_read_b64_tr_b16 v[96:97], v24 offset:0
    v_mfma_f32_16x16x32_bf16 v[36:39], v[128:131], a[60:63], v[36:39]
    ds_read_b64_tr_b16 v[98:99], v24 offset:2048
    s_add_u32 s40, s40, 4096
    buffer_load_dwordx4 a[112:115], v4, s[28:31], s40 offen offset:0
    v_mfma_f32_16x16x32_bf16 v[40:43], v[132:135], a[56:59], v[40:43]
    ds_read_b64_tr_b16 v[100:101], v25 offset:0
    v_mfma_f32_16x16x32_bf16 v[44:47], v[132:135], a[60:63], v[44:47]
    ds_read_b64_tr_b16 v[102:103], v25 offset:2048
    s_add_u32 m0, s61, 0
    s_add_u32 s60, s60, 229376
    buffer_load_dwordx4 v240, s[56:59], s60 offen offset:0 lds
    s_waitcnt lgkmcnt(12)
    v_mfma_f32_16x16x32_bf16 v[48:51], v[136:139], a[56:59], v[48:51]
    ds_read_b64_tr_b16 v[104:105], v26 offset:0
    v_mfma_f32_16x16x32_bf16 v[52:55], v[136:139], a[60:63], v[52:55]
    ds_read_b64_tr_b16 v[106:107], v26 offset:2048
    buffer_load_dwordx4 a[116:119], v4, s[28:31], s40 offen offset:256
    v_mfma_f32_16x16x32_bf16 v[56:59], v[140:143], a[56:59], v[56:59]
    ds_read_b64_tr_b16 v[108:109], v27 offset:0
    v_mfma_f32_16x16x32_bf16 v[60:63], v[140:143], a[60:63], v[60:63]
    ds_read_b64_tr_b16 v[110:111], v27 offset:2048
    buffer_load_dwordx4 v241, s[56:59], s60 offen offset:1024 lds
    s_waitcnt lgkmcnt(12)
    v_mfma_f32_16x16x32_bf16 v[64:67], v[144:147], a[56:59], v[64:67]
    ds_read_b64_tr_b16 v[112:113], v28 offset:0
    v_mfma_f32_16x16x32_bf16 v[68:71], v[144:147], a[60:63], v[68:71]
    ds_read_b64_tr_b16 v[114:115], v28 offset:2048
    v_mfma_f32_16x16x32_bf16 v[72:75], v[148:151], a[56:59], v[72:75]
    ds_read_b64_tr_b16 v[116:117], v29 offset:0
    v_mfma_f32_16x16x32_bf16 v[76:79], v[148:151], a[60:63], v[76:79]
    ds_read_b64_tr_b16 v[118:119], v29 offset:2048
    s_waitcnt lgkmcnt(12)
    v_mfma_f32_16x16x32_bf16 v[80:83], v[152:155], a[56:59], v[80:83]
    ds_read_b64_tr_b16 v[120:121], v30 offset:0
    v_mfma_f32_16x16x32_bf16 v[84:87], v[152:155], a[60:63], v[84:87]
    ds_read_b64_tr_b16 v[122:123], v30 offset:2048
    v_mfma_f32_16x16x32_bf16 v[88:91], v[156:159], a[56:59], v[88:91]
    ds_read_b64_tr_b16 v[124:125], v31 offset:0
    v_mfma_f32_16x16x32_bf16 v[92:95], v[156:159], a[60:63], v[92:95]
    ds_read_b64_tr_b16 v[126:127], v31 offset:2048
    s_mov_b32 s44, 2
.p2align 6
L_k4_glu_kernel_main_5:
    s_waitcnt vmcnt(14) lgkmcnt(12)
    v_mfma_f32_16x16x32_bf16 v[32:35], v[96:99], a[64:67], v[32:35]
    ds_read_b64_tr_b16 v[128:129], v24 offset:8192
    v_mfma_f32_16x16x32_bf16 v[36:39], v[96:99], a[68:71], v[36:39]
    ds_read_b64_tr_b16 v[130:131], v24 offset:10240
    buffer_load_dwordx4 a[120:123], v4, s[28:31], s40 offen offset:2048
    v_mfma_f32_16x16x32_bf16 v[40:43], v[100:103], a[64:67], v[40:43]
    ds_read_b64_tr_b16 v[132:133], v25 offset:8192
    v_mfma_f32_16x16x32_bf16 v[44:47], v[100:103], a[68:71], v[44:47]
    ds_read_b64_tr_b16 v[134:135], v25 offset:10240
    s_waitcnt lgkmcnt(12)
    v_mfma_f32_16x16x32_bf16 v[48:51], v[104:107], a[64:67], v[48:51]
    ds_read_b64_tr_b16 v[136:137], v26 offset:8192
    v_mfma_f32_16x16x32_bf16 v[52:55], v[104:107], a[68:71], v[52:55]
    ds_read_b64_tr_b16 v[138:139], v26 offset:10240
    buffer_load_dwordx4 v242, s[56:59], s60 offen offset:2048 lds
    v_mfma_f32_16x16x32_bf16 v[56:59], v[108:111], a[64:67], v[56:59]
    ds_read_b64_tr_b16 v[140:141], v27 offset:8192
    v_mfma_f32_16x16x32_bf16 v[60:63], v[108:111], a[68:71], v[60:63]
    ds_read_b64_tr_b16 v[142:143], v27 offset:10240
    s_waitcnt lgkmcnt(12)
    v_mfma_f32_16x16x32_bf16 v[64:67], v[112:115], a[64:67], v[64:67]
    ds_read_b64_tr_b16 v[144:145], v28 offset:8192
    v_mfma_f32_16x16x32_bf16 v[68:71], v[112:115], a[68:71], v[68:71]
    ds_read_b64_tr_b16 v[146:147], v28 offset:10240
    buffer_load_dwordx4 a[124:127], v4, s[28:31], s40 offen offset:2304
    v_mfma_f32_16x16x32_bf16 v[72:75], v[116:119], a[64:67], v[72:75]
    ds_read_b64_tr_b16 v[148:149], v29 offset:8192
    v_mfma_f32_16x16x32_bf16 v[76:79], v[116:119], a[68:71], v[76:79]
    ds_read_b64_tr_b16 v[150:151], v29 offset:10240
    s_waitcnt lgkmcnt(12)
    v_mfma_f32_16x16x32_bf16 v[80:83], v[120:123], a[64:67], v[80:83]
    ds_read_b64_tr_b16 v[152:153], v30 offset:8192
    v_mfma_f32_16x16x32_bf16 v[84:87], v[120:123], a[68:71], v[84:87]
    ds_read_b64_tr_b16 v[154:155], v30 offset:10240
    buffer_load_dwordx4 v243, s[56:59], s60 offen offset:3072 lds
    v_mfma_f32_16x16x32_bf16 v[88:91], v[124:127], a[64:67], v[88:91]
    ds_read_b64_tr_b16 v[156:157], v31 offset:8192
    v_mfma_f32_16x16x32_bf16 v[92:95], v[124:127], a[68:71], v[92:95]
    ds_read_b64_tr_b16 v[158:159], v31 offset:10240
    s_waitcnt vmcnt(16) lgkmcnt(12)
    v_mfma_f32_16x16x32_bf16 v[32:35], v[128:131], a[72:75], v[32:35]
    ds_read_b64_tr_b16 v[96:97], v24 offset:16384
    s_add_u32 s40, s40, 4096
    v_mfma_f32_16x16x32_bf16 v[36:39], v[128:131], a[76:79], v[36:39]
    ds_read_b64_tr_b16 v[98:99], v24 offset:18432
    buffer_load_dwordx4 a[0:3], v4, s[28:31], s40 offen offset:0
    v_mfma_f32_16x16x32_bf16 v[40:43], v[132:135], a[72:75], v[40:43]
    ds_read_b64_tr_b16 v[100:101], v25 offset:16384
    v_mfma_f32_16x16x32_bf16 v[44:47], v[132:135], a[76:79], v[44:47]
    ds_read_b64_tr_b16 v[102:103], v25 offset:18432
    s_add_u32 m0, s61, 4096
    s_waitcnt lgkmcnt(12)
    v_mfma_f32_16x16x32_bf16 v[48:51], v[136:139], a[72:75], v[48:51]
    ds_read_b64_tr_b16 v[104:105], v26 offset:16384
    s_add_u32 s60, s60, 32768
    v_mfma_f32_16x16x32_bf16 v[52:55], v[136:139], a[76:79], v[52:55]
    ds_read_b64_tr_b16 v[106:107], v26 offset:18432
    buffer_load_dwordx4 v240, s[56:59], s60 offen offset:0 lds
    v_mfma_f32_16x16x32_bf16 v[56:59], v[140:143], a[72:75], v[56:59]
    ds_read_b64_tr_b16 v[108:109], v27 offset:16384
    v_mfma_f32_16x16x32_bf16 v[60:63], v[140:143], a[76:79], v[60:63]
    ds_read_b64_tr_b16 v[110:111], v27 offset:18432
    s_waitcnt lgkmcnt(12)
    v_mfma_f32_16x16x32_bf16 v[64:67], v[144:147], a[72:75], v[64:67]
    ds_read_b64_tr_b16 v[112:113], v28 offset:16384
    v_mfma_f32_16x16x32_bf16 v[68:71], v[144:147], a[76:79], v[68:71]
    ds_read_b64_tr_b16 v[114:115], v28 offset:18432
    buffer_load_dwordx4 a[4:7], v4, s[28:31], s40 offen offset:256
    v_mfma_f32_16x16x32_bf16 v[72:75], v[148:151], a[72:75], v[72:75]
    ds_read_b64_tr_b16 v[116:117], v29 offset:16384
    v_mfma_f32_16x16x32_bf16 v[76:79], v[148:151], a[76:79], v[76:79]
    ds_read_b64_tr_b16 v[118:119], v29 offset:18432
    s_waitcnt lgkmcnt(12)
    v_mfma_f32_16x16x32_bf16 v[80:83], v[152:155], a[72:75], v[80:83]
    ds_read_b64_tr_b16 v[120:121], v30 offset:16384
    v_mfma_f32_16x16x32_bf16 v[84:87], v[152:155], a[76:79], v[84:87]
    ds_read_b64_tr_b16 v[122:123], v30 offset:18432
    buffer_load_dwordx4 v241, s[56:59], s60 offen offset:1024 lds
    v_mfma_f32_16x16x32_bf16 v[88:91], v[156:159], a[72:75], v[88:91]
    ds_read_b64_tr_b16 v[124:125], v31 offset:16384
    v_mfma_f32_16x16x32_bf16 v[92:95], v[156:159], a[76:79], v[92:95]
    ds_read_b64_tr_b16 v[126:127], v31 offset:18432
    s_waitcnt vmcnt(18) lgkmcnt(12)
    v_mfma_f32_16x16x32_bf16 v[32:35], v[96:99], a[80:83], v[32:35]
    ds_read_b64_tr_b16 v[128:129], v24 offset:24576
    v_mfma_f32_16x16x32_bf16 v[36:39], v[96:99], a[84:87], v[36:39]
    ds_read_b64_tr_b16 v[130:131], v24 offset:26624
    buffer_load_dwordx4 a[8:11], v4, s[28:31], s40 offen offset:2048
    v_mfma_f32_16x16x32_bf16 v[40:43], v[100:103], a[80:83], v[40:43]
    ds_read_b64_tr_b16 v[132:133], v25 offset:24576
    v_mfma_f32_16x16x32_bf16 v[44:47], v[100:103], a[84:87], v[44:47]
    ds_read_b64_tr_b16 v[134:135], v25 offset:26624
    s_waitcnt lgkmcnt(12)
    v_mfma_f32_16x16x32_bf16 v[48:51], v[104:107], a[80:83], v[48:51]
    ds_read_b64_tr_b16 v[136:137], v26 offset:24576
    v_mfma_f32_16x16x32_bf16 v[52:55], v[104:107], a[84:87], v[52:55]
    ds_read_b64_tr_b16 v[138:139], v26 offset:26624
    buffer_load_dwordx4 v242, s[56:59], s60 offen offset:2048 lds
    v_mfma_f32_16x16x32_bf16 v[56:59], v[108:111], a[80:83], v[56:59]
    ds_read_b64_tr_b16 v[140:141], v27 offset:24576
    v_mfma_f32_16x16x32_bf16 v[60:63], v[108:111], a[84:87], v[60:63]
    ds_read_b64_tr_b16 v[142:143], v27 offset:26624
    s_waitcnt lgkmcnt(12)
    v_mfma_f32_16x16x32_bf16 v[64:67], v[112:115], a[80:83], v[64:67]
    ds_read_b64_tr_b16 v[144:145], v28 offset:24576
    v_mfma_f32_16x16x32_bf16 v[68:71], v[112:115], a[84:87], v[68:71]
    ds_read_b64_tr_b16 v[146:147], v28 offset:26624
    buffer_load_dwordx4 a[12:15], v4, s[28:31], s40 offen offset:2304
    v_mfma_f32_16x16x32_bf16 v[72:75], v[116:119], a[80:83], v[72:75]
    ds_read_b64_tr_b16 v[148:149], v29 offset:24576
    v_mfma_f32_16x16x32_bf16 v[76:79], v[116:119], a[84:87], v[76:79]
    ds_read_b64_tr_b16 v[150:151], v29 offset:26624
    s_waitcnt lgkmcnt(12)
    v_mfma_f32_16x16x32_bf16 v[80:83], v[120:123], a[80:83], v[80:83]
    ds_read_b64_tr_b16 v[152:153], v30 offset:24576
    v_mfma_f32_16x16x32_bf16 v[84:87], v[120:123], a[84:87], v[84:87]
    ds_read_b64_tr_b16 v[154:155], v30 offset:26624
    buffer_load_dwordx4 v243, s[56:59], s60 offen offset:3072 lds
    v_mfma_f32_16x16x32_bf16 v[88:91], v[124:127], a[80:83], v[88:91]
    ds_read_b64_tr_b16 v[156:157], v31 offset:24576
    v_mfma_f32_16x16x32_bf16 v[92:95], v[124:127], a[84:87], v[92:95]
    ds_read_b64_tr_b16 v[158:159], v31 offset:26624
    s_waitcnt vmcnt(20) lgkmcnt(12)
    v_mfma_f32_16x16x32_bf16 v[32:35], v[128:131], a[88:91], v[32:35]
    s_waitcnt vmcnt(16)
    s_barrier
    ds_read_b64_tr_b16 v[96:97], v24 offset:32768
    s_add_u32 s40, s40, 4096
    v_mfma_f32_16x16x32_bf16 v[36:39], v[128:131], a[92:95], v[36:39]
    ds_read_b64_tr_b16 v[98:99], v24 offset:34816
    buffer_load_dwordx4 a[16:19], v4, s[28:31], s40 offen offset:0
    v_mfma_f32_16x16x32_bf16 v[40:43], v[132:135], a[88:91], v[40:43]
    ds_read_b64_tr_b16 v[100:101], v25 offset:32768
    v_mfma_f32_16x16x32_bf16 v[44:47], v[132:135], a[92:95], v[44:47]
    ds_read_b64_tr_b16 v[102:103], v25 offset:34816
    s_add_u32 m0, s61, 32768
    s_waitcnt lgkmcnt(12)
    v_mfma_f32_16x16x32_bf16 v[48:51], v[136:139], a[88:91], v[48:51]
    ds_read_b64_tr_b16 v[104:105], v26 offset:32768
    s_add_u32 s60, s60, 229376
    v_mfma_f32_16x16x32_bf16 v[52:55], v[136:139], a[92:95], v[52:55]
    ds_read_b64_tr_b16 v[106:107], v26 offset:34816
    buffer_load_dwordx4 v240, s[56:59], s60 offen offset:0 lds
    v_mfma_f32_16x16x32_bf16 v[56:59], v[140:143], a[88:91], v[56:59]
    ds_read_b64_tr_b16 v[108:109], v27 offset:32768
    v_mfma_f32_16x16x32_bf16 v[60:63], v[140:143], a[92:95], v[60:63]
    ds_read_b64_tr_b16 v[110:111], v27 offset:34816
    s_waitcnt lgkmcnt(12)
    v_mfma_f32_16x16x32_bf16 v[64:67], v[144:147], a[88:91], v[64:67]
    ds_read_b64_tr_b16 v[112:113], v28 offset:32768
    v_mfma_f32_16x16x32_bf16 v[68:71], v[144:147], a[92:95], v[68:71]
    ds_read_b64_tr_b16 v[114:115], v28 offset:34816
    buffer_load_dwordx4 a[20:23], v4, s[28:31], s40 offen offset:256
    v_mfma_f32_16x16x32_bf16 v[72:75], v[148:151], a[88:91], v[72:75]
    ds_read_b64_tr_b16 v[116:117], v29 offset:32768
    v_mfma_f32_16x16x32_bf16 v[76:79], v[148:151], a[92:95], v[76:79]
    ds_read_b64_tr_b16 v[118:119], v29 offset:34816
    s_waitcnt lgkmcnt(12)
    v_mfma_f32_16x16x32_bf16 v[80:83], v[152:155], a[88:91], v[80:83]
    ds_read_b64_tr_b16 v[120:121], v30 offset:32768
    v_mfma_f32_16x16x32_bf16 v[84:87], v[152:155], a[92:95], v[84:87]
    ds_read_b64_tr_b16 v[122:123], v30 offset:34816
    buffer_load_dwordx4 v241, s[56:59], s60 offen offset:1024 lds
    v_mfma_f32_16x16x32_bf16 v[88:91], v[156:159], a[88:91], v[88:91]
    ds_read_b64_tr_b16 v[124:125], v31 offset:32768
    v_mfma_f32_16x16x32_bf16 v[92:95], v[156:159], a[92:95], v[92:95]
    ds_read_b64_tr_b16 v[126:127], v31 offset:34816
    s_waitcnt vmcnt(22) lgkmcnt(12)
    v_mfma_f32_16x16x32_bf16 v[32:35], v[96:99], a[96:99], v[32:35]
    ds_read_b64_tr_b16 v[128:129], v24 offset:40960
    v_mfma_f32_16x16x32_bf16 v[36:39], v[96:99], a[100:103], v[36:39]
    ds_read_b64_tr_b16 v[130:131], v24 offset:43008
    buffer_load_dwordx4 a[24:27], v4, s[28:31], s40 offen offset:2048
    v_mfma_f32_16x16x32_bf16 v[40:43], v[100:103], a[96:99], v[40:43]
    ds_read_b64_tr_b16 v[132:133], v25 offset:40960
    v_mfma_f32_16x16x32_bf16 v[44:47], v[100:103], a[100:103], v[44:47]
    ds_read_b64_tr_b16 v[134:135], v25 offset:43008
    s_waitcnt lgkmcnt(12)
    v_mfma_f32_16x16x32_bf16 v[48:51], v[104:107], a[96:99], v[48:51]
    ds_read_b64_tr_b16 v[136:137], v26 offset:40960
    v_mfma_f32_16x16x32_bf16 v[52:55], v[104:107], a[100:103], v[52:55]
    ds_read_b64_tr_b16 v[138:139], v26 offset:43008
    buffer_load_dwordx4 v242, s[56:59], s60 offen offset:2048 lds
    v_mfma_f32_16x16x32_bf16 v[56:59], v[108:111], a[96:99], v[56:59]
    ds_read_b64_tr_b16 v[140:141], v27 offset:40960
    v_mfma_f32_16x16x32_bf16 v[60:63], v[108:111], a[100:103], v[60:63]
    ds_read_b64_tr_b16 v[142:143], v27 offset:43008
    s_waitcnt lgkmcnt(12)
    v_mfma_f32_16x16x32_bf16 v[64:67], v[112:115], a[96:99], v[64:67]
    ds_read_b64_tr_b16 v[144:145], v28 offset:40960
    v_mfma_f32_16x16x32_bf16 v[68:71], v[112:115], a[100:103], v[68:71]
    ds_read_b64_tr_b16 v[146:147], v28 offset:43008
    buffer_load_dwordx4 a[28:31], v4, s[28:31], s40 offen offset:2304
    v_mfma_f32_16x16x32_bf16 v[72:75], v[116:119], a[96:99], v[72:75]
    ds_read_b64_tr_b16 v[148:149], v29 offset:40960
    v_mfma_f32_16x16x32_bf16 v[76:79], v[116:119], a[100:103], v[76:79]
    ds_read_b64_tr_b16 v[150:151], v29 offset:43008
    s_waitcnt lgkmcnt(12)
    v_mfma_f32_16x16x32_bf16 v[80:83], v[120:123], a[96:99], v[80:83]
    ds_read_b64_tr_b16 v[152:153], v30 offset:40960
    v_mfma_f32_16x16x32_bf16 v[84:87], v[120:123], a[100:103], v[84:87]
    ds_read_b64_tr_b16 v[154:155], v30 offset:43008
    buffer_load_dwordx4 v243, s[56:59], s60 offen offset:3072 lds
    v_mfma_f32_16x16x32_bf16 v[88:91], v[124:127], a[96:99], v[88:91]
    ds_read_b64_tr_b16 v[156:157], v31 offset:40960
    v_mfma_f32_16x16x32_bf16 v[92:95], v[124:127], a[100:103], v[92:95]
    ds_read_b64_tr_b16 v[158:159], v31 offset:43008
    s_waitcnt vmcnt(24) lgkmcnt(12)
    v_mfma_f32_16x16x32_bf16 v[32:35], v[128:131], a[104:107], v[32:35]
    ds_read_b64_tr_b16 v[96:97], v24 offset:49152
    s_add_u32 s40, s40, 4096
    v_mfma_f32_16x16x32_bf16 v[36:39], v[128:131], a[108:111], v[36:39]
    ds_read_b64_tr_b16 v[98:99], v24 offset:51200
    buffer_load_dwordx4 a[32:35], v4, s[28:31], s40 offen offset:0
    v_mfma_f32_16x16x32_bf16 v[40:43], v[132:135], a[104:107], v[40:43]
    ds_read_b64_tr_b16 v[100:101], v25 offset:49152
    v_mfma_f32_16x16x32_bf16 v[44:47], v[132:135], a[108:111], v[44:47]
    ds_read_b64_tr_b16 v[102:103], v25 offset:51200
    s_add_u32 m0, s61, 36864
    s_waitcnt lgkmcnt(12)
    v_mfma_f32_16x16x32_bf16 v[48:51], v[136:139], a[104:107], v[48:51]
    ds_read_b64_tr_b16 v[104:105], v26 offset:49152
    s_add_u32 s60, s60, 32768
    v_mfma_f32_16x16x32_bf16 v[52:55], v[136:139], a[108:111], v[52:55]
    ds_read_b64_tr_b16 v[106:107], v26 offset:51200
    buffer_load_dwordx4 v240, s[56:59], s60 offen offset:0 lds
    v_mfma_f32_16x16x32_bf16 v[56:59], v[140:143], a[104:107], v[56:59]
    ds_read_b64_tr_b16 v[108:109], v27 offset:49152
    v_mfma_f32_16x16x32_bf16 v[60:63], v[140:143], a[108:111], v[60:63]
    ds_read_b64_tr_b16 v[110:111], v27 offset:51200
    s_waitcnt lgkmcnt(12)
    v_mfma_f32_16x16x32_bf16 v[64:67], v[144:147], a[104:107], v[64:67]
    ds_read_b64_tr_b16 v[112:113], v28 offset:49152
    v_mfma_f32_16x16x32_bf16 v[68:71], v[144:147], a[108:111], v[68:71]
    ds_read_b64_tr_b16 v[114:115], v28 offset:51200
    buffer_load_dwordx4 a[36:39], v4, s[28:31], s40 offen offset:256
    v_mfma_f32_16x16x32_bf16 v[72:75], v[148:151], a[104:107], v[72:75]
    ds_read_b64_tr_b16 v[116:117], v29 offset:49152
    v_mfma_f32_16x16x32_bf16 v[76:79], v[148:151], a[108:111], v[76:79]
    ds_read_b64_tr_b16 v[118:119], v29 offset:51200
    s_waitcnt lgkmcnt(12)
    v_mfma_f32_16x16x32_bf16 v[80:83], v[152:155], a[104:107], v[80:83]
    ds_read_b64_tr_b16 v[120:121], v30 offset:49152
    v_mfma_f32_16x16x32_bf16 v[84:87], v[152:155], a[108:111], v[84:87]
    ds_read_b64_tr_b16 v[122:123], v30 offset:51200
    buffer_load_dwordx4 v241, s[56:59], s60 offen offset:1024 lds
    v_mfma_f32_16x16x32_bf16 v[88:91], v[156:159], a[104:107], v[88:91]
    ds_read_b64_tr_b16 v[124:125], v31 offset:49152
    v_mfma_f32_16x16x32_bf16 v[92:95], v[156:159], a[108:111], v[92:95]
    ds_read_b64_tr_b16 v[126:127], v31 offset:51200
    s_waitcnt vmcnt(25) lgkmcnt(12)
    v_mfma_f32_16x16x32_bf16 v[32:35], v[96:99], a[112:115], v[32:35]
    ds_read_b64_tr_b16 v[128:129], v24 offset:57344
    v_mfma_f32_16x16x32_bf16 v[36:39], v[96:99], a[116:119], v[36:39]
    ds_read_b64_tr_b16 v[130:131], v24 offset:59392
    buffer_load_dwordx4 a[40:43], v4, s[28:31], s40 offen offset:2048
    v_mfma_f32_16x16x32_bf16 v[40:43], v[100:103], a[112:115], v[40:43]
    ds_read_b64_tr_b16 v[132:133], v25 offset:57344
    v_mfma_f32_16x16x32_bf16 v[44:47], v[100:103], a[116:119], v[44:47]
    ds_read_b64_tr_b16 v[134:135], v25 offset:59392
    s_waitcnt lgkmcnt(12)
    v_mfma_f32_16x16x32_bf16 v[48:51], v[104:107], a[112:115], v[48:51]
    ds_read_b64_tr_b16 v[136:137], v26 offset:57344
    v_mfma_f32_16x16x32_bf16 v[52:55], v[104:107], a[116:119], v[52:55]
    ds_read_b64_tr_b16 v[138:139], v26 offset:59392
    buffer_load_dwordx4 v242, s[56:59], s60 offen offset:2048 lds
    v_mfma_f32_16x16x32_bf16 v[56:59], v[108:111], a[112:115], v[56:59]
    ds_read_b64_tr_b16 v[140:141], v27 offset:57344
    v_mfma_f32_16x16x32_bf16 v[60:63], v[108:111], a[116:119], v[60:63]
    ds_read_b64_tr_b16 v[142:143], v27 offset:59392
    s_waitcnt lgkmcnt(12)
    v_mfma_f32_16x16x32_bf16 v[64:67], v[112:115], a[112:115], v[64:67]
    ds_read_b64_tr_b16 v[144:145], v28 offset:57344
    v_mfma_f32_16x16x32_bf16 v[68:71], v[112:115], a[116:119], v[68:71]
    ds_read_b64_tr_b16 v[146:147], v28 offset:59392
    buffer_load_dwordx4 a[44:47], v4, s[28:31], s40 offen offset:2304
    v_mfma_f32_16x16x32_bf16 v[72:75], v[116:119], a[112:115], v[72:75]
    ds_read_b64_tr_b16 v[148:149], v29 offset:57344
    v_mfma_f32_16x16x32_bf16 v[76:79], v[116:119], a[116:119], v[76:79]
    ds_read_b64_tr_b16 v[150:151], v29 offset:59392
    s_waitcnt lgkmcnt(12)
    v_mfma_f32_16x16x32_bf16 v[80:83], v[120:123], a[112:115], v[80:83]
    ds_read_b64_tr_b16 v[152:153], v30 offset:57344
    v_mfma_f32_16x16x32_bf16 v[84:87], v[120:123], a[116:119], v[84:87]
    ds_read_b64_tr_b16 v[154:155], v30 offset:59392
    buffer_load_dwordx4 v243, s[56:59], s60 offen offset:3072 lds
    v_mfma_f32_16x16x32_bf16 v[88:91], v[124:127], a[112:115], v[88:91]
    ds_read_b64_tr_b16 v[156:157], v31 offset:57344
    v_mfma_f32_16x16x32_bf16 v[92:95], v[124:127], a[116:119], v[92:95]
    ds_read_b64_tr_b16 v[158:159], v31 offset:59392
    s_waitcnt vmcnt(25) lgkmcnt(12)
    v_mfma_f32_16x16x32_bf16 v[32:35], v[128:131], a[120:123], v[32:35]
    s_waitcnt vmcnt(16)
    s_barrier
    ds_read_b64_tr_b16 v[96:97], v16 offset:0
    s_add_u32 s40, s40, 4096
    v_mfma_f32_16x16x32_bf16 v[36:39], v[128:131], a[124:127], v[36:39]
    ds_read_b64_tr_b16 v[98:99], v16 offset:2048
    buffer_load_dwordx4 a[48:51], v4, s[28:31], s40 offen offset:0
    v_mfma_f32_16x16x32_bf16 v[40:43], v[132:135], a[120:123], v[40:43]
    ds_read_b64_tr_b16 v[100:101], v17 offset:0
    v_mfma_f32_16x16x32_bf16 v[44:47], v[132:135], a[124:127], v[44:47]
    ds_read_b64_tr_b16 v[102:103], v17 offset:2048
    s_add_u32 m0, s61, 65536
    s_waitcnt lgkmcnt(12)
    v_mfma_f32_16x16x32_bf16 v[48:51], v[136:139], a[120:123], v[48:51]
    ds_read_b64_tr_b16 v[104:105], v18 offset:0
    s_add_u32 s60, s60, 229376
    v_mfma_f32_16x16x32_bf16 v[52:55], v[136:139], a[124:127], v[52:55]
    ds_read_b64_tr_b16 v[106:107], v18 offset:2048
    buffer_load_dwordx4 v240, s[56:59], s60 offen offset:0 lds
    v_mfma_f32_16x16x32_bf16 v[56:59], v[140:143], a[120:123], v[56:59]
    ds_read_b64_tr_b16 v[108:109], v19 offset:0
    v_mfma_f32_16x16x32_bf16 v[60:63], v[140:143], a[124:127], v[60:63]
    ds_read_b64_tr_b16 v[110:111], v19 offset:2048
    s_waitcnt lgkmcnt(12)
    v_mfma_f32_16x16x32_bf16 v[64:67], v[144:147], a[120:123], v[64:67]
    ds_read_b64_tr_b16 v[112:113], v20 offset:0
    v_mfma_f32_16x16x32_bf16 v[68:71], v[144:147], a[124:127], v[68:71]
    ds_read_b64_tr_b16 v[114:115], v20 offset:2048
    buffer_load_dwordx4 a[52:55], v4, s[28:31], s40 offen offset:256
    v_mfma_f32_16x16x32_bf16 v[72:75], v[148:151], a[120:123], v[72:75]
    ds_read_b64_tr_b16 v[116:117], v21 offset:0
    v_mfma_f32_16x16x32_bf16 v[76:79], v[148:151], a[124:127], v[76:79]
    ds_read_b64_tr_b16 v[118:119], v21 offset:2048
    s_waitcnt lgkmcnt(12)
    v_mfma_f32_16x16x32_bf16 v[80:83], v[152:155], a[120:123], v[80:83]
    ds_read_b64_tr_b16 v[120:121], v22 offset:0
    v_mfma_f32_16x16x32_bf16 v[84:87], v[152:155], a[124:127], v[84:87]
    ds_read_b64_tr_b16 v[122:123], v22 offset:2048
    buffer_load_dwordx4 v241, s[56:59], s60 offen offset:1024 lds
    v_mfma_f32_16x16x32_bf16 v[88:91], v[156:159], a[120:123], v[88:91]
    ds_read_b64_tr_b16 v[124:125], v23 offset:0
    v_mfma_f32_16x16x32_bf16 v[92:95], v[156:159], a[124:127], v[92:95]
    ds_read_b64_tr_b16 v[126:127], v23 offset:2048
    s_waitcnt lgkmcnt(12)
    v_mfma_f32_16x16x32_bf16 v[32:35], v[96:99], a[0:3], v[32:35]
    ds_read_b64_tr_b16 v[128:129], v16 offset:8192
    v_mfma_f32_16x16x32_bf16 v[36:39], v[96:99], a[4:7], v[36:39]
    ds_read_b64_tr_b16 v[130:131], v16 offset:10240
    buffer_load_dwordx4 a[56:59], v4, s[28:31], s40 offen offset:2048
    v_mfma_f32_16x16x32_bf16 v[40:43], v[100:103], a[0:3], v[40:43]
    ds_read_b64_tr_b16 v[132:133], v17 offset:8192
    v_mfma_f32_16x16x32_bf16 v[44:47], v[100:103], a[4:7], v[44:47]
    ds_read_b64_tr_b16 v[134:135], v17 offset:10240
    s_waitcnt lgkmcnt(12)
    v_mfma_f32_16x16x32_bf16 v[48:51], v[104:107], a[0:3], v[48:51]
    ds_read_b64_tr_b16 v[136:137], v18 offset:8192
    v_mfma_f32_16x16x32_bf16 v[52:55], v[104:107], a[4:7], v[52:55]
    ds_read_b64_tr_b16 v[138:139], v18 offset:10240
    buffer_load_dwordx4 v242, s[56:59], s60 offen offset:2048 lds
    v_mfma_f32_16x16x32_bf16 v[56:59], v[108:111], a[0:3], v[56:59]
    ds_read_b64_tr_b16 v[140:141], v19 offset:8192
    v_mfma_f32_16x16x32_bf16 v[60:63], v[108:111], a[4:7], v[60:63]
    ds_read_b64_tr_b16 v[142:143], v19 offset:10240
    s_waitcnt lgkmcnt(12)
    v_mfma_f32_16x16x32_bf16 v[64:67], v[112:115], a[0:3], v[64:67]
    ds_read_b64_tr_b16 v[144:145], v20 offset:8192
    v_mfma_f32_16x16x32_bf16 v[68:71], v[112:115], a[4:7], v[68:71]
    ds_read_b64_tr_b16 v[146:147], v20 offset:10240
    buffer_load_dwordx4 a[60:63], v4, s[28:31], s40 offen offset:2304
    v_mfma_f32_16x16x32_bf16 v[72:75], v[116:119], a[0:3], v[72:75]
    ds_read_b64_tr_b16 v[148:149], v21 offset:8192
    v_mfma_f32_16x16x32_bf16 v[76:79], v[116:119], a[4:7], v[76:79]
    ds_read_b64_tr_b16 v[150:151], v21 offset:10240
    s_waitcnt lgkmcnt(12)
    v_mfma_f32_16x16x32_bf16 v[80:83], v[120:123], a[0:3], v[80:83]
    ds_read_b64_tr_b16 v[152:153], v22 offset:8192
    v_mfma_f32_16x16x32_bf16 v[84:87], v[120:123], a[4:7], v[84:87]
    ds_read_b64_tr_b16 v[154:155], v22 offset:10240
    buffer_load_dwordx4 v243, s[56:59], s60 offen offset:3072 lds
    v_mfma_f32_16x16x32_bf16 v[88:91], v[124:127], a[0:3], v[88:91]
    ds_read_b64_tr_b16 v[156:157], v23 offset:8192
    v_mfma_f32_16x16x32_bf16 v[92:95], v[124:127], a[4:7], v[92:95]
    ds_read_b64_tr_b16 v[158:159], v23 offset:10240
    s_waitcnt lgkmcnt(12)
    v_mfma_f32_16x16x32_bf16 v[32:35], v[128:131], a[8:11], v[32:35]
    ds_read_b64_tr_b16 v[96:97], v16 offset:16384
    s_add_u32 s40, s40, 4096
    v_mfma_f32_16x16x32_bf16 v[36:39], v[128:131], a[12:15], v[36:39]
    ds_read_b64_tr_b16 v[98:99], v16 offset:18432
    buffer_load_dwordx4 a[64:67], v4, s[28:31], s40 offen offset:0
    v_mfma_f32_16x16x32_bf16 v[40:43], v[132:135], a[8:11], v[40:43]
    ds_read_b64_tr_b16 v[100:101], v17 offset:16384
    v_mfma_f32_16x16x32_bf16 v[44:47], v[132:135], a[12:15], v[44:47]
    ds_read_b64_tr_b16 v[102:103], v17 offset:18432
    s_add_u32 m0, s61, 69632
    s_waitcnt lgkmcnt(12)
    v_mfma_f32_16x16x32_bf16 v[48:51], v[136:139], a[8:11], v[48:51]
    ds_read_b64_tr_b16 v[104:105], v18 offset:16384
    s_add_u32 s60, s60, 32768
    v_mfma_f32_16x16x32_bf16 v[52:55], v[136:139], a[12:15], v[52:55]
    ds_read_b64_tr_b16 v[106:107], v18 offset:18432
    buffer_load_dwordx4 v240, s[56:59], s60 offen offset:0 lds
    v_mfma_f32_16x16x32_bf16 v[56:59], v[140:143], a[8:11], v[56:59]
    ds_read_b64_tr_b16 v[108:109], v19 offset:16384
    v_mfma_f32_16x16x32_bf16 v[60:63], v[140:143], a[12:15], v[60:63]
    ds_read_b64_tr_b16 v[110:111], v19 offset:18432
    s_waitcnt lgkmcnt(12)
    v_mfma_f32_16x16x32_bf16 v[64:67], v[144:147], a[8:11], v[64:67]
    ds_read_b64_tr_b16 v[112:113], v20 offset:16384
    v_mfma_f32_16x16x32_bf16 v[68:71], v[144:147], a[12:15], v[68:71]
    ds_read_b64_tr_b16 v[114:115], v20 offset:18432
    buffer_load_dwordx4 a[68:71], v4, s[28:31], s40 offen offset:256
    v_mfma_f32_16x16x32_bf16 v[72:75], v[148:151], a[8:11], v[72:75]
    ds_read_b64_tr_b16 v[116:117], v21 offset:16384
    v_mfma_f32_16x16x32_bf16 v[76:79], v[148:151], a[12:15], v[76:79]
    ds_read_b64_tr_b16 v[118:119], v21 offset:18432
    s_waitcnt lgkmcnt(12)
    v_mfma_f32_16x16x32_bf16 v[80:83], v[152:155], a[8:11], v[80:83]
    ds_read_b64_tr_b16 v[120:121], v22 offset:16384
    v_mfma_f32_16x16x32_bf16 v[84:87], v[152:155], a[12:15], v[84:87]
    ds_read_b64_tr_b16 v[122:123], v22 offset:18432
    buffer_load_dwordx4 v241, s[56:59], s60 offen offset:1024 lds
    v_mfma_f32_16x16x32_bf16 v[88:91], v[156:159], a[8:11], v[88:91]
    ds_read_b64_tr_b16 v[124:125], v23 offset:16384
    v_mfma_f32_16x16x32_bf16 v[92:95], v[156:159], a[12:15], v[92:95]
    ds_read_b64_tr_b16 v[126:127], v23 offset:18432
    s_waitcnt vmcnt(25) lgkmcnt(12)
    v_mfma_f32_16x16x32_bf16 v[32:35], v[96:99], a[16:19], v[32:35]
    ds_read_b64_tr_b16 v[128:129], v16 offset:24576
    v_mfma_f32_16x16x32_bf16 v[36:39], v[96:99], a[20:23], v[36:39]
    ds_read_b64_tr_b16 v[130:131], v16 offset:26624
    buffer_load_dwordx4 a[72:75], v4, s[28:31], s40 offen offset:2048
    v_mfma_f32_16x16x32_bf16 v[40:43], v[100:103], a[16:19], v[40:43]
    ds_read_b64_tr_b16 v[132:133], v17 offset:24576
    v_mfma_f32_16x16x32_bf16 v[44:47], v[100:103], a[20:23], v[44:47]
    ds_read_b64_tr_b16 v[134:135], v17 offset:26624
    s_waitcnt lgkmcnt(12)
    v_mfma_f32_16x16x32_bf16 v[48:51], v[104:107], a[16:19], v[48:51]
    ds_read_b64_tr_b16 v[136:137], v18 offset:24576
    v_mfma_f32_16x16x32_bf16 v[52:55], v[104:107], a[20:23], v[52:55]
    ds_read_b64_tr_b16 v[138:139], v18 offset:26624
    buffer_load_dwordx4 v242, s[56:59], s60 offen offset:2048 lds
    v_mfma_f32_16x16x32_bf16 v[56:59], v[108:111], a[16:19], v[56:59]
    ds_read_b64_tr_b16 v[140:141], v19 offset:24576
    v_mfma_f32_16x16x32_bf16 v[60:63], v[108:111], a[20:23], v[60:63]
    ds_read_b64_tr_b16 v[142:143], v19 offset:26624
    s_waitcnt lgkmcnt(12)
    v_mfma_f32_16x16x32_bf16 v[64:67], v[112:115], a[16:19], v[64:67]
    ds_read_b64_tr_b16 v[144:145], v20 offset:24576
    v_mfma_f32_16x16x32_bf16 v[68:71], v[112:115], a[20:23], v[68:71]
    ds_read_b64_tr_b16 v[146:147], v20 offset:26624
    buffer_load_dwordx4 a[76:79], v4, s[28:31], s40 offen offset:2304
    v_mfma_f32_16x16x32_bf16 v[72:75], v[116:119], a[16:19], v[72:75]
    ds_read_b64_tr_b16 v[148:149], v21 offset:24576
    v_mfma_f32_16x16x32_bf16 v[76:79], v[116:119], a[20:23], v[76:79]
    ds_read_b64_tr_b16 v[150:151], v21 offset:26624
    s_waitcnt lgkmcnt(12)
    v_mfma_f32_16x16x32_bf16 v[80:83], v[120:123], a[16:19], v[80:83]
    ds_read_b64_tr_b16 v[152:153], v22 offset:24576
    v_mfma_f32_16x16x32_bf16 v[84:87], v[120:123], a[20:23], v[84:87]
    ds_read_b64_tr_b16 v[154:155], v22 offset:26624
    buffer_load_dwordx4 v243, s[56:59], s60 offen offset:3072 lds
    v_mfma_f32_16x16x32_bf16 v[88:91], v[124:127], a[16:19], v[88:91]
    ds_read_b64_tr_b16 v[156:157], v23 offset:24576
    v_mfma_f32_16x16x32_bf16 v[92:95], v[124:127], a[20:23], v[92:95]
    ds_read_b64_tr_b16 v[158:159], v23 offset:26624
    s_waitcnt vmcnt(25) lgkmcnt(12)
    v_mfma_f32_16x16x32_bf16 v[32:35], v[128:131], a[24:27], v[32:35]
    s_waitcnt vmcnt(16)
    s_barrier
    ds_read_b64_tr_b16 v[96:97], v16 offset:32768
    s_add_u32 s40, s40, 4096
    v_mfma_f32_16x16x32_bf16 v[36:39], v[128:131], a[28:31], v[36:39]
    ds_read_b64_tr_b16 v[98:99], v16 offset:34816
    buffer_load_dwordx4 a[80:83], v4, s[28:31], s40 offen offset:0
    v_mfma_f32_16x16x32_bf16 v[40:43], v[132:135], a[24:27], v[40:43]
    ds_read_b64_tr_b16 v[100:101], v17 offset:32768
    v_mfma_f32_16x16x32_bf16 v[44:47], v[132:135], a[28:31], v[44:47]
    ds_read_b64_tr_b16 v[102:103], v17 offset:34816
    s_add_u32 m0, s61, 98304
    s_waitcnt lgkmcnt(12)
    v_mfma_f32_16x16x32_bf16 v[48:51], v[136:139], a[24:27], v[48:51]
    ds_read_b64_tr_b16 v[104:105], v18 offset:32768
    s_add_u32 s60, s60, 229376
    v_mfma_f32_16x16x32_bf16 v[52:55], v[136:139], a[28:31], v[52:55]
    ds_read_b64_tr_b16 v[106:107], v18 offset:34816
    buffer_load_dwordx4 v240, s[56:59], s60 offen offset:0 lds
    v_mfma_f32_16x16x32_bf16 v[56:59], v[140:143], a[24:27], v[56:59]
    ds_read_b64_tr_b16 v[108:109], v19 offset:32768
    v_mfma_f32_16x16x32_bf16 v[60:63], v[140:143], a[28:31], v[60:63]
    ds_read_b64_tr_b16 v[110:111], v19 offset:34816
    s_waitcnt lgkmcnt(12)
    v_mfma_f32_16x16x32_bf16 v[64:67], v[144:147], a[24:27], v[64:67]
    ds_read_b64_tr_b16 v[112:113], v20 offset:32768
    v_mfma_f32_16x16x32_bf16 v[68:71], v[144:147], a[28:31], v[68:71]
    ds_read_b64_tr_b16 v[114:115], v20 offset:34816
    buffer_load_dwordx4 a[84:87], v4, s[28:31], s40 offen offset:256
    v_mfma_f32_16x16x32_bf16 v[72:75], v[148:151], a[24:27], v[72:75]
    ds_read_b64_tr_b16 v[116:117], v21 offset:32768
    v_mfma_f32_16x16x32_bf16 v[76:79], v[148:151], a[28:31], v[76:79]
    ds_read_b64_tr_b16 v[118:119], v21 offset:34816
    s_waitcnt lgkmcnt(12)
    v_mfma_f32_16x16x32_bf16 v[80:83], v[152:155], a[24:27], v[80:83]
    ds_read_b64_tr_b16 v[120:121], v22 offset:32768
    v_mfma_f32_16x16x32_bf16 v[84:87], v[152:155], a[28:31], v[84:87]
    ds_read_b64_tr_b16 v[122:123], v22 offset:34816
    buffer_load_dwordx4 v241, s[56:59], s60 offen offset:1024 lds
    v_mfma_f32_16x16x32_bf16 v[88:91], v[156:159], a[24:27], v[88:91]
    ds_read_b64_tr_b16 v[124:125], v23 offset:32768
    v_mfma_f32_16x16x32_bf16 v[92:95], v[156:159], a[28:31], v[92:95]
    ds_read_b64_tr_b16 v[126:127], v23 offset:34816
    s_waitcnt lgkmcnt(12)
    v_mfma_f32_16x16x32_bf16 v[32:35], v[96:99], a[32:35], v[32:35]
    ds_read_b64_tr_b16 v[128:129], v16 offset:40960
    v_mfma_f32_16x16x32_bf16 v[36:39], v[96:99], a[36:39], v[36:39]
    ds_read_b64_tr_b16 v[130:131], v16 offset:43008
    buffer_load_dwordx4 a[88:91], v4, s[28:31], s40 offen offset:2048
    v_mfma_f32_16x16x32_bf16 v[40:43], v[100:103], a[32:35], v[40:43]
    ds_read_b64_tr_b16 v[132:133], v17 offset:40960
    v_mfma_f32_16x16x32_bf16 v[44:47], v[100:103], a[36:39], v[44:47]
    ds_read_b64_tr_b16 v[134:135], v17 offset:43008
    s_waitcnt lgkmcnt(12)
    v_mfma_f32_16x16x32_bf16 v[48:51], v[104:107], a[32:35], v[48:51]
    ds_read_b64_tr_b16 v[136:137], v18 offset:40960
    v_mfma_f32_16x16x32_bf16 v[52:55], v[104:107], a[36:39], v[52:55]
    ds_read_b64_tr_b16 v[138:139], v18 offset:43008
    buffer_load_dwordx4 v242, s[56:59], s60 offen offset:2048 lds
    v_mfma_f32_16x16x32_bf16 v[56:59], v[108:111], a[32:35], v[56:59]
    ds_read_b64_tr_b16 v[140:141], v19 offset:40960
    v_mfma_f32_16x16x32_bf16 v[60:63], v[108:111], a[36:39], v[60:63]
    ds_read_b64_tr_b16 v[142:143], v19 offset:43008
    s_waitcnt lgkmcnt(12)
    v_mfma_f32_16x16x32_bf16 v[64:67], v[112:115], a[32:35], v[64:67]
    ds_read_b64_tr_b16 v[144:145], v20 offset:40960
    v_mfma_f32_16x16x32_bf16 v[68:71], v[112:115], a[36:39], v[68:71]
    ds_read_b64_tr_b16 v[146:147], v20 offset:43008
    buffer_load_dwordx4 a[92:95], v4, s[28:31], s40 offen offset:2304
    v_mfma_f32_16x16x32_bf16 v[72:75], v[116:119], a[32:35], v[72:75]
    ds_read_b64_tr_b16 v[148:149], v21 offset:40960
    v_mfma_f32_16x16x32_bf16 v[76:79], v[116:119], a[36:39], v[76:79]
    ds_read_b64_tr_b16 v[150:151], v21 offset:43008
    s_waitcnt lgkmcnt(12)
    v_mfma_f32_16x16x32_bf16 v[80:83], v[120:123], a[32:35], v[80:83]
    ds_read_b64_tr_b16 v[152:153], v22 offset:40960
    v_mfma_f32_16x16x32_bf16 v[84:87], v[120:123], a[36:39], v[84:87]
    ds_read_b64_tr_b16 v[154:155], v22 offset:43008
    buffer_load_dwordx4 v243, s[56:59], s60 offen offset:3072 lds
    v_mfma_f32_16x16x32_bf16 v[88:91], v[124:127], a[32:35], v[88:91]
    ds_read_b64_tr_b16 v[156:157], v23 offset:40960
    v_mfma_f32_16x16x32_bf16 v[92:95], v[124:127], a[36:39], v[92:95]
    ds_read_b64_tr_b16 v[158:159], v23 offset:43008
    s_waitcnt lgkmcnt(12)
    v_mfma_f32_16x16x32_bf16 v[32:35], v[128:131], a[40:43], v[32:35]
    ds_read_b64_tr_b16 v[96:97], v16 offset:49152
    s_add_u32 s40, s40, 4096
    v_mfma_f32_16x16x32_bf16 v[36:39], v[128:131], a[44:47], v[36:39]
    ds_read_b64_tr_b16 v[98:99], v16 offset:51200
    buffer_load_dwordx4 a[96:99], v4, s[28:31], s40 offen offset:0
    v_mfma_f32_16x16x32_bf16 v[40:43], v[132:135], a[40:43], v[40:43]
    ds_read_b64_tr_b16 v[100:101], v17 offset:49152
    v_mfma_f32_16x16x32_bf16 v[44:47], v[132:135], a[44:47], v[44:47]
    ds_read_b64_tr_b16 v[102:103], v17 offset:51200
    s_add_u32 m0, s61, 102400
    s_waitcnt lgkmcnt(12)
    v_mfma_f32_16x16x32_bf16 v[48:51], v[136:139], a[40:43], v[48:51]
    ds_read_b64_tr_b16 v[104:105], v18 offset:49152
    s_add_u32 s60, s60, 32768
    v_mfma_f32_16x16x32_bf16 v[52:55], v[136:139], a[44:47], v[52:55]
    ds_read_b64_tr_b16 v[106:107], v18 offset:51200
    buffer_load_dwordx4 v240, s[56:59], s60 offen offset:0 lds
    v_mfma_f32_16x16x32_bf16 v[56:59], v[140:143], a[40:43], v[56:59]
    ds_read_b64_tr_b16 v[108:109], v19 offset:49152
    v_mfma_f32_16x16x32_bf16 v[60:63], v[140:143], a[44:47], v[60:63]
    ds_read_b64_tr_b16 v[110:111], v19 offset:51200
    s_waitcnt lgkmcnt(12)
    v_mfma_f32_16x16x32_bf16 v[64:67], v[144:147], a[40:43], v[64:67]
    ds_read_b64_tr_b16 v[112:113], v20 offset:49152
    v_mfma_f32_16x16x32_bf16 v[68:71], v[144:147], a[44:47], v[68:71]
    ds_read_b64_tr_b16 v[114:115], v20 offset:51200
    buffer_load_dwordx4 a[100:103], v4, s[28:31], s40 offen offset:256
    v_mfma_f32_16x16x32_bf16 v[72:75], v[148:151], a[40:43], v[72:75]
    ds_read_b64_tr_b16 v[116:117], v21 offset:49152
    v_mfma_f32_16x16x32_bf16 v[76:79], v[148:151], a[44:47], v[76:79]
    ds_read_b64_tr_b16 v[118:119], v21 offset:51200
    s_waitcnt lgkmcnt(12)
    v_mfma_f32_16x16x32_bf16 v[80:83], v[152:155], a[40:43], v[80:83]
    ds_read_b64_tr_b16 v[120:121], v22 offset:49152
    v_mfma_f32_16x16x32_bf16 v[84:87], v[152:155], a[44:47], v[84:87]
    ds_read_b64_tr_b16 v[122:123], v22 offset:51200
    buffer_load_dwordx4 v241, s[56:59], s60 offen offset:1024 lds
    v_mfma_f32_16x16x32_bf16 v[88:91], v[156:159], a[40:43], v[88:91]
    ds_read_b64_tr_b16 v[124:125], v23 offset:49152
    v_mfma_f32_16x16x32_bf16 v[92:95], v[156:159], a[44:47], v[92:95]
    ds_read_b64_tr_b16 v[126:127], v23 offset:51200
    s_waitcnt vmcnt(25) lgkmcnt(12)
    v_mfma_f32_16x16x32_bf16 v[32:35], v[96:99], a[48:51], v[32:35]
    ds_read_b64_tr_b16 v[128:129], v16 offset:57344
    v_mfma_f32_16x16x32_bf16 v[36:39], v[96:99], a[52:55], v[36:39]
    ds_read_b64_tr_b16 v[130:131], v16 offset:59392
    buffer_load_dwordx4 a[104:107], v4, s[28:31], s40 offen offset:2048
    v_mfma_f32_16x16x32_bf16 v[40:43], v[100:103], a[48:51], v[40:43]
    ds_read_b64_tr_b16 v[132:133], v17 offset:57344
    v_mfma_f32_16x16x32_bf16 v[44:47], v[100:103], a[52:55], v[44:47]
    ds_read_b64_tr_b16 v[134:135], v17 offset:59392
    s_waitcnt lgkmcnt(12)
    v_mfma_f32_16x16x32_bf16 v[48:51], v[104:107], a[48:51], v[48:51]
    ds_read_b64_tr_b16 v[136:137], v18 offset:57344
    v_mfma_f32_16x16x32_bf16 v[52:55], v[104:107], a[52:55], v[52:55]
    ds_read_b64_tr_b16 v[138:139], v18 offset:59392
    buffer_load_dwordx4 v242, s[56:59], s60 offen offset:2048 lds
    v_mfma_f32_16x16x32_bf16 v[56:59], v[108:111], a[48:51], v[56:59]
    ds_read_b64_tr_b16 v[140:141], v19 offset:57344
    v_mfma_f32_16x16x32_bf16 v[60:63], v[108:111], a[52:55], v[60:63]
    ds_read_b64_tr_b16 v[142:143], v19 offset:59392
    s_waitcnt lgkmcnt(12)
    v_mfma_f32_16x16x32_bf16 v[64:67], v[112:115], a[48:51], v[64:67]
    ds_read_b64_tr_b16 v[144:145], v20 offset:57344
    v_mfma_f32_16x16x32_bf16 v[68:71], v[112:115], a[52:55], v[68:71]
    ds_read_b64_tr_b16 v[146:147], v20 offset:59392
    buffer_load_dwordx4 a[108:111], v4, s[28:31], s40 offen offset:2304
    v_mfma_f32_16x16x32_bf16 v[72:75], v[116:119], a[48:51], v[72:75]
    ds_read_b64_tr_b16 v[148:149], v21 offset:57344
    v_mfma_f32_16x16x32_bf16 v[76:79], v[116:119], a[52:55], v[76:79]
    ds_read_b64_tr_b16 v[150:151], v21 offset:59392
    s_waitcnt lgkmcnt(12)
    v_mfma_f32_16x16x32_bf16 v[80:83], v[120:123], a[48:51], v[80:83]
    ds_read_b64_tr_b16 v[152:153], v22 offset:57344
    v_mfma_f32_16x16x32_bf16 v[84:87], v[120:123], a[52:55], v[84:87]
    ds_read_b64_tr_b16 v[154:155], v22 offset:59392
    buffer_load_dwordx4 v243, s[56:59], s60 offen offset:3072 lds
    v_mfma_f32_16x16x32_bf16 v[88:91], v[124:127], a[48:51], v[88:91]
    ds_read_b64_tr_b16 v[156:157], v23 offset:57344
    v_mfma_f32_16x16x32_bf16 v[92:95], v[124:127], a[52:55], v[92:95]
    ds_read_b64_tr_b16 v[158:159], v23 offset:59392
    s_waitcnt vmcnt(25) lgkmcnt(12)
    v_mfma_f32_16x16x32_bf16 v[32:35], v[128:131], a[56:59], v[32:35]
    s_waitcnt vmcnt(16)
    s_barrier
    ds_read_b64_tr_b16 v[96:97], v24 offset:0
    s_add_u32 s40, s40, 4096
    v_mfma_f32_16x16x32_bf16 v[36:39], v[128:131], a[60:63], v[36:39]
    ds_read_b64_tr_b16 v[98:99], v24 offset:2048
    buffer_load_dwordx4 a[112:115], v4, s[28:31], s40 offen offset:0
    v_mfma_f32_16x16x32_bf16 v[40:43], v[132:135], a[56:59], v[40:43]
    ds_read_b64_tr_b16 v[100:101], v25 offset:0
    v_mfma_f32_16x16x32_bf16 v[44:47], v[132:135], a[60:63], v[44:47]
    ds_read_b64_tr_b16 v[102:103], v25 offset:2048
    s_add_u32 m0, s61, 0
    s_waitcnt lgkmcnt(12)
    v_mfma_f32_16x16x32_bf16 v[48:51], v[136:139], a[56:59], v[48:51]
    ds_read_b64_tr_b16 v[104:105], v26 offset:0
    s_add_u32 s60, s60, 229376
    v_mfma_f32_16x16x32_bf16 v[52:55], v[136:139], a[60:63], v[52:55]
    ds_read_b64_tr_b16 v[106:107], v26 offset:2048
    buffer_load_dwordx4 v240, s[56:59], s60 offen offset:0 lds
    v_mfma_f32_16x16x32_bf16 v[56:59], v[140:143], a[56:59], v[56:59]
    ds_read_b64_tr_b16 v[108:109], v27 offset:0
    v_mfma_f32_16x16x32_bf16 v[60:63], v[140:143], a[60:63], v[60:63]
    ds_read_b64_tr_b16 v[110:111], v27 offset:2048
    s_waitcnt lgkmcnt(12)
    v_mfma_f32_16x16x32_bf16 v[64:67], v[144:147], a[56:59], v[64:67]
    ds_read_b64_tr_b16 v[112:113], v28 offset:0
    v_mfma_f32_16x16x32_bf16 v[68:71], v[144:147], a[60:63], v[68:71]
    ds_read_b64_tr_b16 v[114:115], v28 offset:2048
    buffer_load_dwordx4 a[116:119], v4, s[28:31], s40 offen offset:256
    v_mfma_f32_16x16x32_bf16 v[72:75], v[148:151], a[56:59], v[72:75]
    ds_read_b64_tr_b16 v[116:117], v29 offset:0
    v_mfma_f32_16x16x32_bf16 v[76:79], v[148:151], a[60:63], v[76:79]
    ds_read_b64_tr_b16 v[118:119], v29 offset:2048
    s_waitcnt lgkmcnt(12)
    v_mfma_f32_16x16x32_bf16 v[80:83], v[152:155], a[56:59], v[80:83]
    ds_read_b64_tr_b16 v[120:121], v30 offset:0
    v_mfma_f32_16x16x32_bf16 v[84:87], v[152:155], a[60:63], v[84:87]
    ds_read_b64_tr_b16 v[122:123], v30 offset:2048
    buffer_load_dwordx4 v241, s[56:59], s60 offen offset:1024 lds
    v_mfma_f32_16x16x32_bf16 v[88:91], v[156:159], a[56:59], v[88:91]
    ds_read_b64_tr_b16 v[124:125], v31 offset:0
    v_mfma_f32_16x16x32_bf16 v[92:95], v[156:159], a[60:63], v[92:95]
    ds_read_b64_tr_b16 v[126:127], v31 offset:2048
    s_sub_u32 s44, s44, 1
    s_cmp_lg_u32 s44, 0
    s_cbranch_scc1 L_k4_glu_kernel_main_5
    s_waitcnt lgkmcnt(12)
    v_mfma_f32_16x16x32_bf16 v[32:35], v[96:99], a[64:67], v[32:35]
    ds_read_b64_tr_b16 v[128:129], v24 offset:8192
    v_mfma_f32_16x16x32_bf16 v[36:39], v[96:99], a[68:71], v[36:39]
    ds_read_b64_tr_b16 v[130:131], v24 offset:10240
    buffer_load_dwordx4 a[120:123], v4, s[28:31], s40 offen offset:2048
    v_mfma_f32_16x16x32_bf16 v[40:43], v[100:103], a[64:67], v[40:43]
    ds_read_b64_tr_b16 v[132:133], v25 offset:8192
    v_mfma_f32_16x16x32_bf16 v[44:47], v[100:103], a[68:71], v[44:47]
    ds_read_b64_tr_b16 v[134:135], v25 offset:10240
    s_waitcnt lgkmcnt(12)
    v_mfma_f32_16x16x32_bf16 v[48:51], v[104:107], a[64:67], v[48:51]
    ds_read_b64_tr_b16 v[136:137], v26 offset:8192
    v_mfma_f32_16x16x32_bf16 v[52:55], v[104:107], a[68:71], v[52:55]
    ds_read_b64_tr_b16 v[138:139], v26 offset:10240
    buffer_load_dwordx4 v242, s[56:59], s60 offen offset:2048 lds
    v_mfma_f32_16x16x32_bf16 v[56:59], v[108:111], a[64:67], v[56:59]
    ds_read_b64_tr_b16 v[140:141], v27 offset:8192
    v_mfma_f32_16x16x32_bf16 v[60:63], v[108:111], a[68:71], v[60:63]
    ds_read_b64_tr_b16 v[142:143], v27 offset:10240
    s_waitcnt lgkmcnt(12)
    v_mfma_f32_16x16x32_bf16 v[64:67], v[112:115], a[64:67], v[64:67]
    ds_read_b64_tr_b16 v[144:145], v28 offset:8192
    v_mfma_f32_16x16x32_bf16 v[68:71], v[112:115], a[68:71], v[68:71]
    ds_read_b64_tr_b16 v[146:147], v28 offset:10240
    buffer_load_dwordx4 a[124:127], v4, s[28:31], s40 offen offset:2304
    v_mfma_f32_16x16x32_bf16 v[72:75], v[116:119], a[64:67], v[72:75]
    ds_read_b64_tr_b16 v[148:149], v29 offset:8192
    v_mfma_f32_16x16x32_bf16 v[76:79], v[116:119], a[68:71], v[76:79]
    ds_read_b64_tr_b16 v[150:151], v29 offset:10240
    s_waitcnt lgkmcnt(12)
    v_mfma_f32_16x16x32_bf16 v[80:83], v[120:123], a[64:67], v[80:83]
    ds_read_b64_tr_b16 v[152:153], v30 offset:8192
    v_mfma_f32_16x16x32_bf16 v[84:87], v[120:123], a[68:71], v[84:87]
    ds_read_b64_tr_b16 v[154:155], v30 offset:10240
    buffer_load_dwordx4 v243, s[56:59], s60 offen offset:3072 lds
    v_mfma_f32_16x16x32_bf16 v[88:91], v[124:127], a[64:67], v[88:91]
    ds_read_b64_tr_b16 v[156:157], v31 offset:8192
    v_mfma_f32_16x16x32_bf16 v[92:95], v[124:127], a[68:71], v[92:95]
    ds_read_b64_tr_b16 v[158:159], v31 offset:10240
    s_waitcnt lgkmcnt(12)
    v_mfma_f32_16x16x32_bf16 v[32:35], v[128:131], a[72:75], v[32:35]
    ds_read_b64_tr_b16 v[96:97], v24 offset:16384
    s_add_u32 s40, s40, 4096
    v_mfma_f32_16x16x32_bf16 v[36:39], v[128:131], a[76:79], v[36:39]
    ds_read_b64_tr_b16 v[98:99], v24 offset:18432
    buffer_load_dwordx4 a[0:3], v4, s[28:31], s40 offen offset:0
    v_mfma_f32_16x16x32_bf16 v[40:43], v[132:135], a[72:75], v[40:43]
    ds_read_b64_tr_b16 v[100:101], v25 offset:16384
    v_mfma_f32_16x16x32_bf16 v[44:47], v[132:135], a[76:79], v[44:47]
    ds_read_b64_tr_b16 v[102:103], v25 offset:18432
    s_add_u32 m0, s61, 4096
    s_waitcnt lgkmcnt(12)
    v_mfma_f32_16x16x32_bf16 v[48:51], v[136:139], a[72:75], v[48:51]
    ds_read_b64_tr_b16 v[104:105], v26 offset:16384
    s_add_u32 s60, s60, 32768
    v_mfma_f32_16x16x32_bf16 v[52:55], v[136:139], a[76:79], v[52:55]
    ds_read_b64_tr_b16 v[106:107], v26 offset:18432
    buffer_load_dwordx4 v240, s[56:59], s60 offen offset:0 lds
    v_mfma_f32_16x16x32_bf16 v[56:59], v[140:143], a[72:75], v[56:59]
    ds_read_b64_tr_b16 v[108:109], v27 offset:16384
    v_lshlrev_b32 v11, 2, v1
    s_lshl_b32 s18, s15, 8
    s_lshl_b32 s17, s3, 8
    s_add_u32 s17, s17, 149504
    v_add_u32 v12, s17, v11
    v_lshrrev_b32 v13, 4, v1
    v_lshl_add_u32 v13, v13, 4, s17
    s_add_u32 s17, s18, 20480
    buffer_load_dword v160, v11, s[36:39], s17 offen
    s_add_u32 s17, s18, 45056
    buffer_load_dword v161, v11, s[36:39], s17 offen
    s_add_u32 s17, s18, 69632
    buffer_load_dword v162, v11, s[36:39], s17 offen
    s_add_u32 s17, s18, 94208
    buffer_load_dword v163, v11, s[36:39], s17 offen
    v_mfma_f32_16x16x32_bf16 v[60:63], v[140:143], a[76:79], v[60:63]
    ds_read_b64_tr_b16 v[110:111], v27 offset:18432
    s_waitcnt lgkmcnt(12)
    v_mfma_f32_16x16x32_bf16 v[64:67], v[144:147], a[72:75], v[64:67]
    ds_read_b64_tr_b16 v[112:113], v28 offset:16384
    v_mfma_f32_16x16x32_bf16 v[68:71], v[144:147], a[76:79], v[68:71]
    ds_read_b64_tr_b16 v[114:115], v28 offset:18432
    buffer_load_dwordx4 a[4:7], v4, s[28:31], s40 offen offset:256
    v_mfma_f32_16x16x32_bf16 v[72:75], v[148:151], a[72:75], v[72:75]
    ds_read_b64_tr_b16 v[116:117], v29 offset:16384
    v_mfma_f32_16x16x32_bf16 v[76:79], v[148:151], a[76:79], v[76:79]
    ds_read_b64_tr_b16 v[118:119], v29 offset:18432
    s_waitcnt lgkmcnt(12)
    v_mfma_f32_16x16x32_bf16 v[80:83], v[152:155], a[72:75], v[80:83]
    ds_read_b64_tr_b16 v[120:121], v30 offset:16384
    v_mfma_f32_16x16x32_bf16 v[84:87], v[152:155], a[76:79], v[84:87]
    ds_read_b64_tr_b16 v[122:123], v30 offset:18432
    buffer_load_dwordx4 v241, s[56:59], s60 offen offset:1024 lds
    v_mfma_f32_16x16x32_bf16 v[88:91], v[156:159], a[72:75], v[88:91]
    ds_read_b64_tr_b16 v[124:125], v31 offset:16384
    v_mfma_f32_16x16x32_bf16 v[92:95], v[156:159], a[76:79], v[92:95]
    ds_read_b64_tr_b16 v[126:127], v31 offset:18432
    s_waitcnt vmcnt(29)
    s_waitcnt lgkmcnt(12)
    v_mfma_f32_16x16x32_bf16 v[32:35], v[96:99], a[80:83], v[32:35]
    ds_read_b64_tr_b16 v[128:129], v24 offset:24576
    v_mfma_f32_16x16x32_bf16 v[36:39], v[96:99], a[84:87], v[36:39]
    ds_read_b64_tr_b16 v[130:131], v24 offset:26624
    buffer_load_dwordx4 a[8:11], v4, s[28:31], s40 offen offset:2048
    v_mfma_f32_16x16x32_bf16 v[40:43], v[100:103], a[80:83], v[40:43]
    ds_read_b64_tr_b16 v[132:133], v25 offset:24576
    v_mfma_f32_16x16x32_bf16 v[44:47], v[100:103], a[84:87], v[44:47]
    ds_read_b64_tr_b16 v[134:135], v25 offset:26624
    s_waitcnt lgkmcnt(12)
    v_mfma_f32_16x16x32_bf16 v[48:51], v[104:107], a[80:83], v[48:51]
    ds_read_b64_tr_b16 v[136:137], v26 offset:24576
    v_mfma_f32_16x16x32_bf16 v[52:55], v[104:107], a[84:87], v[52:55]
    ds_read_b64_tr_b16 v[138:139], v26 offset:26624
    buffer_load_dwordx4 v242, s[56:59], s60 offen offset:2048 lds
    v_mfma_f32_16x16x32_bf16 v[56:59], v[108:111], a[80:83], v[56:59]
    ds_read_b64_tr_b16 v[140:141], v27 offset:24576
    s_mul_i32 s16, s3, 4608
    s_add_u32 s16, s16, 131072
    v_mul_u32_u24 v14, 144, v3
    v_lshrrev_b32 v15, 4, v1
    v_lshl_add_u32 v14, v15, 3, v14
    v_add_u32 v14, s16, v14
    v_lshrrev_b32 v10, 3, v1
    v_mul_u32_u24 v15, 144, v10
    v_and_b32 v9, 7, v1
    v_lshl_add_u32 v15, v9, 4, v15
    v_add_u32 v15, s16, v15
    v_lshlrev_b32 v10, 11, v10
    v_lshl_add_u32 v10, v9, 4, v10
    s_lshl_b32 s16, s43, 16
    s_lshl_b32 s17, s15, 7
    s_add_u32 s16, s16, s17
    v_lshlrev_b32 v9, 4, v1
    s_lshl_b32 s46, s2, 14
    s_lshl_b32 s17, s3, 12
    s_add_u32 s46, s46, s17
    s_xor_b32 s47, s46, 16384
    s_mov_b32 s45, 0
    v_mfma_f32_16x16x32_bf16 v[60:63], v[108:111], a[84:87], v[60:63]
    ds_read_b64_tr_b16 v[142:143], v27 offset:26624
    s_waitcnt lgkmcnt(12)
    v_mfma_f32_16x16x32_bf16 v[64:67], v[112:115], a[80:83], v[64:67]
    ds_read_b64_tr_b16 v[144:145], v28 offset:24576
    v_mfma_f32_16x16x32_bf16 v[68:71], v[112:115], a[84:87], v[68:71]
    ds_read_b64_tr_b16 v[146:147], v28 offset:26624
    buffer_load_dwordx4 a[12:15], v4, s[28:31], s40 offen offset:2304
    v_mfma_f32_16x16x32_bf16 v[72:75], v[116:119], a[80:83], v[72:75]
    ds_read_b64_tr_b16 v[148:149], v29 offset:24576
    v_mfma_f32_16x16x32_bf16 v[76:79], v[116:119], a[84:87], v[76:79]
    ds_read_b64_tr_b16 v[150:151], v29 offset:26624
    s_waitcnt lgkmcnt(12)
    v_mfma_f32_16x16x32_bf16 v[80:83], v[120:123], a[80:83], v[80:83]
    ds_read_b64_tr_b16 v[152:153], v30 offset:24576
    v_mfma_f32_16x16x32_bf16 v[84:87], v[120:123], a[84:87], v[84:87]
    ds_read_b64_tr_b16 v[154:155], v30 offset:26624
    buffer_load_dwordx4 v243, s[56:59], s60 offen offset:3072 lds
    v_mfma_f32_16x16x32_bf16 v[88:91], v[124:127], a[80:83], v[88:91]
    ds_read_b64_tr_b16 v[156:157], v31 offset:24576
    v_mfma_f32_16x16x32_bf16 v[92:95], v[124:127], a[84:87], v[92:95]
    ds_read_b64_tr_b16 v[158:159], v31 offset:26624
    s_waitcnt vmcnt(29)
    s_waitcnt lgkmcnt(12)
    v_mfma_f32_16x16x32_bf16 v[32:35], v[128:131], a[88:91], v[32:35]
    s_waitcnt vmcnt(20)
    s_barrier
    ds_read_b64_tr_b16 v[96:97], v28 offset:32768
    s_add_u32 s40, s40, 4096
    v_mfma_f32_16x16x32_bf16 v[36:39], v[128:131], a[92:95], v[36:39]
    buffer_load_dwordx4 a[16:19], v4, s[28:31], s40 offen offset:0
    v_mfma_f32_16x16x32_bf16 v[40:43], v[132:135], a[88:91], v[40:43]
    ds_read_b64_tr_b16 v[98:99], v28 offset:34816
    v_mfma_f32_16x16x32_bf16 v[44:47], v[132:135], a[92:95], v[44:47]
    s_add_u32 m0, s61, 32768
    s_waitcnt lgkmcnt(10)
    v_mfma_f32_16x16x32_bf16 v[48:51], v[136:139], a[88:91], v[48:51]
    ds_read_b64_tr_b16 v[100:101], v29 offset:32768
    s_add_u32 s60, s60, 229376
    v_mfma_f32_16x16x32_bf16 v[52:55], v[136:139], a[92:95], v[52:55]
    buffer_load_dwordx4 v240, s[56:59], s60 offen offset:0 lds
    v_mfma_f32_16x16x32_bf16 v[56:59], v[140:143], a[88:91], v[56:59]
    ds_read_b64_tr_b16 v[102:103], v29 offset:34816
    s_lshl_b32 s19, s43, 16
    s_lshl_b32 s17, s15, 12
    s_add_u32 s19, s19, s17
    buffer_load_dwordx2 v[176:177], v2, s[20:23], s19 offen offset:0
    buffer_load_dwordx2 v[178:179], v2, s[20:23], s19 offen offset:256
    buffer_load_dwordx2 v[180:181], v2, s[20:23], s19 offen offset:1024
    buffer_load_dwordx2 v[182:183], v2, s[20:23], s19 offen offset:1280
    buffer_load_dwordx2 v[184:185], v2, s[20:23], s19 offen offset:2048
    buffer_load_dwordx2 v[186:187], v2, s[20:23], s19 offen offset:2304
    buffer_load_dwordx2 v[188:189], v2, s[20:23], s19 offen offset:3072
    buffer_load_dwordx2 v[190:191], v2, s[20:23], s19 offen offset:3328
    v_mfma_f32_16x16x32_bf16 v[60:63], v[140:143], a[92:95], v[60:63]
    s_waitcnt lgkmcnt(8)
    v_mfma_f32_16x16x32_bf16 v[64:67], v[144:147], a[88:91], v[64:67]
    ds_read_b64_tr_b16 v[104:105], v30 offset:32768
    v_mfma_f32_16x16x32_bf16 v[68:71], v[144:147], a[92:95], v[68:71]
    buffer_load_dwordx4 a[20:23], v4, s[28:31], s40 offen offset:256
    v_mfma_f32_16x16x32_bf16 v[72:75], v[148:151], a[88:91], v[72:75]
    ds_read_b64_tr_b16 v[106:107], v30 offset:34816
    v_mfma_f32_16x16x32_bf16 v[76:79], v[148:151], a[92:95], v[76:79]
    s_waitcnt lgkmcnt(6)
    v_mfma_f32_16x16x32_bf16 v[80:83], v[152:155], a[88:91], v[80:83]
    ds_read_b64_tr_b16 v[108:109], v31 offset:32768
    v_mfma_f32_16x16x32_bf16 v[84:87], v[152:155], a[92:95], v[84:87]
    buffer_load_dwordx4 v241, s[56:59], s60 offen offset:1024 lds
    v_mfma_f32_16x16x32_bf16 v[88:91], v[156:159], a[88:91], v[88:91]
    ds_read_b64_tr_b16 v[110:111], v31 offset:34816
    v_mfma_f32_16x16x32_bf16 v[92:95], v[156:159], a[92:95], v[92:95]
    s_waitcnt lgkmcnt(4)
    v_mfma_f32_16x16x32_bf16 v[64:67], v[96:99], a[96:99], v[64:67]
    ds_read_b64_tr_b16 v[128:129], v28 offset:40960
    v_mfma_f32_16x16x32_bf16 v[68:71], v[96:99], a[100:103], v[68:71]
    ds_read_b64_tr_b16 v[130:131], v28 offset:43008
    buffer_load_dwordx4 v242, s[56:59], s60 offen offset:2048 lds
    v_mfma_f32_16x16x32_bf16 v[72:75], v[100:103], a[96:99], v[72:75]
    ds_read_b64_tr_b16 v[132:133], v29 offset:40960
    v_mfma_f32_16x16x32_bf16 v[76:79], v[100:103], a[100:103], v[76:79]
    ds_read_b64_tr_b16 v[134:135], v29 offset:43008
    buffer_load_dwordx4 v243, s[56:59], s60 offen offset:3072 lds
    s_waitcnt lgkmcnt(4)
    v_mfma_f32_16x16x32_bf16 v[80:83], v[104:107], a[96:99], v[80:83]
    ds_read_b64_tr_b16 v[136:137], v30 offset:40960
    v_mfma_f32_16x16x32_bf16 v[84:87], v[104:107], a[100:103], v[84:87]
    ds_read_b64_tr_b16 v[138:139], v30 offset:43008
    s_add_u32 m0, s61, 36864
    s_add_u32 s60, s60, 32768
    buffer_load_dwordx4 v240, s[56:59], s60 offen offset:0 lds
    v_mfma_f32_16x16x32_bf16 v[88:91], v[108:111], a[96:99], v[88:91]
    ds_read_b64_tr_b16 v[140:141], v31 offset:40960
    v_mfma_f32_16x16x32_bf16 v[92:95], v[108:111], a[100:103], v[92:95]
    ds_read_b64_tr_b16 v[142:143], v31 offset:43008
    buffer_load_dwordx4 v241, s[56:59], s60 offen offset:1024 lds
    s_waitcnt lgkmcnt(4)
    v_mfma_f32_16x16x32_bf16 v[64:67], v[128:131], a[104:107], v[64:67]
    ds_read_b64_tr_b16 v[96:97], v28 offset:49152
    v_mfma_f32_16x16x32_bf16 v[68:71], v[128:131], a[108:111], v[68:71]
    ds_read_b64_tr_b16 v[98:99], v28 offset:51200
    buffer_load_dwordx4 v242, s[56:59], s60 offen offset:2048 lds
    v_mfma_f32_16x16x32_bf16 v[72:75], v[132:135], a[104:107], v[72:75]
    ds_read_b64_tr_b16 v[100:101], v29 offset:49152
    v_mfma_f32_16x16x32_bf16 v[76:79], v[132:135], a[108:111], v[76:79]
    ds_read_b64_tr_b16 v[102:103], v29 offset:51200
    buffer_load_dwordx4 v243, s[56:59], s60 offen offset:3072 lds
    s_waitcnt lgkmcnt(4)
    v_mfma_f32_16x16x32_bf16 v[80:83], v[136:139], a[104:107], v[80:83]
    ds_read_b64_tr_b16 v[104:105], v30 offset:49152
    v_mfma_f32_16x16x32_bf16 v[84:87], v[136:139], a[108:111], v[84:87]
    ds_read_b64_tr_b16 v[106:107], v30 offset:51200
    buffer_load_dwordx4 a[24:27], v4, s[28:31], s40 offen offset:2048
    v_mfma_f32_16x16x32_bf16 v[88:91], v[140:143], a[104:107], v[88:91]
    ds_read_b64_tr_b16 v[108:109], v31 offset:49152
    s_waitcnt vmcnt(25)
    v_add_f32 v160, v160, v161
    v_add_f32 v162, v162, v163
    v_add_f32 v160, v160, v162
    v_cvt_pk_bf16_f32 v160, v160, v160
    v_lshlrev_b32 v160, 16, v160
    ds_write_b32 v12, v160
    v_mfma_f32_16x16x32_bf16 v[92:95], v[140:143], a[108:111], v[92:95]
    ds_read_b64_tr_b16 v[110:111], v31 offset:51200
    buffer_load_dwordx4 a[28:31], v4, s[28:31], s40 offen offset:2304
    s_waitcnt lgkmcnt(5)
    v_mfma_f32_16x16x32_bf16 v[64:67], v[96:99], a[112:115], v[64:67]
    ds_read_b64_tr_b16 v[128:129], v28 offset:57344
    v_mfma_f32_16x16x32_bf16 v[68:71], v[96:99], a[116:119], v[68:71]
    ds_read_b64_tr_b16 v[130:131], v28 offset:59392
    s_add_u32 s40, s40, 4096
    buffer_load_dwordx4 a[32:35], v4, s[28:31], s40 offen offset:0
    v_mfma_f32_16x16x32_bf16 v[72:75], v[100:103], a[112:115], v[72:75]
    ds_read_b64_tr_b16 v[132:133], v29 offset:57344
    v_mfma_f32_16x16x32_bf16 v[76:79], v[100:103], a[116:119], v[76:79]
    ds_read_b64_tr_b16 v[134:135], v29 offset:59392
    buffer_load_dwordx4 a[36:39], v4, s[28:31], s40 offen offset:256
    s_waitcnt lgkmcnt(4)
    v_mfma_f32_16x16x32_bf16 v[80:83], v[104:107], a[112:115], v[80:83]
    ds_read_b64_tr_b16 v[136:137], v30 offset:57344
    v_mfma_f32_16x16x32_bf16 v[84:87], v[104:107], a[116:119], v[84:87]
    ds_read_b64_tr_b16 v[138:139], v30 offset:59392
    buffer_load_dwordx4 a[40:43], v4, s[28:31], s40 offen offset:2048
    v_mfma_f32_16x16x32_bf16 v[88:91], v[108:111], a[112:115], v[88:91]
    ds_read_b64_tr_b16 v[140:141], v31 offset:57344
    v_mfma_f32_16x16x32_bf16 v[92:95], v[108:111], a[116:119], v[92:95]
    ds_read_b64_tr_b16 v[142:143], v31 offset:59392
    buffer_load_dwordx4 a[44:47], v4, s[28:31], s40 offen offset:2304
    s_waitcnt lgkmcnt(4)
    v_mfma_f32_16x16x32_bf16 v[64:67], v[128:131], a[120:123], v[64:67]
    s_waitcnt vmcnt(24)
    s_barrier
    ds_read_b64_tr_b16 v[96:97], v20 offset:0
    v_mfma_f32_16x16x32_bf16 v[68:71], v[128:131], a[124:127], v[68:71]
    ds_read_b64_tr_b16 v[98:99], v20 offset:2048
    s_add_u32 s40, s40, 4096
    buffer_load_dwordx4 a[48:51], v4, s[28:31], s40 offen offset:0
    v_mfma_f32_16x16x32_bf16 v[72:75], v[132:135], a[120:123], v[72:75]
    ds_read_b64_tr_b16 v[100:101], v21 offset:0
    v_mfma_f32_16x16x32_bf16 v[76:79], v[132:135], a[124:127], v[76:79]
    ds_read_b64_tr_b16 v[102:103], v21 offset:2048
    buffer_load_dwordx4 a[52:55], v4, s[28:31], s40 offen offset:256
    s_waitcnt lgkmcnt(4)
    v_mfma_f32_16x16x32_bf16 v[80:83], v[136:139], a[120:123], v[80:83]
    ds_read_b64_tr_b16 v[104:105], v22 offset:0
    v_mfma_f32_16x16x32_bf16 v[84:87], v[136:139], a[124:127], v[84:87]
    ds_read_b64_tr_b16 v[106:107], v22 offset:2048
    buffer_load_dwordx4 a[56:59], v4, s[28:31], s40 offen offset:2048
    v_mfma_f32_16x16x32_bf16 v[88:91], v[140:143], a[120:123], v[88:91]
    ds_read_b64_tr_b16 v[108:109], v23 offset:0
    ds_read_b128 v[160:163], v13 offset:0
    ds_read_b128 v[164:167], v13 offset:64
    ds_read_b128 v[168:171], v13 offset:128
    ds_read_b128 v[172:175], v13 offset:192
    v_mfma_f32_16x16x32_bf16 v[92:95], v[140:143], a[124:127], v[92:95]
    ds_read_b64_tr_b16 v[110:111], v23 offset:2048
    buffer_load_dwordx4 a[60:63], v4, s[28:31], s40 offen offset:2304
    s_waitcnt lgkmcnt(8)
    v_mfma_f32_16x16x32_bf16 v[64:67], v[96:99], a[0:3], v[64:67]
    ds_read_b64_tr_b16 v[128:129], v20 offset:8192
    v_mfma_f32_16x16x32_bf16 v[68:71], v[96:99], a[4:7], v[68:71]
    ds_read_b64_tr_b16 v[130:131], v20 offset:10240
    v_mfma_f32_16x16x32_bf16 v[72:75], v[100:103], a[0:3], v[72:75]
    ds_read_b64_tr_b16 v[132:133], v21 offset:8192
    v_mfma_f32_16x16x32_bf16 v[76:79], v[100:103], a[4:7], v[76:79]
    ds_read_b64_tr_b16 v[134:135], v21 offset:10240
    s_waitcnt lgkmcnt(4)
    v_mfma_f32_16x16x32_bf16 v[80:83], v[104:107], a[0:3], v[80:83]
    ds_read_b64_tr_b16 v[136:137], v22 offset:8192
    v_mfma_f32_16x16x32_bf16 v[84:87], v[104:107], a[4:7], v[84:87]
    ds_read_b64_tr_b16 v[138:139], v22 offset:10240
    v_mfma_f32_16x16x32_bf16 v[88:91], v[108:111], a[0:3], v[88:91]
    ds_read_b64_tr_b16 v[140:141], v23 offset:8192
    v_mfma_f32_16x16x32_bf16 v[92:95], v[108:111], a[4:7], v[92:95]
    ds_read_b64_tr_b16 v[142:143], v23 offset:10240
    s_waitcnt lgkmcnt(4)
    v_mfma_f32_16x16x32_bf16 v[64:67], v[128:131], a[8:11], v[64:67]
    ds_read_b64_tr_b16 v[96:97], v20 offset:16384
    v_mfma_f32_16x16x32_bf16 v[68:71], v[128:131], a[12:15], v[68:71]
    ds_read_b64_tr_b16 v[98:99], v20 offset:18432
    v_mfma_f32_16x16x32_bf16 v[72:75], v[132:135], a[8:11], v[72:75]
    ds_read_b64_tr_b16 v[100:101], v21 offset:16384
    v_mfma_f32_16x16x32_bf16 v[76:79], v[132:135], a[12:15], v[76:79]
    ds_read_b64_tr_b16 v[102:103], v21 offset:18432
    s_waitcnt lgkmcnt(4)
    v_mfma_f32_16x16x32_bf16 v[80:83], v[136:139], a[8:11], v[80:83]
    ds_read_b64_tr_b16 v[104:105], v22 offset:16384
    v_mfma_f32_16x16x32_bf16 v[84:87], v[136:139], a[12:15], v[84:87]
    ds_read_b64_tr_b16 v[106:107], v22 offset:18432
    v_mfma_f32_16x16x32_bf16 v[88:91], v[140:143], a[8:11], v[88:91]
    ds_read_b64_tr_b16 v[108:109], v23 offset:16384
    v_mfma_f32_16x16x32_bf16 v[92:95], v[140:143], a[12:15], v[92:95]
    ds_read_b64_tr_b16 v[110:111], v23 offset:18432
    s_waitcnt vmcnt(17)
    s_waitcnt lgkmcnt(4)
    v_mfma_f32_16x16x32_bf16 v[64:67], v[96:99], a[16:19], v[64:67]
    ds_read_b64_tr_b16 v[128:129], v20 offset:24576
    v_mfma_f32_16x16x32_bf16 v[68:71], v[96:99], a[20:23], v[68:71]
    ds_read_b64_tr_b16 v[130:131], v20 offset:26624
    v_mfma_f32_16x16x32_bf16 v[72:75], v[100:103], a[16:19], v[72:75]
    ds_read_b64_tr_b16 v[132:133], v21 offset:24576
    v_mfma_f32_16x16x32_bf16 v[76:79], v[100:103], a[20:23], v[76:79]
    ds_read_b64_tr_b16 v[134:135], v21 offset:26624
    s_waitcnt lgkmcnt(4)
    v_mfma_f32_16x16x32_bf16 v[80:83], v[104:107], a[16:19], v[80:83]
    ds_read_b64_tr_b16 v[136:137], v22 offset:24576
    v_mfma_f32_16x16x32_bf16 v[84:87], v[104:107], a[20:23], v[84:87]
    ds_read_b64_tr_b16 v[138:139], v22 offset:26624
    v_mfma_f32_16x16x32_bf16 v[88:91], v[108:111], a[16:19], v[88:91]
    ds_read_b64_tr_b16 v[140:141], v23 offset:24576
    v_mfma_f32_16x16x32_bf16 v[92:95], v[108:111], a[20:23], v[92:95]
    ds_read_b64_tr_b16 v[142:143], v23 offset:26624
    s_waitcnt vmcnt(8)
    s_waitcnt lgkmcnt(4)
    v_mfma_f32_16x16x32_bf16 v[64:67], v[128:131], a[24:27], v[64:67]
    s_barrier
    ds_read_b64_tr_b16 v[96:97], v20 offset:32768
    v_mfma_f32_16x16x32_bf16 v[68:71], v[128:131], a[28:31], v[68:71]
    ds_read_b64_tr_b16 v[98:99], v20 offset:34816
    v_mfma_f32_16x16x32_bf16 v[72:75], v[132:135], a[24:27], v[72:75]
    ds_read_b64_tr_b16 v[100:101], v21 offset:32768
    v_mfma_f32_16x16x32_bf16 v[76:79], v[132:135], a[28:31], v[76:79]
    ds_read_b64_tr_b16 v[102:103], v21 offset:34816
    s_waitcnt lgkmcnt(4)
    v_mfma_f32_16x16x32_bf16 v[80:83], v[136:139], a[24:27], v[80:83]
    ds_read_b64_tr_b16 v[104:105], v22 offset:32768
    v_mfma_f32_16x16x32_bf16 v[84:87], v[136:139], a[28:31], v[84:87]
    ds_read_b64_tr_b16 v[106:107], v22 offset:34816
    v_mfma_f32_16x16x32_bf16 v[88:91], v[140:143], a[24:27], v[88:91]
    ds_read_b64_tr_b16 v[108:109], v23 offset:32768
    v_mfma_f32_16x16x32_bf16 v[92:95], v[140:143], a[28:31], v[92:95]
    ds_read_b64_tr_b16 v[110:111], v23 offset:34816
    s_waitcnt vmcnt(6)
    s_waitcnt lgkmcnt(4)
    v_mfma_f32_16x16x32_bf16 v[64:67], v[96:99], a[32:35], v[64:67]
    ds_read_b64_tr_b16 v[128:129], v20 offset:40960
    v_mfma_f32_16x16x32_bf16 v[68:71], v[96:99], a[36:39], v[68:71]
    ds_read_b64_tr_b16 v[130:131], v20 offset:43008
    v_mfma_f32_16x16x32_bf16 v[72:75], v[100:103], a[32:35], v[72:75]
    ds_read_b64_tr_b16 v[132:133], v21 offset:40960
    v_mfma_f32_16x16x32_bf16 v[76:79], v[100:103], a[36:39], v[76:79]
    ds_read_b64_tr_b16 v[134:135], v21 offset:43008
    s_waitcnt lgkmcnt(4)
    v_mfma_f32_16x16x32_bf16 v[80:83], v[104:107], a[32:35], v[80:83]
    ds_read_b64_tr_b16 v[136:137], v22 offset:40960
    v_mfma_f32_16x16x32_bf16 v[84:87], v[104:107], a[36:39], v[84:87]
    ds_read_b64_tr_b16 v[138:139], v22 offset:43008
    v_mfma_f32_16x16x32_bf16 v[88:91], v[108:111], a[32:35], v[88:91]
    ds_read_b64_tr_b16 v[140:141], v23 offset:40960
    v_mfma_f32_16x16x32_bf16 v[92:95], v[108:111], a[36:39], v[92:95]
    ds_read_b64_tr_b16 v[142:143], v23 offset:43008
    s_waitcnt vmcnt(4)
    s_waitcnt lgkmcnt(4)
    v_mfma_f32_16x16x32_bf16 v[64:67], v[128:131], a[40:43], v[64:67]
    ds_read_b64_tr_b16 v[96:97], v20 offset:49152
    v_mfma_f32_16x16x32_bf16 v[68:71], v[128:131], a[44:47], v[68:71]
    ds_read_b64_tr_b16 v[98:99], v20 offset:51200
    v_mfma_f32_16x16x32_bf16 v[72:75], v[132:135], a[40:43], v[72:75]
    ds_read_b64_tr_b16 v[100:101], v21 offset:49152
    v_mfma_f32_16x16x32_bf16 v[76:79], v[132:135], a[44:47], v[76:79]
    ds_read_b64_tr_b16 v[102:103], v21 offset:51200
    s_waitcnt lgkmcnt(4)
    v_mfma_f32_16x16x32_bf16 v[80:83], v[136:139], a[40:43], v[80:83]
    ds_read_b64_tr_b16 v[104:105], v22 offset:49152
    v_mfma_f32_16x16x32_bf16 v[84:87], v[136:139], a[44:47], v[84:87]
    ds_read_b64_tr_b16 v[106:107], v22 offset:51200
    v_mfma_f32_16x16x32_bf16 v[88:91], v[140:143], a[40:43], v[88:91]
    ds_read_b64_tr_b16 v[108:109], v23 offset:49152
    v_mfma_f32_16x16x32_bf16 v[92:95], v[140:143], a[44:47], v[92:95]
    ds_read_b64_tr_b16 v[110:111], v23 offset:51200
    s_waitcnt vmcnt(2)
    s_waitcnt lgkmcnt(4)
    v_mfma_f32_16x16x32_bf16 v[64:67], v[96:99], a[48:51], v[64:67]
    ds_read_b64_tr_b16 v[128:129], v20 offset:57344
    v_mfma_f32_16x16x32_bf16 v[68:71], v[96:99], a[52:55], v[68:71]
    ds_read_b64_tr_b16 v[130:131], v20 offset:59392
    v_mfma_f32_16x16x32_bf16 v[72:75], v[100:103], a[48:51], v[72:75]
    ds_read_b64_tr_b16 v[132:133], v21 offset:57344
    v_mfma_f32_16x16x32_bf16 v[76:79], v[100:103], a[52:55], v[76:79]
    ds_read_b64_tr_b16 v[134:135], v21 offset:59392
    s_waitcnt lgkmcnt(4)
    v_mfma_f32_16x16x32_bf16 v[80:83], v[104:107], a[48:51], v[80:83]
    ds_read_b64_tr_b16 v[136:137], v22 offset:57344
    v_mfma_f32_16x16x32_bf16 v[84:87], v[104:107], a[52:55], v[84:87]
    ds_read_b64_tr_b16 v[138:139], v22 offset:59392
    v_mfma_f32_16x16x32_bf16 v[88:91], v[108:111], a[48:51], v[88:91]
    ds_read_b64_tr_b16 v[140:141], v23 offset:57344
    v_mfma_f32_16x16x32_bf16 v[92:95], v[108:111], a[52:55], v[92:95]
    ds_read_b64_tr_b16 v[142:143], v23 offset:59392
    s_waitcnt vmcnt(0)
    s_waitcnt lgkmcnt(4)
    v_mfma_f32_16x16x32_bf16 v[64:67], v[128:131], a[56:59], v[64:67]
    ds_read_b64_tr_b16 v[96:97], v24 offset:32768
    v_mfma_f32_16x16x32_bf16 v[68:71], v[128:131], a[60:63], v[68:71]
    ds_read_b64_tr_b16 v[98:99], v24 offset:34816
    v_mfma_f32_16x16x32_bf16 v[72:75], v[132:135], a[56:59], v[72:75]
    ds_read_b64_tr_b16 v[100:101], v25 offset:32768
    v_mfma_f32_16x16x32_bf16 v[76:79], v[132:135], a[60:63], v[76:79]
    ds_read_b64_tr_b16 v[102:103], v25 offset:34816
    s_waitcnt lgkmcnt(4)
    v_mfma_f32_16x16x32_bf16 v[80:83], v[136:139], a[56:59], v[80:83]
    ds_read_b64_tr_b16 v[104:105], v26 offset:32768
    v_mfma_f32_16x16x32_bf16 v[84:87], v[136:139], a[60:63], v[84:87]
    ds_read_b64_tr_b16 v[106:107], v26 offset:34816
    v_mfma_f32_16x16x32_bf16 v[88:91], v[140:143], a[56:59], v[88:91]
    ds_read_b64_tr_b16 v[108:109], v27 offset:32768
    v_mfma_f32_16x16x32_bf16 v[92:95], v[140:143], a[60:63], v[92:95]
    ds_read_b64_tr_b16 v[110:111], v27 offset:34816
    s_waitcnt lgkmcnt(4)
    v_mfma_f32_16x16x32_bf16 v[32:35], v[96:99], a[96:99], v[32:35]
    ds_read_b64_tr_b16 v[128:129], v24 offset:40960
    v_cvt_pk_bf16_f32 v224, v64, v65
    v_cvt_pk_bf16_f32 v225, v66, v67
    v_cvt_pk_bf16_f32 v226, v68, v69
    v_cvt_pk_bf16_f32 v227, v70, v71
    buffer_store_dwordx4 v[224:227], v9, s[32:35], s46 offen offset:0 sc1
    v_mfma_f32_16x16x32_bf16 v[36:39], v[96:99], a[100:103], v[36:39]
    ds_read_b64_tr_b16 v[130:131], v24 offset:43008
    v_mfma_f32_16x16x32_bf16 v[40:43], v[100:103], a[96:99], v[40:43]
    ds_read_b64_tr_b16 v[132:133], v25 offset:40960
    v_cvt_pk_bf16_f32 v228, v72, v73
    v_cvt_pk_bf16_f32 v229, v74, v75
    v_cvt_pk_bf16_f32 v230, v76, v77
    v_cvt_pk_bf16_f32 v231, v78, v79
    buffer_store_dwordx4 v[228:231], v9, s[32:35], s46 offen offset:1024 sc1
    v_mfma_f32_16x16x32_bf16 v[44:47], v[100:103], a[100:103], v[44:47]
    ds_read_b64_tr_b16 v[134:135], v25 offset:43008
    s_waitcnt lgkmcnt(4)
    v_mfma_f32_16x16x32_bf16 v[48:51], v[104:107], a[96:99], v[48:51]
    ds_read_b64_tr_b16 v[136:137], v26 offset:40960
    v_cvt_pk_bf16_f32 v232, v80, v81
    v_cvt_pk_bf16_f32 v233, v82, v83
    v_cvt_pk_bf16_f32 v234, v84, v85
    v_cvt_pk_bf16_f32 v235, v86, v87
    buffer_store_dwordx4 v[232:235], v9, s[32:35], s46 offen offset:2048 sc1
    v_mfma_f32_16x16x32_bf16 v[52:55], v[104:107], a[100:103], v[52:55]
    ds_read_b64_tr_b16 v[138:139], v26 offset:43008
    v_mfma_f32_16x16x32_bf16 v[56:59], v[108:111], a[96:99], v[56:59]
    ds_read_b64_tr_b16 v[140:141], v27 offset:40960
    v_cvt_pk_bf16_f32 v236, v88, v89
    v_cvt_pk_bf16_f32 v237, v90, v91
    v_cvt_pk_bf16_f32 v238, v92, v93
    v_cvt_pk_bf16_f32 v239, v94, v95
    buffer_store_dwordx4 v[236:239], v9, s[32:35], s46 offen offset:3072 sc1
    v_mfma_f32_16x16x32_bf16 v[60:63], v[108:111], a[100:103], v[60:63]
    ds_read_b64_tr_b16 v[142:143], v27 offset:43008
    s_waitcnt lgkmcnt(4)
    v_mfma_f32_16x16x32_bf16 v[32:35], v[128:131], a[104:107], v[32:35]
    ds_read_b64_tr_b16 v[96:97], v24 offset:49152
    v_mfma_f32_16x16x32_bf16 v[36:39], v[128:131], a[108:111], v[36:39]
    ds_read_b64_tr_b16 v[98:99], v24 offset:51200
    v_mfma_f32_16x16x32_bf16 v[40:43], v[132:135], a[104:107], v[40:43]
    ds_read_b64_tr_b16 v[100:101], v25 offset:49152
    v_mfma_f32_16x16x32_bf16 v[44:47], v[132:135], a[108:111], v[44:47]
    ds_read_b64_tr_b16 v[102:103], v25 offset:51200
    s_waitcnt lgkmcnt(4)
    v_mfma_f32_16x16x32_bf16 v[48:51], v[136:139], a[104:107], v[48:51]
    ds_read_b64_tr_b16 v[104:105], v26 offset:49152
    v_mfma_f32_16x16x32_bf16 v[52:55], v[136:139], a[108:111], v[52:55]
    ds_read_b64_tr_b16 v[106:107], v26 offset:51200
    v_mfma_f32_16x16x32_bf16 v[56:59], v[140:143], a[104:107], v[56:59]
    ds_read_b64_tr_b16 v[108:109], v27 offset:49152
    v_mfma_f32_16x16x32_bf16 v[60:63], v[140:143], a[108:111], v[60:63]
    ds_read_b64_tr_b16 v[110:111], v27 offset:51200
    s_waitcnt lgkmcnt(4)
    v_mfma_f32_16x16x32_bf16 v[32:35], v[96:99], a[112:115], v[32:35]
    ds_read_b64_tr_b16 v[128:129], v24 offset:57344
    v_mfma_f32_16x16x32_bf16 v[36:39], v[96:99], a[116:119], v[36:39]
    ds_read_b64_tr_b16 v[130:131], v24 offset:59392
    v_mfma_f32_16x16x32_bf16 v[40:43], v[100:103], a[112:115], v[40:43]
    ds_read_b64_tr_b16 v[132:133], v25 offset:57344
    v_mfma_f32_16x16x32_bf16 v[44:47], v[100:103], a[116:119], v[44:47]
    ds_read_b64_tr_b16 v[134:135], v25 offset:59392
    s_waitcnt lgkmcnt(4)
    v_mfma_f32_16x16x32_bf16 v[48:51], v[104:107], a[112:115], v[48:51]
    ds_read_b64_tr_b16 v[136:137], v26 offset:57344
    v_mfma_f32_16x16x32_bf16 v[52:55], v[104:107], a[116:119], v[52:55]
    ds_read_b64_tr_b16 v[138:139], v26 offset:59392
    v_mfma_f32_16x16x32_bf16 v[56:59], v[108:111], a[112:115], v[56:59]
    ds_read_b64_tr_b16 v[140:141], v27 offset:57344
    v_mfma_f32_16x16x32_bf16 v[60:63], v[108:111], a[116:119], v[60:63]
    ds_read_b64_tr_b16 v[142:143], v27 offset:59392
    s_waitcnt lgkmcnt(4)
    v_mfma_f32_16x16x32_bf16 v[32:35], v[128:131], a[120:123], v[32:35]
    ds_read_b64_tr_b16 v[96:97], v16 offset:0
    v_mfma_f32_16x16x32_bf16 v[36:39], v[128:131], a[124:127], v[36:39]
    ds_read_b64_tr_b16 v[98:99], v16 offset:2048
    v_mfma_f32_16x16x32_bf16 v[40:43], v[132:135], a[120:123], v[40:43]
    ds_read_b64_tr_b16 v[100:101], v17 offset:0
    v_mfma_f32_16x16x32_bf16 v[44:47], v[132:135], a[124:127], v[44:47]
    ds_read_b64_tr_b16 v[102:103], v17 offset:2048
    s_waitcnt lgkmcnt(4)
    v_mfma_f32_16x16x32_bf16 v[48:51], v[136:139], a[120:123], v[48:51]
    ds_read_b64_tr_b16 v[104:105], v18 offset:0
    v_mfma_f32_16x16x32_bf16 v[52:55], v[136:139], a[124:127], v[52:55]
    ds_read_b64_tr_b16 v[106:107], v18 offset:2048
    v_mfma_f32_16x16x32_bf16 v[56:59], v[140:143], a[120:123], v[56:59]
    ds_read_b64_tr_b16 v[108:109], v19 offset:0
    v_mfma_f32_16x16x32_bf16 v[60:63], v[140:143], a[124:127], v[60:63]
    ds_read_b64_tr_b16 v[110:111], v19 offset:2048
    s_waitcnt lgkmcnt(4)
    v_mfma_f32_16x16x32_bf16 v[32:35], v[96:99], a[0:3], v[32:35]
    ds_read_b64_tr_b16 v[128:129], v16 offset:8192
    v_mfma_f32_16x16x32_bf16 v[36:39], v[96:99], a[4:7], v[36:39]
    ds_read_b64_tr_b16 v[130:131], v16 offset:10240
    v_mfma_f32_16x16x32_bf16 v[40:43], v[100:103], a[0:3], v[40:43]
    ds_read_b64_tr_b16 v[132:133], v17 offset:8192
    v_mfma_f32_16x16x32_bf16 v[44:47], v[100:103], a[4:7], v[44:47]
    ds_read_b64_tr_b16 v[134:135], v17 offset:10240
    s_waitcnt lgkmcnt(4)
    v_mfma_f32_16x16x32_bf16 v[48:51], v[104:107], a[0:3], v[48:51]
    ds_read_b64_tr_b16 v[136:137], v18 offset:8192
    v_mfma_f32_16x16x32_bf16 v[52:55], v[104:107], a[4:7], v[52:55]
    ds_read_b64_tr_b16 v[138:139], v18 offset:10240
    v_mfma_f32_16x16x32_bf16 v[56:59], v[108:111], a[0:3], v[56:59]
    ds_read_b64_tr_b16 v[140:141], v19 offset:8192
    v_mfma_f32_16x16x32_bf16 v[60:63], v[108:111], a[4:7], v[60:63]
    ds_read_b64_tr_b16 v[142:143], v19 offset:10240
    s_waitcnt lgkmcnt(4)
    v_mfma_f32_16x16x32_bf16 v[32:35], v[128:131], a[8:11], v[32:35]
    ds_read_b64_tr_b16 v[96:97], v16 offset:16384
    v_mfma_f32_16x16x32_bf16 v[36:39], v[128:131], a[12:15], v[36:39]
    ds_read_b64_tr_b16 v[98:99], v16 offset:18432
    v_mfma_f32_16x16x32_bf16 v[40:43], v[132:135], a[8:11], v[40:43]
    ds_read_b64_tr_b16 v[100:101], v17 offset:16384
    v_mfma_f32_16x16x32_bf16 v[44:47], v[132:135], a[12:15], v[44:47]
    ds_read_b64_tr_b16 v[102:103], v17 offset:18432
    s_waitcnt lgkmcnt(4)
    v_mfma_f32_16x16x32_bf16 v[48:51], v[136:139], a[8:11], v[48:51]
    ds_read_b64_tr_b16 v[104:105], v18 offset:16384
    v_mfma_f32_16x16x32_bf16 v[52:55], v[136:139], a[12:15], v[52:55]
    ds_read_b64_tr_b16 v[106:107], v18 offset:18432
    v_mfma_f32_16x16x32_bf16 v[56:59], v[140:143], a[8:11], v[56:59]
    ds_read_b64_tr_b16 v[108:109], v19 offset:16384
    v_mfma_f32_16x16x32_bf16 v[60:63], v[140:143], a[12:15], v[60:63]
    ds_read_b64_tr_b16 v[110:111], v19 offset:18432
    s_waitcnt lgkmcnt(4)
    v_mfma_f32_16x16x32_bf16 v[32:35], v[96:99], a[16:19], v[32:35]
    ds_read_b64_tr_b16 v[128:129], v16 offset:24576
    v_mfma_f32_16x16x32_bf16 v[36:39], v[96:99], a[20:23], v[36:39]
    ds_read_b64_tr_b16 v[130:131], v16 offset:26624
    v_mfma_f32_16x16x32_bf16 v[40:43], v[100:103], a[16:19], v[40:43]
    ds_read_b64_tr_b16 v[132:133], v17 offset:24576
    v_mfma_f32_16x16x32_bf16 v[44:47], v[100:103], a[20:23], v[44:47]
    ds_read_b64_tr_b16 v[134:135], v17 offset:26624
    s_waitcnt lgkmcnt(4)
    v_mfma_f32_16x16x32_bf16 v[48:51], v[104:107], a[16:19], v[48:51]
    ds_read_b64_tr_b16 v[136:137], v18 offset:24576
    v_mfma_f32_16x16x32_bf16 v[52:55], v[104:107], a[20:23], v[52:55]
    ds_read_b64_tr_b16 v[138:139], v18 offset:26624
    v_mfma_f32_16x16x32_bf16 v[56:59], v[108:111], a[16:19], v[56:59]
    ds_read_b64_tr_b16 v[140:141], v19 offset:24576
    v_mfma_f32_16x16x32_bf16 v[60:63], v[108:111], a[20:23], v[60:63]
    ds_read_b64_tr_b16 v[142:143], v19 offset:26624
    s_waitcnt lgkmcnt(4)
    v_mfma_f32_16x16x32_bf16 v[32:35], v[128:131], a[24:27], v[32:35]
    ds_read_b64_tr_b16 v[96:97], v16 offset:32768
    v_mfma_f32_16x16x32_bf16 v[36:39], v[128:131], a[28:31], v[36:39]
    ds_read_b64_tr_b16 v[98:99], v16 offset:34816
    v_mfma_f32_16x16x32_bf16 v[40:43], v[132:135], a[24:27], v[40:43]
    ds_read_b64_tr_b16 v[100:101], v17 offset:32768
    v_mfma_f32_16x16x32_bf16 v[44:47], v[132:135], a[28:31], v[44:47]
    ds_read_b64_tr_b16 v[102:103], v17 offset:34816
    s_waitcnt lgkmcnt(4)
    v_mfma_f32_16x16x32_bf16 v[48:51], v[136:139], a[24:27], v[48:51]
    ds_read_b64_tr_b16 v[104:105], v18 offset:32768
    v_mfma_f32_16x16x32_bf16 v[52:55], v[136:139], a[28:31], v[52:55]
    ds_read_b64_tr_b16 v[106:107], v18 offset:34816
    v_mfma_f32_16x16x32_bf16 v[56:59], v[140:143], a[24:27], v[56:59]
    ds_read_b64_tr_b16 v[108:109], v19 offset:32768
    v_mfma_f32_16x16x32_bf16 v[60:63], v[140:143], a[28:31], v[60:63]
    ds_read_b64_tr_b16 v[110:111], v19 offset:34816
    s_waitcnt lgkmcnt(4)
    v_mfma_f32_16x16x32_bf16 v[32:35], v[96:99], a[32:35], v[32:35]
    ds_read_b64_tr_b16 v[128:129], v16 offset:40960
    v_mfma_f32_16x16x32_bf16 v[36:39], v[96:99], a[36:39], v[36:39]
    ds_read_b64_tr_b16 v[130:131], v16 offset:43008
    v_mfma_f32_16x16x32_bf16 v[40:43], v[100:103], a[32:35], v[40:43]
    ds_read_b64_tr_b16 v[132:133], v17 offset:40960
    v_mfma_f32_16x16x32_bf16 v[44:47], v[100:103], a[36:39], v[44:47]
    ds_read_b64_tr_b16 v[134:135], v17 offset:43008
    s_waitcnt lgkmcnt(4)
    v_mfma_f32_16x16x32_bf16 v[48:51], v[104:107], a[32:35], v[48:51]
    ds_read_b64_tr_b16 v[136:137], v18 offset:40960
    v_mfma_f32_16x16x32_bf16 v[52:55], v[104:107], a[36:39], v[52:55]
    ds_read_b64_tr_b16 v[138:139], v18 offset:43008
    v_mfma_f32_16x16x32_bf16 v[56:59], v[108:111], a[32:35], v[56:59]
    ds_read_b64_tr_b16 v[140:141], v19 offset:40960
    v_mfma_f32_16x16x32_bf16 v[60:63], v[108:111], a[36:39], v[60:63]
    ds_read_b64_tr_b16 v[142:143], v19 offset:43008
    s_waitcnt lgkmcnt(4)
    v_mfma_f32_16x16x32_bf16 v[32:35], v[128:131], a[40:43], v[32:35]
    ds_read_b64_tr_b16 v[96:97], v16 offset:49152
    v_mfma_f32_16x16x32_bf16 v[36:39], v[128:131], a[44:47], v[36:39]
    ds_read_b64_tr_b16 v[98:99], v16 offset:51200
    v_mfma_f32_16x16x32_bf16 v[40:43], v[132:135], a[40:43], v[40:43]
    ds_read_b64_tr_b16 v[100:101], v17 offset:49152
    v_mfma_f32_16x16x32_bf16 v[44:47], v[132:135], a[44:47], v[44:47]
    ds_read_b64_tr_b16 v[102:103], v17 offset:51200
    s_waitcnt lgkmcnt(4)
    v_mfma_f32_16x16x32_bf16 v[48:51], v[136:139], a[40:43], v[48:51]
    ds_read_b64_tr_b16 v[104:105], v18 offset:49152
    v_mfma_f32_16x16x32_bf16 v[52:55], v[136:139], a[44:47], v[52:55]
    ds_read_b64_tr_b16 v[106:107], v18 offset:51200
    v_mfma_f32_16x16x32_bf16 v[56:59], v[140:143], a[40:43], v[56:59]
    ds_read_b64_tr_b16 v[108:109], v19 offset:49152
    v_mfma_f32_16x16x32_bf16 v[60:63], v[140:143], a[44:47], v[60:63]
    ds_read_b64_tr_b16 v[110:111], v19 offset:51200
    s_waitcnt lgkmcnt(4)
    v_mfma_f32_16x16x32_bf16 v[32:35], v[96:99], a[48:51], v[32:35]
    ds_read_b64_tr_b16 v[128:129], v16 offset:57344
    v_mfma_f32_16x16x32_bf16 v[36:39], v[96:99], a[52:55], v[36:39]
    ds_read_b64_tr_b16 v[130:131], v16 offset:59392
    v_mfma_f32_16x16x32_bf16 v[40:43], v[100:103], a[48:51], v[40:43]
    ds_read_b64_tr_b16 v[132:133], v17 offset:57344
    v_mfma_f32_16x16x32_bf16 v[44:47], v[100:103], a[52:55], v[44:47]
    ds_read_b64_tr_b16 v[134:135], v17 offset:59392
    s_waitcnt lgkmcnt(4)
    v_mfma_f32_16x16x32_bf16 v[48:51], v[104:107], a[48:51], v[48:51]
    ds_read_b64_tr_b16 v[136:137], v18 offset:57344
    v_mfma_f32_16x16x32_bf16 v[52:55], v[104:107], a[52:55], v[52:55]
    ds_read_b64_tr_b16 v[138:139], v18 offset:59392
    v_mfma_f32_16x16x32_bf16 v[56:59], v[108:111], a[48:51], v[56:59]
    ds_read_b64_tr_b16 v[140:141], v19 offset:57344
    buffer_load_dwordx4 v[192:195], v9, s[32:35], s47 offen offset:0 sc1
    buffer_load_dwordx4 v[196:199], v9, s[32:35], s47 offen offset:1024 sc1
    buffer_load_dwordx4 v[200:203], v9, s[32:35], s47 offen offset:2048 sc1
    buffer_load_dwordx4 v[204:207], v9, s[32:35], s47 offen offset:3072 sc1
    v_mfma_f32_16x16x32_bf16 v[60:63], v[108:111], a[52:55], v[60:63]
    ds_read_b64_tr_b16 v[142:143], v19 offset:59392
    s_waitcnt lgkmcnt(4)
    v_mfma_f32_16x16x32_bf16 v[32:35], v[128:131], a[56:59], v[32:35]
    v_mfma_f32_16x16x32_bf16 v[36:39], v[128:131], a[60:63], v[36:39]
    v_mfma_f32_16x16x32_bf16 v[40:43], v[132:135], a[56:59], v[40:43]
    v_mfma_f32_16x16x32_bf16 v[44:47], v[132:135], a[60:63], v[44:47]
    s_waitcnt lgkmcnt(0)
    v_mfma_f32_16x16x32_bf16 v[48:51], v[136:139], a[56:59], v[48:51]
    v_mfma_f32_16x16x32_bf16 v[52:55], v[136:139], a[60:63], v[52:55]
    v_mfma_f32_16x16x32_bf16 v[56:59], v[140:143], a[56:59], v[56:59]
    v_mfma_f32_16x16x32_bf16 v[60:63], v[140:143], a[60:63], v[60:63]
    s_waitcnt vmcnt(0)
    v_max3_u32 v6, v192, v193, v194
    v_max3_u32 v7, v195, v196, v197
    v_max3_u32 v6, v6, v198, v199
    v_max3_u32 v7, v7, v200, v201
    v_max3_u32 v6, v6, v202, v203
    v_max3_u32 v7, v7, v204, v205
    v_max3_u32 v6, v6, v206, v207
    v_max_u32 v6, v6, v7
    v_cmp_eq_u32 vcc, -1, v6
    s_cbranch_vccz L_k4_glu_kernel_got_7
L_k4_glu_kernel_poll_6:
    buffer_load_dwordx4 v[192:195], v9, s[32:35], s47 offen offset:0 sc1
    buffer_load_dwordx4 v[196:199], v9, s[32:35], s47 offen offset:1024 sc1
    buffer_load_dwordx4 v[200:203], v9, s[32:35], s47 offen offset:2048 sc1
    buffer_load_dwordx4 v[204:207], v9, s[32:35], s47 offen offset:3072 sc1
    s_add_u32 s45, s45, 1
    s_waitcnt vmcnt(0)
    s_cmp_gt_u32 s45, 4000
    s_cbranch_scc1 L_k4_glu_kernel_got_7
    v_max3_u32 v6, v192, v193, v194
    v_max3_u32 v7, v195, v196, v197
    v_max3_u32 v6, v6, v198, v199
    v_max3_u32 v7, v7, v200, v201
    v_max3_u32 v6, v6, v202, v203
    v_max3_u32 v7, v7, v204, v205
    v_max3_u32 v6, v6, v206, v207
    v_max_u32 v6, v6, v7
    v_cmp_eq_u32 vcc, -1, v6
    s_cbranch_vccnz L_k4_glu_kernel_poll_6
L_k4_glu_kernel_got_7:
    v_lshlrev_b32 v6, 16, v192
    v_and_b32 v7, 0xffff0000, v192
    v_lshlrev_b32 v11, 16, v176
    v_and_b32 v12, 0xffff0000, v176
    v_add_f32 v6, v6, v32
    v_add_f32 v7, v7, v33
    v_fma_f32 v6, v6, v160, v11
    v_fma_f32 v7, v7, v161, v12
    v_cvt_pk_bf16_f32 v96, v6, v7
    v_lshlrev_b32 v6, 16, v193
    v_and_b32 v7, 0xffff0000, v193
    v_lshlrev_b32 v11, 16, v177
    v_and_b32 v12, 0xffff0000, v177
    v_add_f32 v6, v6, v34
    v_add_f32 v7, v7, v35
    v_fma_f32 v6, v6, v162, v11
    v_fma_f32 v7, v7, v163, v12
    v_cvt_pk_bf16_f32 v97, v6, v7
    ds_write_b64 v14, v[96:97] offset:0
    v_lshlrev_b32 v6, 16, v194
    v_and_b32 v7, 0xffff0000, v194
    v_lshlrev_b32 v11, 16, v178
    v_and_b32 v12, 0xffff0000, v178
    v_add_f32 v6, v6, v36
    v_add_f32 v7, v7, v37
    v_fma_f32 v6, v6, v160, v11
    v_fma_f32 v7, v7, v161, v12
    v_cvt_pk_bf16_f32 v98, v6, v7
    v_lshlrev_b32 v6, 16, v195
    v_and_b32 v7, 0xffff0000, v195
    v_lshlrev_b32 v11, 16, v179
    v_and_b32 v12, 0xffff0000, v179
    v_add_f32 v6, v6, v38
    v_add_f32 v7, v7, v39
    v_fma_f32 v6, v6, v162, v11
    v_fma_f32 v7, v7, v163, v12
    v_cvt_pk_bf16_f32 v99, v6, v7
    ds_write_b64 v14, v[98:99] offset:2304
    v_lshlrev_b32 v6, 16, v196
    v_and_b32 v7, 0xffff0000, v196
    v_lshlrev_b32 v11, 16, v180
    v_and_b32 v12, 0xffff0000, v180
    v_add_f32 v6, v6, v40
    v_add_f32 v7, v7, v41
    v_fma_f32 v6, v6, v164, v11
    v_fma_f32 v7, v7, v165, v12
    v_cvt_pk_bf16_f32 v100, v6, v7
    v_lshlrev_b32 v6, 16, v197
    v_and_b32 v7, 0xffff0000, v197
    v_lshlrev_b32 v11, 16, v181
    v_and_b32 v12, 0xffff0000, v181
    v_add_f32 v6, v6, v42
    v_add_f32 v7, v7, v43
    v_fma_f32 v6, v6, v166, v11
    v_fma_f32 v7, v7, v167, v12
    v_cvt_pk_bf16_f32 v101, v6, v7
    ds_write_b64 v14, v[100:101] offset:32
    v_lshlrev_b32 v6, 16, v198
    v_and_b32 v7, 0xffff0000, v198
    v_lshlrev_b32 v11, 16, v182
    v_and_b32 v12, 0xffff0000, v182
    v_add_f32 v6, v6, v44
    v_add_f32 v7, v7, v45
    v_fma_f32 v6, v6, v164, v11
    v_fma_f32 v7, v7, v165, v12
    v_cvt_pk_bf16_f32 v102, v6, v7
    v_lshlrev_b32 v6, 16, v199
    v_and_b32 v7, 0xffff0000, v199
    v_lshlrev_b32 v11, 16, v183
    v_and_b32 v12, 0xffff0000, v183
    v_add_f32 v6, v6, v46
    v_add_f32 v7, v7, v47
    v_fma_f32 v6, v6, v166, v11
    v_fma_f32 v7, v7, v167, v12
    v_cvt_pk_bf16_f32 v103, v6, v7
    ds_write_b64 v14, v[102:103] offset:2336
    v_lshlrev_b32 v6, 16, v200
    v_and_b32 v7, 0xffff0000, v200
    v_lshlrev_b32 v11, 16, v184
    v_and_b32 v12, 0xffff0000, v184
    v_add_f32 v6, v6, v48
    v_add_f32 v7, v7, v49
    v_fma_f32 v6, v6, v168, v11
    v_fma_f32 v7, v7, v169, v12
    v_cvt_pk_bf16_f32 v104, v6, v7
    v_lshlrev_b32 v6, 16, v201
    v_and_b32 v7, 0xffff0000, v201
    v_lshlrev_b32 v11, 16, v185
    v_and_b32 v12, 0xffff0000, v185
    v_add_f32 v6, v6, v50
    v_add_f32 v7, v7, v51
    v_fma_f32 v6, v6, v170, v11
    v_fma_f32 v7, v7, v171, v12
    v_cvt_pk_bf16_f32 v105, v6, v7
    ds_write_b64 v14, v[104:105] offset:64
    v_lshlrev_b32 v6, 16, v202
    v_and_b32 v7, 0xffff0000, v202
    v_lshlrev_b32 v11, 16, v186
    v_and_b32 v12, 0xffff0000, v186
    v_add_f32 v6, v6, v52
    v_add_f32 v7, v7, v53
    v_fma_f32 v6, v6, v168, v11
    v_fma_f32 v7, v7, v169, v12
    v_cvt_pk_bf16_f32 v106, v6, v7
    v_lshlrev_b32 v6, 16, v203
    v_and_b32 v7, 0xffff0000, v203
    v_lshlrev_b32 v11, 16, v187
    v_and_b32 v12, 0xffff0000, v187
    v_add_f32 v6, v6, v54
    v_add_f32 v7, v7, v55
    v_fma_f32 v6, v6, v170, v11
    v_fma_f32 v7, v7, v171, v12
    v_cvt_pk_bf16_f32 v107, v6, v7
    ds_write_b64 v14, v[106:107] offset:2368
    v_lshlrev_b32 v6, 16, v204
    v_and_b32 v7, 0xffff0000, v204
    v_lshlrev_b32 v11, 16, v188
    v_and_b32 v12, 0xffff0000, v188
    v_add_f32 v6, v6, v56
    v_add_f32 v7, v7, v57
    v_fma_f32 v6, v6, v172, v11
    v_fma_f32 v7, v7, v173, v12
    v_cvt_pk_bf16_f32 v108, v6, v7
    v_lshlrev_b32 v6, 16, v205
    v_and_b32 v7, 0xffff0000, v205
    v_lshlrev_b32 v11, 16, v189
    v_and_b32 v12, 0xffff0000, v189
    v_add_f32 v6, v6, v58
    v_add_f32 v7, v7, v59
    v_fma_f32 v6, v6, v174, v11
    v_fma_f32 v7, v7, v175, v12
    v_cvt_pk_bf16_f32 v109, v6, v7
    ds_write_b64 v14, v[108:109] offset:96
    v_lshlrev_b32 v6, 16, v206
    v_and_b32 v7, 0xffff0000, v206
    v_lshlrev_b32 v11, 16, v190
    v_and_b32 v12, 0xffff0000, v190
    v_add_f32 v6, v6, v60
    v_add_f32 v7, v7, v61
    v_fma_f32 v6, v6, v172, v11
    v_fma_f32 v7, v7, v173, v12
    v_cvt_pk_bf16_f32 v110, v6, v7
    v_lshlrev_b32 v6, 16, v207
    v_and_b32 v7, 0xffff0000, v207
    v_lshlrev_b32 v11, 16, v191
    v_and_b32 v12, 0xffff0000, v191
    v_add_f32 v6, v6, v62
    v_add_f32 v7, v7, v63
    v_fma_f32 v6, v6, v174, v11
    v_fma_f32 v7, v7, v175, v12
    v_cvt_pk_bf16_f32 v111, v6, v7
    ds_write_b64 v14, v[110:111] offset:2400
    s_waitcnt lgkmcnt(0)
    ds_read_b128 v[112:115], v15 offset:0
    ds_read_b128 v[116:119], v15 offset:1152
    ds_read_b128 v[120:123], v15 offset:2304
    ds_read_b128 v[124:127], v15 offset:3456
    s_waitcnt lgkmcnt(3)
    buffer_store_dwordx4 v[112:115], v10, s[24:27], s16 offen sc1
    s_add_u32 s16, s16, 16384
    s_waitcnt lgkmcnt(2)
    buffer_store_dwordx4 v[116:119], v10, s[24:27], s16 offen sc1
    s_add_u32 s16, s16, 16384
    s_waitcnt lgkmcnt(1)
    buffer_store_dwordx4 v[120:123], v10, s[24:27], s16 offen sc1
    s_add_u32 s16, s16, 16384
    s_waitcnt lgkmcnt(0)
    buffer_store_dwordx4 v[124:127], v10, s[24:27], s16 offen sc1
L_k4_glu_kernel_end:
    s_endpgm
.section .rodata,"a"
.p2align 6
.amdhsa_kernel k0_mod_kernel
  .amdhsa_next_free_vgpr 96
  .amdhsa_next_free_sgpr 96
  .amdhsa_accum_offset 96
  .amdhsa_group_segment_fixed_size 0
  .amdhsa_kernarg_size 112
  .amdhsa_user_sgpr_count 2
  .amdhsa_user_sgpr_kernarg_segment_ptr 1
  .amdhsa_system_sgpr_workgroup_id_x 1
.end_amdhsa_kernel
.p2align 6
.amdhsa_kernel ka_attn_kernel
  .amdhsa_next_free_vgpr 256
  .amdhsa_next_free_sgpr 102
  .amdhsa_accum_offset 256
  .amdhsa_group_segment_fixed_size 0
  .amdhsa_kernarg_size 112
  .amdhsa_user_sgpr_count 2
  .amdhsa_user_sgpr_kernarg_segment_ptr 1
  .amdhsa_system_sgpr_workgroup_id_x 1
.end_amdhsa_kernel
.p2align 6
.amdhsa_kernel k4_glu_kernel
  .amdhsa_next_free_vgpr 512
  .amdhsa_next_free_sgpr 96
  .amdhsa_accum_offset 256
  .amdhsa_group_segment_fixed_size 0
  .amdhsa_kernarg_size 112
  .amdhsa_user_sgpr_count 2
  .amdhsa_user_sgpr_kernarg_segment_ptr 1
  .amdhsa_system_sgpr_workgroup_id_x 1
.end_amdhsa_kernel
```
